```python
import torch

def _softmax(x, axis=-1):
    return torch.softmax(x, dim=axis)

def _gelu(x):
    return torch.nn.functional.gelu(x, approximate='tanh')

def _silu(x):
    return torch.nn.functional.silu(x)

def _sigmoid(x):
    return torch.sigmoid(x)

def _layernorm(x, axis=-1, eps=1e-05):
    m = x.mean(dim=axis, keepdim=True)
    v = x.var(dim=axis, keepdim=True, unbiased=False)
    return (x - m) / torch.sqrt(v + eps)

def _scatter_add(tgt, idx, src, axis=0):
    return tgt.clone().index_add_(axis, idx, src)

def _segment_sum(src, seg, n):
    out = torch.zeros((n,) + src.shape[1:], dtype=src.dtype)
    return out.index_add_(0, seg, src)

def _pad(x, pw):
    flat = tuple((v for pair in reversed(pw) for v in pair))
    return torch.nn.functional.pad(x, flat)
kernel_name = 'adaLN_cond__mha_block_cached__moe_arch_mod__prompt'

def setup_inputs():

    _w = lambda a: (lambda t: t.to(torch.bfloat16) if t.is_floating_point() else t)(torch.as_tensor(a))

    def _A_setup():
        B, Sq, D = (1, 2048, 448)
        H, Sk, Dh = (16, 2048, 256)
        return {'x': _w((lambda *s: torch.randn(*s, dtype=torch.bfloat16) * 0.05)(B, Sq, D)), 'k_cache': _w((lambda *s: torch.randn(*s, dtype=torch.bfloat16) * 3.2)(B, H, Sk, Dh)), 'v_cache': _w((lambda *s: torch.randn(*s, dtype=torch.bfloat16) * 0.4)(B, H, Sk, Dh)), 'wq': _w((lambda *s: torch.randn(*s, dtype=torch.bfloat16) * 3.2)(D, H * Dh) * D ** (-0.5)), 'wo': _w((lambda *s: torch.randn(*s, dtype=torch.bfloat16) * 0.4)(H * Dh, D) * (H * Dh) ** (-0.5))}
    _A_in = _A_setup()

    def _B_setup():
        B, S, D, F, C = (1, 2048, 448, 1792, 1)
        return {'x': _w((lambda *s: torch.randn(*s, dtype=torch.bfloat16) * 0.05)(B, S, D)), 'w_r': _w((lambda *s: torch.randn(*s, dtype=torch.bfloat16) * 3.2)(D)), 'w_gate': _w((lambda *s: torch.randn(*s, dtype=torch.bfloat16) * 0.1)(D, F)), 'w_up': _w((lambda *s: torch.randn(*s, dtype=torch.bfloat16) * 0.1)(D, F)), 'w_down': _w((lambda *s: torch.randn(*s, dtype=torch.bfloat16) * 0.1)(F, D))}
    _B_in = _B_setup()
    return {'A_x': _A_in['x'], 'A_k_cache': _A_in['k_cache'], 'A_v_cache': _A_in['v_cache'], 'A_wq': _A_in['wq'], 'A_wo': _A_in['wo'], 'B_x': _B_in['x'], 'B_w_r': _B_in['w_r'], 'B_w_gate': _B_in['w_gate'], 'B_w_up': _B_in['w_up'], 'B_w_down': _B_in['w_down'], 'c': _w((lambda *s: torch.randn(*s, dtype=torch.bfloat16) * 0.1)(1, 448) * 8.0), 'w_mod': _w((lambda *s: torch.randn(*s, dtype=torch.bfloat16) * 0.1)(448, 6 * 448) * 448 ** (-0.5) * 8.0)}

def reference(A_x, A_k_cache, A_v_cache, A_wq, A_wo, B_x, B_w_r, B_w_gate, B_w_up, B_w_down, c, w_mod):

    def _A_ref(x, k_cache, v_cache, wq, wo):
        B, Sq, D = x.shape
        H, Dh = (16, 256)
        q = (lambda x, *d: x.permute(*d))((x @ wq).reshape(B, Sq, H, Dh), 0, 2, 1, 3)
        scores = torch.einsum('bhqd,bhkd->bhqk', q, k_cache) * Dh ** (-0.5)
        p = _softmax(scores, axis=-1)
        o = torch.einsum('bhqk,bhkd->bhqd', p, v_cache)
        return (lambda x, *d: x.permute(*d))(o, 0, 2, 1, 3).reshape(B, Sq, H * Dh) @ wo

    def _B_ref(x, w_r, w_gate, w_up, w_down):
        B, S, D = x.shape
        C = 1
        r = x @ w_r
        idx = torch.argsort(-r, axis=-1)[:, :C]
        idx_e = (lambda x, n, axis: torch.repeat_interleave(x, n, dim=axis))(idx.reshape(B, C, 1), D, axis=2)
        x_sel = (lambda x, i, axis: torch.take_along_dim(x, i, dim=axis))(x, idx_e, axis=1)
        g = _silu(x_sel @ w_gate)
        u = x_sel @ w_up
        y = g * u @ w_down
        r_sel = _sigmoid((lambda x, i, axis: torch.take_along_dim(x, i, dim=axis))(r, idx, axis=1))
        y = y * r_sel.reshape(B, C, 1)
        b_off = (torch.arange(B) * S).reshape(B, 1)
        flat_idx = (idx + b_off).reshape(B * C)
        zero = (x * 0.0).reshape(B * S, D)
        upd = _scatter_add(zero, flat_idx, y.reshape(B * C, D), axis=0)
        return x + upd.reshape(B, S, D)
    x = A_x
    mod = (_silu(c) @ w_mod).reshape(c.shape[0], 6, 1, -1)
    sa, ca, ga, sb, cb, gb = (mod[:, 0].clone(), mod[:, 1].clone(), mod[:, 2].clone(), mod[:, 3].clone(), mod[:, 4].clone(), mod[:, 5].clone())
    h = _layernorm(x, axis=-1) * (1 + ca) + sa
    x = x + ga * _A_ref(h, A_k_cache, A_v_cache, A_wq, A_wo)
    h = _layernorm(x, axis=-1) * (1 + cb) + sb
    x = x + gb * _B_ref(h, B_w_r, B_w_gate, B_w_up, B_w_down)
    return x
```

```asm
; @launch kernel=k1_kernel grid=(256,1,1) block=(256,1,1) lds=163840
; @launch kernel=k2g_kernel grid=(256,1,1) block=(896,1,1) lds=86016
.amdgcn_target "amdgcn-amd-amdhsa--gfx950"
.text
.globl k1_kernel
.p2align 8
.type k1_kernel,@function
k1_kernel:
    s_cmp_ge_u32 s2, 256
    s_cbranch_scc1 k1_done
    s_load_dwordx8 s[36:43], s[0:1], 8
    s_load_dwordx2 s[44:45], s[0:1], 112
    s_load_dwordx4 s[92:95], s[0:1], 56
    s_load_dwordx2 s[96:97], s[0:1], 72
    s_load_dwordx2 s[60:61], s[0:1], 0
    s_load_dwordx4 s[64:67], s[0:1], 80
    s_load_dwordx2 s[76:77], s[0:1], 104
    v_lshrrev_b32 v1, 6, v0
    v_and_b32 v248, 63, v0
    s_getpc_b64 s[88:89]
k1_pc:
    v_lshlrev_b32 v240, 7, v0
    s_mov_b32 s90, k2g_end-k1_pc
    s_mov_b32 s91, 0x20000
    s_lshr_b32 s33, s2, 3
    s_lshl_b32 s33, s33, 11
    v_mov_b32 v241, 0x7ffffff0
    v_cmp_gt_u32 vcc, 16, v0
    s_nop 1
    v_cndmask_b32 v240, v241, v240, vcc
    buffer_load_dword v241, v240, s[88:91], s33 offen
    s_and_b32 s33, s2, 7
    s_lshl_b32 s33, s33, 1
    s_bfe_u32 s34, s2, 0x10003
    s_add_u32 s33, s33, s34
    v_readfirstlane_b32 s24, v1
    s_lshr_b32 s34, s2, 4
    s_mul_i32 s25, s24, 4224
    s_mul_i32 s26, s24, 4160
    s_lshl_b32 s35, s34, 2
    s_add_u32 s35, s35, s24
    s_mul_i32 s30, s35, 28672
    s_lshl_b32 s46, s33, 6
    s_add_u32 s46, s46, s35
    s_mul_i32 s31, s46, 28672
    s_add_u32 s31, s31, 4194304
    s_mov_b32 s27, 0
    s_mov_b32 s28, 0
    s_lshl_b32 s46, s33, 20
    s_lshl_b32 s47, s33, 9
    s_mul_i32 s48, s33, 229376
    s_waitcnt lgkmcnt(0)
    s_add_u32 s4, s36, s46
    s_addc_u32 s5, s37, 0
    s_mov_b32 s6, 1048576
    s_mov_b32 s7, 0x20000
    s_add_u32 s8, s38, s46
    s_addc_u32 s9, s39, 0
    s_mov_b32 s10, 1048576
    s_mov_b32 s11, 0x20000
    s_add_u32 s12, s40, s47
    s_addc_u32 s13, s41, 0
    s_sub_u32 s14, 3670016, s47
    s_mov_b32 s15, 0x20000
    s_add_u32 s16, s42, s48
    s_addc_u32 s17, s43, 0
    s_mov_b32 s18, 229376
    s_mov_b32 s19, 0x20000
    s_mov_b32 s20, s44
    s_mov_b32 s21, s45
    s_mov_b32 s22, 268435456
    s_mov_b32 s23, 0x20000
    s_mov_b32 s62, 1835008
    s_mov_b32 s63, 0x20000
    s_mov_b32 s68, s66
    s_mov_b32 s69, s67
    s_mov_b32 s70, 2408448
    s_mov_b32 s71, 0x20000
    s_mov_b32 s66, 896
    s_mov_b32 s67, 0x20000
    s_mov_b32 s78, 256
    s_mov_b32 s79, 0x20000
    s_mov_b32 s50, 4096
    buffer_load_dword v124, off, s[20:23], s50 sc1
    buffer_load_dword v125, off, s[76:79], 0 offset:4 sc1
    s_cmp_eq_u32 s24, 2
    s_cselect_b32 s92, s94, s92
    s_cselect_b32 s93, s95, s93
    s_cmp_eq_u32 s24, 3
    s_cselect_b32 s92, s96, s92
    s_cselect_b32 s93, s97, s93
    s_cmp_eq_u32 s24, 0
    s_cselect_b32 s92, s16, s92
    s_cselect_b32 s93, s17, s93
    s_cselect_b32 s94, s18, 1605632
    s_mov_b32 s95, 0x20000
    s_mul_i32 s98, s34, 14336
    s_mul_i32 s99, s2, 6272
    s_cselect_b32 s97, s98, s99
    s_mov_b32 s96, 131072
    s_lshl_b32 s46, s34, 11
    s_lshl_b32 s47, s24, 9
    s_add_u32 s98, s46, s47
    v_and_b32 v230, 3, v248
    v_lshlrev_b32 v230, 7, v230
    v_lshrrev_b32 v229, 2, v248
    v_lshl_add_u32 v229, v229, 15, v230
    v_add_u32 v229, s98, v229
    s_mov_b32 s98, 0
    v_mov_b32 v230, 0x7ffffff0
    v_cmp_gt_u32 vcc, 16, v248
    s_nop 1
    v_cndmask_b32 v231, v230, v229, vcc
    v_cmp_gt_u32 vcc, 8, v248
    s_nop 1
    v_cndmask_b32 v232, v230, v229, vcc
    v_lshlrev_b32 v229, 7, v248
    v_cndmask_b32 v233, v230, v229, vcc
    v_lshlrev_b32 v224, 4, v248
    v_lshrrev_b32 v249, 5, v248
    v_lshl_add_u32 v250, v249, 2, v1
    v_lshlrev_b32 v250, 13, v250
    v_and_b32 v251, 31, v248
    v_lshl_add_u32 v225, v251, 4, v250
    s_and_b32 s52, s2, 7
    s_lshr_b32 s53, s2, 3
    s_mul_i32 s54, s52, 7
    s_add_u32 s54, s54, s53
    s_mul_i32 s55, s52, 14
    s_add_u32 s55, s55, s53
    s_add_u32 s55, s55, 49
    s_cmp_lt_u32 s53, 7
    s_cselect_b32 s54, s54, s55
    s_cmp_ge_u32 s53, 21
    s_cselect_b32 s57, 1, 0
    s_cbranch_scc1 k1_xaddr
    s_lshl_b32 s57, s54, 5
    v_lshl_add_u32 v112, v1, 5, v251
    v_mul_u32_u24 v113, 5376, v112
    v_lshl_add_u32 v113, v249, 4, v113
    v_lshlrev_b32 v112, 1, v112
    buffer_load_ushort v116, v112, s[64:67], 0 offen offset:0
    buffer_load_ushort v117, v112, s[64:67], 0 offen offset:256
    buffer_load_ushort v118, v112, s[64:67], 0 offen offset:512
    buffer_load_ushort v119, v112, s[64:67], 0 offen offset:768
    buffer_load_dwordx4 v[128:131], v113, s[68:71], s57 offen
    s_add_u32 s57, s57, 688128
    buffer_load_dwordx4 v[132:135], v113, s[68:71], s57 offen
    s_add_u32 s57, s57, 688128
    buffer_load_dwordx4 v[136:139], v113, s[68:71], s57 offen
    s_add_u32 s57, s57, 688128
    buffer_load_dwordx4 v[140:143], v113, s[68:71], s57 offen
    s_mov_b32 s57, 0
k1_xaddr:
    v_lshrrev_b32 v120, 3, v248
    v_mul_u32_u24 v120, 896, v120
    v_and_b32 v121, 7, v248
    v_lshrrev_b32 v122, 4, v248
    v_xor_b32 v121, v121, v122
    v_lshl_add_u32 v144, v121, 4, v120
    v_xor_b32 v121, 4, v121
    v_lshl_add_u32 v145, v121, 4, v120
    s_mul_i32 s48, s24, 28672
    s_cmp_ge_u32 s24, 2
    s_cselect_b32 s47, 27136, 0
    s_add_u32 s48, s48, s47
    s_cmp_eq_u32 s24, 1
    s_cselect_b32 s58, 121344, s48
    s_add_u32 m0, s48, 0
    s_add_u32 s56, s30, 0
    buffer_load_dwordx4 v144, s[60:63], s56 offen  lds
    s_add_u32 m0, s48, 1024
    s_add_u32 s56, s30, 7168
    buffer_load_dwordx4 v145, s[60:63], s56 offen  lds
    s_add_u32 m0, s48, 2048
    s_add_u32 s56, s30, 14336
    buffer_load_dwordx4 v144, s[60:63], s56 offen  lds
    s_add_u32 m0, s48, 3072
    s_add_u32 s56, s30, 21504
    buffer_load_dwordx4 v145, s[60:63], s56 offen  lds
    s_add_u32 m0, s48, 4096
    s_add_u32 s56, s30, 128
    buffer_load_dwordx4 v144, s[60:63], s56 offen  lds
    s_add_u32 m0, s48, 5120
    s_add_u32 s56, s30, 7296
    buffer_load_dwordx4 v145, s[60:63], s56 offen  lds
    s_add_u32 m0, s48, 6144
    s_add_u32 s56, s30, 14464
    buffer_load_dwordx4 v144, s[60:63], s56 offen  lds
    s_add_u32 m0, s48, 7168
    s_add_u32 s56, s30, 21632
    buffer_load_dwordx4 v145, s[60:63], s56 offen  lds
    s_cmp_eq_u32 s57, 1
    s_cbranch_scc1 k1_nomod
    s_mov_b32 s46, 3216550459
    s_waitcnt vmcnt(12)
    v_lshlrev_b32 v116, 16, v116
    v_lshlrev_b32 v117, 16, v117
    v_lshlrev_b32 v118, 16, v118
    v_lshlrev_b32 v119, 16, v119
    v_mul_f32 v120, s46, v116
    v_mul_f32 v121, s46, v117
    v_mul_f32 v122, s46, v118
    v_mul_f32 v123, s46, v119
    v_exp_f32 v120, v120
    v_exp_f32 v121, v121
    v_exp_f32 v122, v122
    v_exp_f32 v123, v123
    v_add_f32 v120, 1.0, v120
    v_add_f32 v121, 1.0, v121
    v_add_f32 v122, 1.0, v122
    v_add_f32 v123, 1.0, v123
    v_rcp_f32 v120, v120
    v_rcp_f32 v121, v121
    v_rcp_f32 v122, v122
    v_rcp_f32 v123, v123
    v_mul_f32 v116, v116, v120
    v_mul_f32 v117, v117, v121
    v_mul_f32 v118, v118, v122
    v_mul_f32 v119, v119, v123
    v_cvt_pk_bf16_f32 v120, v116, v117
    v_cvt_pk_bf16_f32 v121, v118, v119
    v_lshlrev_b32 v116, 16, v120
    v_and_b32 v117, 0xffff0000, v120
    v_lshlrev_b32 v118, 16, v121
    v_and_b32 v119, 0xffff0000, v121
    s_waitcnt vmcnt(8)
    v_lshlrev_b32 v120, 16, v128
    v_and_b32 v121, 0xffff0000, v128
    v_mul_f32 v160, v120, v116
    v_mul_f32 v161, v121, v116
    v_lshlrev_b32 v120, 16, v129
    v_and_b32 v121, 0xffff0000, v129
    v_mul_f32 v162, v120, v116
    v_mul_f32 v163, v121, v116
    v_lshlrev_b32 v120, 16, v130
    v_and_b32 v121, 0xffff0000, v130
    v_mul_f32 v164, v120, v116
    v_mul_f32 v165, v121, v116
    v_lshlrev_b32 v120, 16, v131
    v_and_b32 v121, 0xffff0000, v131
    v_mul_f32 v166, v120, v116
    v_mul_f32 v167, v121, v116
    v_lshlrev_b32 v120, 16, v132
    v_and_b32 v121, 0xffff0000, v132
    v_fmac_f32 v160, v120, v117
    v_fmac_f32 v161, v121, v117
    v_lshlrev_b32 v120, 16, v133
    v_and_b32 v121, 0xffff0000, v133
    v_fmac_f32 v162, v120, v117
    v_fmac_f32 v163, v121, v117
    v_lshlrev_b32 v120, 16, v134
    v_and_b32 v121, 0xffff0000, v134
    v_fmac_f32 v164, v120, v117
    v_fmac_f32 v165, v121, v117
    v_lshlrev_b32 v120, 16, v135
    v_and_b32 v121, 0xffff0000, v135
    v_fmac_f32 v166, v120, v117
    v_fmac_f32 v167, v121, v117
    v_lshlrev_b32 v120, 16, v136
    v_and_b32 v121, 0xffff0000, v136
    v_fmac_f32 v160, v120, v118
    v_fmac_f32 v161, v121, v118
    v_lshlrev_b32 v120, 16, v137
    v_and_b32 v121, 0xffff0000, v137
    v_fmac_f32 v162, v120, v118
    v_fmac_f32 v163, v121, v118
    v_lshlrev_b32 v120, 16, v138
    v_and_b32 v121, 0xffff0000, v138
    v_fmac_f32 v164, v120, v118
    v_fmac_f32 v165, v121, v118
    v_lshlrev_b32 v120, 16, v139
    v_and_b32 v121, 0xffff0000, v139
    v_fmac_f32 v166, v120, v118
    v_fmac_f32 v167, v121, v118
    v_lshlrev_b32 v120, 16, v140
    v_and_b32 v121, 0xffff0000, v140
    v_fmac_f32 v160, v120, v119
    v_fmac_f32 v161, v121, v119
    v_lshlrev_b32 v120, 16, v141
    v_and_b32 v121, 0xffff0000, v141
    v_fmac_f32 v162, v120, v119
    v_fmac_f32 v163, v121, v119
    v_lshlrev_b32 v120, 16, v142
    v_and_b32 v121, 0xffff0000, v142
    v_fmac_f32 v164, v120, v119
    v_fmac_f32 v165, v121, v119
    v_lshlrev_b32 v120, 16, v143
    v_and_b32 v121, 0xffff0000, v143
    v_fmac_f32 v166, v120, v119
    v_fmac_f32 v167, v121, v119
    v_add_f32_dpp v160, v160, v160 row_shr:1 row_mask:0xf bank_mask:0xf bound_ctrl:0
    v_add_f32_dpp v161, v161, v161 row_shr:1 row_mask:0xf bank_mask:0xf bound_ctrl:0
    v_add_f32_dpp v162, v162, v162 row_shr:1 row_mask:0xf bank_mask:0xf bound_ctrl:0
    v_add_f32_dpp v163, v163, v163 row_shr:1 row_mask:0xf bank_mask:0xf bound_ctrl:0
    v_add_f32_dpp v164, v164, v164 row_shr:1 row_mask:0xf bank_mask:0xf bound_ctrl:0
    v_add_f32_dpp v165, v165, v165 row_shr:1 row_mask:0xf bank_mask:0xf bound_ctrl:0
    v_add_f32_dpp v166, v166, v166 row_shr:1 row_mask:0xf bank_mask:0xf bound_ctrl:0
    v_add_f32_dpp v167, v167, v167 row_shr:1 row_mask:0xf bank_mask:0xf bound_ctrl:0
    v_add_f32_dpp v160, v160, v160 row_shr:2 row_mask:0xf bank_mask:0xf bound_ctrl:0
    v_add_f32_dpp v161, v161, v161 row_shr:2 row_mask:0xf bank_mask:0xf bound_ctrl:0
    v_add_f32_dpp v162, v162, v162 row_shr:2 row_mask:0xf bank_mask:0xf bound_ctrl:0
    v_add_f32_dpp v163, v163, v163 row_shr:2 row_mask:0xf bank_mask:0xf bound_ctrl:0
    v_add_f32_dpp v164, v164, v164 row_shr:2 row_mask:0xf bank_mask:0xf bound_ctrl:0
    v_add_f32_dpp v165, v165, v165 row_shr:2 row_mask:0xf bank_mask:0xf bound_ctrl:0
    v_add_f32_dpp v166, v166, v166 row_shr:2 row_mask:0xf bank_mask:0xf bound_ctrl:0
    v_add_f32_dpp v167, v167, v167 row_shr:2 row_mask:0xf bank_mask:0xf bound_ctrl:0
    v_add_f32_dpp v160, v160, v160 row_shr:4 row_mask:0xf bank_mask:0xf bound_ctrl:0
    v_add_f32_dpp v161, v161, v161 row_shr:4 row_mask:0xf bank_mask:0xf bound_ctrl:0
    v_add_f32_dpp v162, v162, v162 row_shr:4 row_mask:0xf bank_mask:0xf bound_ctrl:0
    v_add_f32_dpp v163, v163, v163 row_shr:4 row_mask:0xf bank_mask:0xf bound_ctrl:0
    v_add_f32_dpp v164, v164, v164 row_shr:4 row_mask:0xf bank_mask:0xf bound_ctrl:0
    v_add_f32_dpp v165, v165, v165 row_shr:4 row_mask:0xf bank_mask:0xf bound_ctrl:0
    v_add_f32_dpp v166, v166, v166 row_shr:4 row_mask:0xf bank_mask:0xf bound_ctrl:0
    v_add_f32_dpp v167, v167, v167 row_shr:4 row_mask:0xf bank_mask:0xf bound_ctrl:0
    v_add_f32_dpp v160, v160, v160 row_shr:8 row_mask:0xf bank_mask:0xf bound_ctrl:0
    v_add_f32_dpp v161, v161, v161 row_shr:8 row_mask:0xf bank_mask:0xf bound_ctrl:0
    v_add_f32_dpp v162, v162, v162 row_shr:8 row_mask:0xf bank_mask:0xf bound_ctrl:0
    v_add_f32_dpp v163, v163, v163 row_shr:8 row_mask:0xf bank_mask:0xf bound_ctrl:0
    v_add_f32_dpp v164, v164, v164 row_shr:8 row_mask:0xf bank_mask:0xf bound_ctrl:0
    v_add_f32_dpp v165, v165, v165 row_shr:8 row_mask:0xf bank_mask:0xf bound_ctrl:0
    v_add_f32_dpp v166, v166, v166 row_shr:8 row_mask:0xf bank_mask:0xf bound_ctrl:0
    v_add_f32_dpp v167, v167, v167 row_shr:8 row_mask:0xf bank_mask:0xf bound_ctrl:0
    v_add_f32_dpp v160, v160, v160 row_bcast:15 row_mask:0xa bank_mask:0xf
    v_add_f32_dpp v161, v161, v161 row_bcast:15 row_mask:0xa bank_mask:0xf
    v_add_f32_dpp v162, v162, v162 row_bcast:15 row_mask:0xa bank_mask:0xf
    v_add_f32_dpp v163, v163, v163 row_bcast:15 row_mask:0xa bank_mask:0xf
    v_add_f32_dpp v164, v164, v164 row_bcast:15 row_mask:0xa bank_mask:0xf
    v_add_f32_dpp v165, v165, v165 row_bcast:15 row_mask:0xa bank_mask:0xf
    v_add_f32_dpp v166, v166, v166 row_bcast:15 row_mask:0xa bank_mask:0xf
    v_add_f32_dpp v167, v167, v167 row_bcast:15 row_mask:0xa bank_mask:0xf
    v_lshrrev_b32 v120, 5, v248
    v_lshlrev_b32 v120, 7, v120
    v_lshl_add_u32 v120, v1, 2, v120
    v_add_u32 v120, 154112, v120
    s_mov_b32 exec_lo, 0x80000000
    s_mov_b32 exec_hi, 0x80000000
    ds_write_b32 v120, v160 offset:0
    ds_write_b32 v120, v161 offset:16
    ds_write_b32 v120, v162 offset:32
    ds_write_b32 v120, v163 offset:48
    ds_write_b32 v120, v164 offset:64
    ds_write_b32 v120, v165 offset:80
    ds_write_b32 v120, v166 offset:96
    ds_write_b32 v120, v167 offset:112
    s_mov_b64 exec, -1
    s_waitcnt lgkmcnt(0)
    s_barrier
    s_cmp_lg_u32 s24, 0
    s_cbranch_scc1 k1_nomod
    s_cmp_ge_u32 s54, 56
    s_cbranch_scc1 k1_modrest
    v_readfirstlane_b32 s50, v124
    v_readfirstlane_b32 s49, v125
    s_nop 3
    s_add_u32 s50, s50, 1
    s_cselect_b32 s50, 1, s50
    s_cmp_eq_u32 s49, 0
    s_cselect_b32 s51, s50, s49
    v_and_b32 v120, 3, v248
    v_lshlrev_b32 v120, 6, v120
    v_add_u32 v120, 154112, v120
    ds_read_b128 v[128:131], v120 offset:0
    ds_read_b128 v[132:135], v120 offset:16
    ds_read_b128 v[136:139], v120 offset:32
    ds_read_b128 v[140:143], v120 offset:48
    v_lshrrev_b32 v121, 3, v248
    v_lshlrev_b32 v121, 13, v121
    v_and_b32 v122, 7, v248
    v_lshl_add_u32 v121, v122, 4, v121
    s_lshl_b32 s46, s54, 7
    s_add_u32 s46, s46, 1966080
    v_mov_b32 v161, s51
    v_mov_b32 v163, s51
    s_waitcnt lgkmcnt(0)
    v_add_f32 v128, v128, v129
    v_add_f32 v130, v130, v131
    v_add_f32 v128, v128, v130
    v_add_f32 v132, v132, v133
    v_add_f32 v134, v134, v135
    v_add_f32 v132, v132, v134
    v_add_f32 v136, v136, v137
    v_add_f32 v138, v138, v139
    v_add_f32 v136, v136, v138
    v_add_f32 v140, v140, v141
    v_add_f32 v142, v142, v143
    v_add_f32 v140, v140, v142
    v_cvt_pk_bf16_f32 v160, v128, v132
    v_cvt_pk_bf16_f32 v162, v136, v140
    s_cmp_lt_u32 s54, 28
    s_cbranch_scc1 k1_pubsa
    v_lshlrev_b32 v128, 16, v160
    v_and_b32 v132, 0xffff0000, v160
    v_lshlrev_b32 v136, 16, v162
    v_and_b32 v140, 0xffff0000, v162
    v_add_f32 v128, 1.0, v128
    v_add_f32 v132, 1.0, v132
    v_add_f32 v136, 1.0, v136
    v_add_f32 v140, 1.0, v140
    v_cvt_pk_bf16_f32 v160, v128, v132
    v_cvt_pk_bf16_f32 v162, v136, v140
k1_pubsa:
    buffer_store_dwordx4 v[160:163], v121, s[20:23], s46 offen sc1
k1_nomod:
    s_add_u32 m0, s48, 8192
    s_add_u32 s56, s30, 256
    buffer_load_dwordx4 v144, s[60:63], s56 offen  lds
    s_add_u32 m0, s48, 9216
    s_add_u32 s56, s30, 7424
    buffer_load_dwordx4 v145, s[60:63], s56 offen  lds
    s_add_u32 m0, s48, 10240
    s_add_u32 s56, s30, 14592
    buffer_load_dwordx4 v144, s[60:63], s56 offen  lds
    s_add_u32 m0, s48, 11264
    s_add_u32 s56, s30, 21760
    buffer_load_dwordx4 v145, s[60:63], s56 offen  lds
    s_add_u32 m0, s48, 12288
    s_add_u32 s56, s30, 384
    buffer_load_dwordx4 v144, s[60:63], s56 offen  lds
    s_add_u32 m0, s48, 13312
    s_add_u32 s56, s30, 7552
    buffer_load_dwordx4 v145, s[60:63], s56 offen  lds
    s_add_u32 m0, s48, 14336
    s_add_u32 s56, s30, 14720
    buffer_load_dwordx4 v144, s[60:63], s56 offen  lds
    s_add_u32 m0, s48, 15360
    s_add_u32 s56, s30, 21888
    buffer_load_dwordx4 v145, s[60:63], s56 offen  lds
    s_add_u32 m0, s48, 16384
    s_add_u32 s56, s30, 512
    buffer_load_dwordx4 v144, s[60:63], s56 offen  lds
    s_add_u32 m0, s48, 17408
    s_add_u32 s56, s30, 7680
    buffer_load_dwordx4 v145, s[60:63], s56 offen  lds
    s_add_u32 m0, s48, 18432
    s_add_u32 s56, s30, 14848
    buffer_load_dwordx4 v144, s[60:63], s56 offen  lds
    s_add_u32 m0, s48, 19456
    s_add_u32 s56, s30, 22016
    buffer_load_dwordx4 v145, s[60:63], s56 offen  lds
    s_add_u32 m0, s58, 20480
    s_add_u32 s56, s30, 640
    buffer_load_dwordx4 v144, s[60:63], s56 offen  lds
    s_add_u32 m0, s58, 21504
    s_add_u32 s56, s30, 7808
    buffer_load_dwordx4 v145, s[60:63], s56 offen  lds
    s_add_u32 m0, s58, 22528
    s_add_u32 s56, s30, 14976
    buffer_load_dwordx4 v144, s[60:63], s56 offen  lds
    s_add_u32 m0, s58, 23552
    s_add_u32 s56, s30, 22144
    buffer_load_dwordx4 v145, s[60:63], s56 offen  lds
    s_add_u32 m0, s58, 24576
    s_add_u32 s56, s30, 768
    buffer_load_dwordx4 v144, s[60:63], s56 offen  lds
    s_add_u32 m0, s58, 25600
    s_add_u32 s56, s30, 7936
    buffer_load_dwordx4 v145, s[60:63], s56 offen  lds
    s_add_u32 m0, s58, 26624
    s_add_u32 s56, s30, 15104
    buffer_load_dwordx4 v144, s[60:63], s56 offen  lds
    s_add_u32 m0, s58, 27648
    s_add_u32 s56, s30, 22272
    buffer_load_dwordx4 v145, s[60:63], s56 offen  lds
    v_lshrrev_b32 v154, 2, v248
    v_and_b32 v155, 3, v248
    v_lshlrev_b32 v156, 7, v154
    v_lshrrev_b32 v157, 1, v155
    v_lshl_add_u32 v156, v157, 6, v156
    v_and_b32 v157, 1, v155
    v_lshl_add_u32 v156, v157, 4, v156
    v_add_u32 v156, 159744, v156
    v_lshlrev_b32 v154, 7, v154
    v_lshl_add_u32 v154, v155, 4, v154
    s_and_b32 s40, s2, 7
    s_lshl_b32 s40, s40, 13
    s_add_u32 s40, s40, 1966080
    s_and_b32 s52, s34, 3
    s_cmp_eq_u32 s52, s24
    s_cselect_b32 s40, s40, 0x7ff00000
    s_add_u32 s41, s40, 3584
    v_bfe_u32 v249, v248, 2, 2
    v_mul_u32_u24 v226, 4160, v249
    v_lshrrev_b32 v250, 5, v248
    v_mul_u32_u24 v251, 1040, v250
    v_add_u32 v226, v226, v251
    v_lshlrev_b32 v228, 6, v250
    v_add_u32 v228, 159744, v228
    v_bfe_u32 v251, v248, 4, 1
    v_lshl_add_u32 v226, v251, 5, v226
    v_and_b32 v251, 1, v248
    v_lshl_add_u32 v226, v251, 4, v226
    v_bfe_u32 v251, v248, 1, 1
    v_lshl_add_u32 v226, v251, 3, v226
    v_add_u32 v227, 67584, v226
    s_lshr_b32 s46, s24, 1
    s_and_b32 s47, s24, 1
    s_lshl_b32 s36, s46, 14
    s_lshl_b32 s37, s47, 12
    s_add_u32 s37, s37, s36
    s_lshl_b32 s38, s47, 11
    s_add_u32 s38, s38, s36
    v_lshlrev_b32 v251, 11, v250
    v_and_b32 v246, 31, v248
    v_lshl_add_u32 v246, v246, 4, v251
    v_add_u32 v246, s37, v246
    v_lshrrev_b32 v250, 4, v248
    v_lshlrev_b32 v251, 12, v250
    v_and_b32 v247, 15, v248
    v_lshl_add_u32 v247, v247, 4, v251
    v_add_u32 v247, s38, v247
    s_mul_i32 s36, s47, 8448
    v_bfe_u32 v251, v248, 3, 1
    v_and_b32 v244, 3, v248
    v_lshl_add_u32 v244, v251, 2, v244
    v_mul_u32_u24 v244, 1056, v244
    v_bfe_u32 v251, v248, 2, 1
    v_lshl_add_u32 v244, v251, 9, v244
    v_lshl_add_u32 v244, v250, 4, v244
    v_add_u32 v244, s36, v244
    v_bfe_u32 v251, v248, 2, 3
    v_mul_u32_u24 v252, 1056, v251
    v_and_b32 v251, 3, v248
    v_lshl_add_u32 v252, v251, 3, v252
    v_lshrrev_b32 v251, 5, v248
    v_lshl_add_u32 v245, v251, 8, v252
    s_add_u32 s36, s36, 67584
    v_add_u32 v245, s36, v245
    v_lshl_add_u32 v252, v251, 7, v252
    s_lshl_b32 s36, s24, 5
    s_mul_i32 s36, s36, 544
    s_add_u32 s36, s36, 84480
    s_xor_b32 s37, s24, 1
    s_lshl_b32 s37, s37, 5
    s_mul_i32 s37, s37, 544
    s_add_u32 s37, s37, 84480
    v_and_b32 v253, 31, v248
    v_mul_u32_u24 v253, 544, v253
    v_lshl_add_u32 v253, v251, 4, v253
    v_add_u32 v253, s36, v253
    v_and_b32 v254, 15, v248
    v_mul_u32_u24 v254, 544, v254
    v_lshl_add_u32 v254, v250, 4, v254
    v_add_u32 v255, s37, v254
    v_add_u32 v254, s36, v254
    v_and_b32 v120, 31, v248
    v_bfe_u32 v121, v120, 1, 3
    v_lshrrev_b32 v122, 5, v248
    v_xor_b32 v121, v121, v122
    v_lshlrev_b32 v120, 7, v120
    v_xor_b32 v122, 0, v121
    v_lshl_add_u32 v122, v122, 4, v120
    v_add_u32 v146, s48, v122
    v_add_u32 v150, s58, v122
    v_xor_b32 v122, 2, v121
    v_lshl_add_u32 v122, v122, 4, v120
    v_add_u32 v147, s48, v122
    v_add_u32 v151, s58, v122
    v_xor_b32 v122, 4, v121
    v_lshl_add_u32 v122, v122, 4, v120
    v_add_u32 v148, s48, v122
    v_add_u32 v152, s58, v122
    v_xor_b32 v122, 6, v121
    v_lshl_add_u32 v122, v122, 4, v120
    v_add_u32 v149, s48, v122
    v_add_u32 v153, s58, v122
    s_mov_b32 s53, 0x3f803f80
    v_mov_b32 v112, 0
    v_mov_b32 v113, 0
    v_mov_b32 v114, 0
    v_mov_b32 v115, 0
    s_waitcnt vmcnt(24)
    ds_read_b128 v[0:3], v146 offset:0
    ds_read_b128 v[4:7], v147 offset:0
    ds_read_b128 v[8:11], v148 offset:0
    ds_read_b128 v[12:15], v149 offset:0
    v_readfirstlane_b32 s50, v124
    v_readfirstlane_b32 s49, v125
    s_nop 3
    s_add_u32 s50, s50, 1
    s_cselect_b32 s50, 1, s50
    s_cmp_eq_u32 s49, 0
    s_cselect_b32 s51, s50, s49
    s_lshl_b32 s46, s2, 2
    s_add_u32 s46, s46, s24
    s_cmp_lg_u32 s46, 1
    s_cbranch_scc1 k1_noann
    v_mov_b32 v120, s51
    s_mov_b64 exec, 1
    buffer_store_dword v120, off, s[76:79], 0 offset:4 sc1
    s_mov_b64 exec, -1
k1_noann:
    s_waitcnt vmcnt(20)
    ds_read_b128 v[16:19], v146 offset:4096
    ds_read_b128 v[20:23], v147 offset:4096
    ds_read_b128 v[24:27], v148 offset:4096
    ds_read_b128 v[28:31], v149 offset:4096
    s_waitcnt lgkmcnt(7)
    v_dot2_f32_bf16 v112, v0, s53, v112
    v_dot2_f32_bf16 v114, v0, v0, v114
    v_dot2_f32_bf16 v113, v1, s53, v113
    v_dot2_f32_bf16 v115, v1, v1, v115
    v_dot2_f32_bf16 v112, v2, s53, v112
    v_dot2_f32_bf16 v114, v2, v2, v114
    v_dot2_f32_bf16 v113, v3, s53, v113
    v_dot2_f32_bf16 v115, v3, v3, v115
    s_waitcnt lgkmcnt(6)
    v_dot2_f32_bf16 v112, v4, s53, v112
    v_dot2_f32_bf16 v114, v4, v4, v114
    v_dot2_f32_bf16 v113, v5, s53, v113
    v_dot2_f32_bf16 v115, v5, v5, v115
    v_dot2_f32_bf16 v112, v6, s53, v112
    v_dot2_f32_bf16 v114, v6, v6, v114
    v_dot2_f32_bf16 v113, v7, s53, v113
    v_dot2_f32_bf16 v115, v7, v7, v115
    s_waitcnt lgkmcnt(5)
    v_dot2_f32_bf16 v112, v8, s53, v112
    v_dot2_f32_bf16 v114, v8, v8, v114
    v_dot2_f32_bf16 v113, v9, s53, v113
    v_dot2_f32_bf16 v115, v9, v9, v115
    v_dot2_f32_bf16 v112, v10, s53, v112
    v_dot2_f32_bf16 v114, v10, v10, v114
    v_dot2_f32_bf16 v113, v11, s53, v113
    v_dot2_f32_bf16 v115, v11, v11, v115
    s_waitcnt lgkmcnt(4)
    v_dot2_f32_bf16 v112, v12, s53, v112
    v_dot2_f32_bf16 v114, v12, v12, v114
    v_dot2_f32_bf16 v113, v13, s53, v113
    v_dot2_f32_bf16 v115, v13, v13, v115
    v_dot2_f32_bf16 v112, v14, s53, v112
    v_dot2_f32_bf16 v114, v14, v14, v114
    v_dot2_f32_bf16 v113, v15, s53, v113
    v_dot2_f32_bf16 v115, v15, v15, v115
    s_waitcnt vmcnt(16)
    ds_read_b128 v[32:35], v146 offset:8192
    ds_read_b128 v[36:39], v147 offset:8192
    ds_read_b128 v[40:43], v148 offset:8192
    ds_read_b128 v[44:47], v149 offset:8192
    s_waitcnt lgkmcnt(7)
    v_dot2_f32_bf16 v112, v16, s53, v112
    v_dot2_f32_bf16 v114, v16, v16, v114
    v_dot2_f32_bf16 v113, v17, s53, v113
    v_dot2_f32_bf16 v115, v17, v17, v115
    v_dot2_f32_bf16 v112, v18, s53, v112
    v_dot2_f32_bf16 v114, v18, v18, v114
    v_dot2_f32_bf16 v113, v19, s53, v113
    v_dot2_f32_bf16 v115, v19, v19, v115
    s_waitcnt lgkmcnt(6)
    v_dot2_f32_bf16 v112, v20, s53, v112
    v_dot2_f32_bf16 v114, v20, v20, v114
    v_dot2_f32_bf16 v113, v21, s53, v113
    v_dot2_f32_bf16 v115, v21, v21, v115
    v_dot2_f32_bf16 v112, v22, s53, v112
    v_dot2_f32_bf16 v114, v22, v22, v114
    v_dot2_f32_bf16 v113, v23, s53, v113
    v_dot2_f32_bf16 v115, v23, v23, v115
    s_waitcnt lgkmcnt(5)
    v_dot2_f32_bf16 v112, v24, s53, v112
    v_dot2_f32_bf16 v114, v24, v24, v114
    v_dot2_f32_bf16 v113, v25, s53, v113
    v_dot2_f32_bf16 v115, v25, v25, v115
    v_dot2_f32_bf16 v112, v26, s53, v112
    v_dot2_f32_bf16 v114, v26, v26, v114
    v_dot2_f32_bf16 v113, v27, s53, v113
    v_dot2_f32_bf16 v115, v27, v27, v115
    s_waitcnt lgkmcnt(4)
    v_dot2_f32_bf16 v112, v28, s53, v112
    v_dot2_f32_bf16 v114, v28, v28, v114
    v_dot2_f32_bf16 v113, v29, s53, v113
    v_dot2_f32_bf16 v115, v29, v29, v115
    v_dot2_f32_bf16 v112, v30, s53, v112
    v_dot2_f32_bf16 v114, v30, v30, v114
    v_dot2_f32_bf16 v113, v31, s53, v113
    v_dot2_f32_bf16 v115, v31, v31, v115
    s_waitcnt vmcnt(12)
    ds_read_b128 v[48:51], v146 offset:12288
    ds_read_b128 v[52:55], v147 offset:12288
    ds_read_b128 v[56:59], v148 offset:12288
    ds_read_b128 v[60:63], v149 offset:12288
    s_waitcnt lgkmcnt(7)
    v_dot2_f32_bf16 v112, v32, s53, v112
    v_dot2_f32_bf16 v114, v32, v32, v114
    v_dot2_f32_bf16 v113, v33, s53, v113
    v_dot2_f32_bf16 v115, v33, v33, v115
    v_dot2_f32_bf16 v112, v34, s53, v112
    v_dot2_f32_bf16 v114, v34, v34, v114
    v_dot2_f32_bf16 v113, v35, s53, v113
    v_dot2_f32_bf16 v115, v35, v35, v115
    s_waitcnt lgkmcnt(6)
    v_dot2_f32_bf16 v112, v36, s53, v112
    v_dot2_f32_bf16 v114, v36, v36, v114
    v_dot2_f32_bf16 v113, v37, s53, v113
    v_dot2_f32_bf16 v115, v37, v37, v115
    v_dot2_f32_bf16 v112, v38, s53, v112
    v_dot2_f32_bf16 v114, v38, v38, v114
    v_dot2_f32_bf16 v113, v39, s53, v113
    v_dot2_f32_bf16 v115, v39, v39, v115
    s_waitcnt lgkmcnt(5)
    v_dot2_f32_bf16 v112, v40, s53, v112
    v_dot2_f32_bf16 v114, v40, v40, v114
    v_dot2_f32_bf16 v113, v41, s53, v113
    v_dot2_f32_bf16 v115, v41, v41, v115
    v_dot2_f32_bf16 v112, v42, s53, v112
    v_dot2_f32_bf16 v114, v42, v42, v114
    v_dot2_f32_bf16 v113, v43, s53, v113
    v_dot2_f32_bf16 v115, v43, v43, v115
    s_waitcnt lgkmcnt(4)
    v_dot2_f32_bf16 v112, v44, s53, v112
    v_dot2_f32_bf16 v114, v44, v44, v114
    v_dot2_f32_bf16 v113, v45, s53, v113
    v_dot2_f32_bf16 v115, v45, v45, v115
    v_dot2_f32_bf16 v112, v46, s53, v112
    v_dot2_f32_bf16 v114, v46, v46, v114
    v_dot2_f32_bf16 v113, v47, s53, v113
    v_dot2_f32_bf16 v115, v47, v47, v115
    buffer_load_dwordx4 v[128:131], v154, s[20:23], s40 offen offset:0 sc1
    buffer_load_dwordx4 v[132:135], v154, s[20:23], s40 offen offset:1792 sc1
    buffer_load_dwordx4 v[136:139], v154, s[20:23], s41 offen offset:0 sc1
    buffer_load_dwordx4 v[140:143], v154, s[20:23], s41 offen offset:1792 sc1
    s_add_u32 m0, s26, 50688
    s_mov_b32 s32, 0
    buffer_load_dwordx4 v225, s[12:15], s32 offen offset:0  lds
    s_mov_b32 s32, 64496
    buffer_load_dwordx4 v225, s[12:15], s32 offen offset:1040  lds
    s_mov_b32 s32, 128992
    buffer_load_dwordx4 v225, s[12:15], s32 offen offset:2080  lds
    s_mov_b32 s32, 193488
    buffer_load_dwordx4 v225, s[12:15], s32 offen offset:3120  lds
    s_add_u32 m0, s26, 67584
    s_mov_b32 s32, 262144
    buffer_load_dwordx4 v225, s[12:15], s32 offen offset:0  lds
    s_mov_b32 s32, 326640
    buffer_load_dwordx4 v225, s[12:15], s32 offen offset:1040  lds
    s_mov_b32 s32, 391136
    buffer_load_dwordx4 v225, s[12:15], s32 offen offset:2080  lds
    s_mov_b32 s32, 455632
    buffer_load_dwordx4 v225, s[12:15], s32 offen offset:3120  lds
    s_waitcnt vmcnt(20)
    ds_read_b128 v[64:67], v146 offset:16384
    ds_read_b128 v[68:71], v147 offset:16384
    ds_read_b128 v[72:75], v148 offset:16384
    ds_read_b128 v[76:79], v149 offset:16384
    s_waitcnt lgkmcnt(7)
    v_dot2_f32_bf16 v112, v48, s53, v112
    v_dot2_f32_bf16 v114, v48, v48, v114
    v_dot2_f32_bf16 v113, v49, s53, v113
    v_dot2_f32_bf16 v115, v49, v49, v115
    v_dot2_f32_bf16 v112, v50, s53, v112
    v_dot2_f32_bf16 v114, v50, v50, v114
    v_dot2_f32_bf16 v113, v51, s53, v113
    v_dot2_f32_bf16 v115, v51, v51, v115
    s_waitcnt lgkmcnt(6)
    v_dot2_f32_bf16 v112, v52, s53, v112
    v_dot2_f32_bf16 v114, v52, v52, v114
    v_dot2_f32_bf16 v113, v53, s53, v113
    v_dot2_f32_bf16 v115, v53, v53, v115
    v_dot2_f32_bf16 v112, v54, s53, v112
    v_dot2_f32_bf16 v114, v54, v54, v114
    v_dot2_f32_bf16 v113, v55, s53, v113
    v_dot2_f32_bf16 v115, v55, v55, v115
    s_waitcnt lgkmcnt(5)
    v_dot2_f32_bf16 v112, v56, s53, v112
    v_dot2_f32_bf16 v114, v56, v56, v114
    v_dot2_f32_bf16 v113, v57, s53, v113
    v_dot2_f32_bf16 v115, v57, v57, v115
    v_dot2_f32_bf16 v112, v58, s53, v112
    v_dot2_f32_bf16 v114, v58, v58, v114
    v_dot2_f32_bf16 v113, v59, s53, v113
    v_dot2_f32_bf16 v115, v59, v59, v115
    s_waitcnt lgkmcnt(4)
    v_dot2_f32_bf16 v112, v60, s53, v112
    v_dot2_f32_bf16 v114, v60, v60, v114
    v_dot2_f32_bf16 v113, v61, s53, v113
    v_dot2_f32_bf16 v115, v61, v61, v115
    v_dot2_f32_bf16 v112, v62, s53, v112
    v_dot2_f32_bf16 v114, v62, v62, v114
    v_dot2_f32_bf16 v113, v63, s53, v113
    v_dot2_f32_bf16 v115, v63, v63, v115
    s_waitcnt vmcnt(16)
    ds_read_b128 v[80:83], v150 offset:20480
    ds_read_b128 v[84:87], v151 offset:20480
    ds_read_b128 v[88:91], v152 offset:20480
    ds_read_b128 v[92:95], v153 offset:20480
    s_waitcnt lgkmcnt(7)
    v_dot2_f32_bf16 v112, v64, s53, v112
    v_dot2_f32_bf16 v114, v64, v64, v114
    v_dot2_f32_bf16 v113, v65, s53, v113
    v_dot2_f32_bf16 v115, v65, v65, v115
    v_dot2_f32_bf16 v112, v66, s53, v112
    v_dot2_f32_bf16 v114, v66, v66, v114
    v_dot2_f32_bf16 v113, v67, s53, v113
    v_dot2_f32_bf16 v115, v67, v67, v115
    s_waitcnt lgkmcnt(6)
    v_dot2_f32_bf16 v112, v68, s53, v112
    v_dot2_f32_bf16 v114, v68, v68, v114
    v_dot2_f32_bf16 v113, v69, s53, v113
    v_dot2_f32_bf16 v115, v69, v69, v115
    v_dot2_f32_bf16 v112, v70, s53, v112
    v_dot2_f32_bf16 v114, v70, v70, v114
    v_dot2_f32_bf16 v113, v71, s53, v113
    v_dot2_f32_bf16 v115, v71, v71, v115
    s_waitcnt lgkmcnt(5)
    v_dot2_f32_bf16 v112, v72, s53, v112
    v_dot2_f32_bf16 v114, v72, v72, v114
    v_dot2_f32_bf16 v113, v73, s53, v113
    v_dot2_f32_bf16 v115, v73, v73, v115
    v_dot2_f32_bf16 v112, v74, s53, v112
    v_dot2_f32_bf16 v114, v74, v74, v114
    v_dot2_f32_bf16 v113, v75, s53, v113
    v_dot2_f32_bf16 v115, v75, v75, v115
    s_waitcnt lgkmcnt(4)
    v_dot2_f32_bf16 v112, v76, s53, v112
    v_dot2_f32_bf16 v114, v76, v76, v114
    v_dot2_f32_bf16 v113, v77, s53, v113
    v_dot2_f32_bf16 v115, v77, v77, v115
    v_dot2_f32_bf16 v112, v78, s53, v112
    v_dot2_f32_bf16 v114, v78, v78, v114
    v_dot2_f32_bf16 v113, v79, s53, v113
    v_dot2_f32_bf16 v115, v79, v79, v115
    s_waitcnt vmcnt(12)
    ds_read_b128 v[96:99], v150 offset:24576
    ds_read_b128 v[100:103], v151 offset:24576
    ds_read_b128 v[104:107], v152 offset:24576
    ds_read_b128 v[108:111], v153 offset:24576
    s_waitcnt lgkmcnt(7)
    v_dot2_f32_bf16 v112, v80, s53, v112
    v_dot2_f32_bf16 v114, v80, v80, v114
    v_dot2_f32_bf16 v113, v81, s53, v113
    v_dot2_f32_bf16 v115, v81, v81, v115
    v_dot2_f32_bf16 v112, v82, s53, v112
    v_dot2_f32_bf16 v114, v82, v82, v114
    v_dot2_f32_bf16 v113, v83, s53, v113
    v_dot2_f32_bf16 v115, v83, v83, v115
    s_waitcnt lgkmcnt(6)
    v_dot2_f32_bf16 v112, v84, s53, v112
    v_dot2_f32_bf16 v114, v84, v84, v114
    v_dot2_f32_bf16 v113, v85, s53, v113
    v_dot2_f32_bf16 v115, v85, v85, v115
    v_dot2_f32_bf16 v112, v86, s53, v112
    v_dot2_f32_bf16 v114, v86, v86, v114
    v_dot2_f32_bf16 v113, v87, s53, v113
    v_dot2_f32_bf16 v115, v87, v87, v115
    s_waitcnt lgkmcnt(5)
    v_dot2_f32_bf16 v112, v88, s53, v112
    v_dot2_f32_bf16 v114, v88, v88, v114
    v_dot2_f32_bf16 v113, v89, s53, v113
    v_dot2_f32_bf16 v115, v89, v89, v115
    v_dot2_f32_bf16 v112, v90, s53, v112
    v_dot2_f32_bf16 v114, v90, v90, v114
    v_dot2_f32_bf16 v113, v91, s53, v113
    v_dot2_f32_bf16 v115, v91, v91, v115
    s_waitcnt lgkmcnt(4)
    v_dot2_f32_bf16 v112, v92, s53, v112
    v_dot2_f32_bf16 v114, v92, v92, v114
    v_dot2_f32_bf16 v113, v93, s53, v113
    v_dot2_f32_bf16 v115, v93, v93, v115
    v_dot2_f32_bf16 v112, v94, s53, v112
    v_dot2_f32_bf16 v114, v94, v94, v114
    v_dot2_f32_bf16 v113, v95, s53, v113
    v_dot2_f32_bf16 v115, v95, v95, v115
    s_waitcnt lgkmcnt(3)
    v_dot2_f32_bf16 v112, v96, s53, v112
    v_dot2_f32_bf16 v114, v96, v96, v114
    v_dot2_f32_bf16 v113, v97, s53, v113
    v_dot2_f32_bf16 v115, v97, v97, v115
    v_dot2_f32_bf16 v112, v98, s53, v112
    v_dot2_f32_bf16 v114, v98, v98, v114
    v_dot2_f32_bf16 v113, v99, s53, v113
    v_dot2_f32_bf16 v115, v99, v99, v115
    s_waitcnt lgkmcnt(2)
    v_dot2_f32_bf16 v112, v100, s53, v112
    v_dot2_f32_bf16 v114, v100, v100, v114
    v_dot2_f32_bf16 v113, v101, s53, v113
    v_dot2_f32_bf16 v115, v101, v101, v115
    v_dot2_f32_bf16 v112, v102, s53, v112
    v_dot2_f32_bf16 v114, v102, v102, v114
    v_dot2_f32_bf16 v113, v103, s53, v113
    v_dot2_f32_bf16 v115, v103, v103, v115
    s_waitcnt lgkmcnt(1)
    v_dot2_f32_bf16 v112, v104, s53, v112
    v_dot2_f32_bf16 v114, v104, v104, v114
    v_dot2_f32_bf16 v113, v105, s53, v113
    v_dot2_f32_bf16 v115, v105, v105, v115
    v_dot2_f32_bf16 v112, v106, s53, v112
    v_dot2_f32_bf16 v114, v106, v106, v114
    v_dot2_f32_bf16 v113, v107, s53, v113
    v_dot2_f32_bf16 v115, v107, v107, v115
    s_waitcnt lgkmcnt(0)
    v_dot2_f32_bf16 v112, v108, s53, v112
    v_dot2_f32_bf16 v114, v108, v108, v114
    v_dot2_f32_bf16 v113, v109, s53, v113
    v_dot2_f32_bf16 v115, v109, v109, v115
    v_dot2_f32_bf16 v112, v110, s53, v112
    v_dot2_f32_bf16 v114, v110, v110, v114
    v_dot2_f32_bf16 v113, v111, s53, v113
    v_dot2_f32_bf16 v115, v111, v111, v115
    s_barrier
    s_cmp_eq_u32 s52, s24
    s_cbranch_scc1 k1_skipwq
    s_add_u32 m0, s26, 33792
    s_mov_b32 s32, 524288
    buffer_load_dwordx4 v225, s[12:15], s32 offen offset:0  lds
    s_mov_b32 s32, 588784
    buffer_load_dwordx4 v225, s[12:15], s32 offen offset:1040  lds
    s_mov_b32 s32, 653280
    buffer_load_dwordx4 v225, s[12:15], s32 offen offset:2080  lds
    s_mov_b32 s32, 717776
    buffer_load_dwordx4 v225, s[12:15], s32 offen offset:3120  lds
    s_add_u32 m0, s26, 84480
    s_mov_b32 s32, 786432
    buffer_load_dwordx4 v225, s[12:15], s32 offen offset:0  lds
    s_mov_b32 s32, 850928
    buffer_load_dwordx4 v225, s[12:15], s32 offen offset:1040  lds
    s_mov_b32 s32, 915424
    buffer_load_dwordx4 v225, s[12:15], s32 offen offset:2080  lds
    s_mov_b32 s32, 979920
    buffer_load_dwordx4 v225, s[12:15], s32 offen offset:3120  lds
    s_add_u32 m0, s26, 101376
    s_mov_b32 s32, 1048576
    buffer_load_dwordx4 v225, s[12:15], s32 offen offset:0  lds
    s_mov_b32 s32, 1113072
    buffer_load_dwordx4 v225, s[12:15], s32 offen offset:1040  lds
    s_mov_b32 s32, 1177568
    buffer_load_dwordx4 v225, s[12:15], s32 offen offset:2080  lds
    s_mov_b32 s32, 1242064
    buffer_load_dwordx4 v225, s[12:15], s32 offen offset:3120  lds
k1_skipwq:
    v_add_f32 v112, v112, v113
    v_add_f32 v114, v114, v115
    v_mov_b32 v113, v112
    v_mov_b32 v115, v114
    s_nop 1
    v_permlane32_swap_b32 v112, v113
    v_permlane32_swap_b32 v114, v115
    v_add_f32 v112, v112, v113
    v_add_f32 v114, v114, v115
    v_mul_f32 v112, 991054117, v112
    v_mul_f32 v114, 991054117, v114
    v_mul_f32 v113, v112, v112
    v_sub_f32 v114, v114, v113
    v_mul_f32 v115, 1132462080, v114
    v_cmp_nle_f32 vcc, v113, v115
    s_cbranch_vccnz k1_slowln
k1_lnok:
    v_add_f32 v114, 925353388, v114
    v_rsq_f32 v237, v114
    s_nop 0
    v_mul_f32 v238, v112, v237
    v_sub_f32 v238, 0, v238
    v_lshlrev_b32 v116, 16, v0
    v_and_b32 v117, 0xffff0000, v0
    v_fma_f32 v116, v116, v237, v238
    v_fma_f32 v117, v117, v237, v238
    v_cvt_pk_f16_f32 v0, v116, v117
    v_lshlrev_b32 v118, 16, v1
    v_and_b32 v119, 0xffff0000, v1
    v_fma_f32 v118, v118, v237, v238
    v_fma_f32 v119, v119, v237, v238
    v_cvt_pk_f16_f32 v1, v118, v119
    v_lshlrev_b32 v116, 16, v2
    v_and_b32 v117, 0xffff0000, v2
    v_fma_f32 v116, v116, v237, v238
    v_fma_f32 v117, v117, v237, v238
    v_cvt_pk_f16_f32 v2, v116, v117
    v_lshlrev_b32 v118, 16, v3
    v_and_b32 v119, 0xffff0000, v3
    v_fma_f32 v118, v118, v237, v238
    v_fma_f32 v119, v119, v237, v238
    v_cvt_pk_f16_f32 v3, v118, v119
    v_lshlrev_b32 v116, 16, v4
    v_and_b32 v117, 0xffff0000, v4
    v_fma_f32 v116, v116, v237, v238
    v_fma_f32 v117, v117, v237, v238
    v_cvt_pk_f16_f32 v4, v116, v117
    v_lshlrev_b32 v118, 16, v5
    v_and_b32 v119, 0xffff0000, v5
    v_fma_f32 v118, v118, v237, v238
    v_fma_f32 v119, v119, v237, v238
    v_cvt_pk_f16_f32 v5, v118, v119
    v_lshlrev_b32 v116, 16, v6
    v_and_b32 v117, 0xffff0000, v6
    v_fma_f32 v116, v116, v237, v238
    v_fma_f32 v117, v117, v237, v238
    v_cvt_pk_f16_f32 v6, v116, v117
    v_lshlrev_b32 v118, 16, v7
    v_and_b32 v119, 0xffff0000, v7
    v_fma_f32 v118, v118, v237, v238
    v_fma_f32 v119, v119, v237, v238
    v_cvt_pk_f16_f32 v7, v118, v119
    s_cmp_eq_u32 s52, s24
    s_cbranch_scc1 k1_pl2
k1_pl2r:
    s_waitcnt vmcnt(12) lgkmcnt(0)
    s_barrier
    ds_read_b128 v[176:179], v228 offset:0
    ds_read_b128 v[180:183], v228 offset:16
    ds_read_b128 v[184:187], v228 offset:32
    ds_read_b128 v[188:191], v228 offset:48
    ds_read_b128 v[192:195], v228 offset:128
    ds_read_b128 v[196:199], v228 offset:144
    ds_read_b128 v[200:203], v228 offset:160
    ds_read_b128 v[204:207], v228 offset:176
    ds_read_b64_tr_b16 a[0:1], v226 offset:50688
    ds_read_b64_tr_b16 a[2:3], v226 offset:51200
    ds_read_b64_tr_b16 a[4:5], v226 offset:50752
    ds_read_b64_tr_b16 a[6:7], v226 offset:51264
    ds_read_b64_tr_b16 a[8:9], v226 offset:50816
    ds_read_b64_tr_b16 a[10:11], v226 offset:51328
    ds_read_b64_tr_b16 a[12:13], v226 offset:50880
    ds_read_b64_tr_b16 a[14:15], v226 offset:51392
    s_waitcnt lgkmcnt(13)
    v_fma_mix_f32 v208, v0, v176, v184 op_sel:[0,0,0] op_sel_hi:[1,0,0]
    v_fma_mix_f32 v209, v0, v177, v185 op_sel:[1,0,0] op_sel_hi:[1,0,0]
    v_fma_mix_f32 v210, v1, v178, v186 op_sel:[0,0,0] op_sel_hi:[1,0,0]
    v_fma_mix_f32 v211, v1, v179, v187 op_sel:[1,0,0] op_sel_hi:[1,0,0]
    v_cvt_pk_bf16_f32 v216, v208, v209
    s_waitcnt lgkmcnt(12)
    v_fma_mix_f32 v212, v2, v180, v188 op_sel:[0,0,0] op_sel_hi:[1,0,0]
    v_fma_mix_f32 v213, v2, v181, v189 op_sel:[1,0,0] op_sel_hi:[1,0,0]
    v_cvt_pk_bf16_f32 v217, v210, v211
    v_fma_mix_f32 v214, v3, v182, v190 op_sel:[0,0,0] op_sel_hi:[1,0,0]
    v_fma_mix_f32 v215, v3, v183, v191 op_sel:[1,0,0] op_sel_hi:[1,0,0]
    v_cvt_pk_bf16_f32 v218, v212, v213
    v_cvt_pk_bf16_f32 v219, v214, v215
    s_nop 0
    s_waitcnt lgkmcnt(6)
    v_mfma_f32_32x32x16_bf16 v[112:127], a[0:3], v[216:219], 0
    s_waitcnt lgkmcnt(4)
    s_add_u32 m0, s26, 118272
    s_mov_b32 s32, 1310720
    ds_read_b64_tr_b16 a[16:17], v226 offset:50944
    ds_read_b64_tr_b16 a[18:19], v226 offset:51456
    ds_read_b128 v[176:179], v228 offset:256
    v_fma_mix_f32 v208, v4, v192, v200 op_sel:[0,0,0] op_sel_hi:[1,0,0]
    v_fma_mix_f32 v209, v4, v193, v201 op_sel:[1,0,0] op_sel_hi:[1,0,0]
    v_mfma_f32_32x32x16_bf16 v[128:143], a[4:7], v[216:219], 0
    s_waitcnt lgkmcnt(5)
    ds_read_b64_tr_b16 a[20:21], v226 offset:51008
    ds_read_b64_tr_b16 a[22:23], v226 offset:51520
    buffer_load_dwordx4 v225, s[12:15], s32 offen offset:0  lds
    v_fma_mix_f32 v210, v5, v194, v202 op_sel:[0,0,0] op_sel_hi:[1,0,0]
    v_mfma_f32_32x32x16_bf16 v[144:159], a[8:11], v[216:219], 0
    s_waitcnt lgkmcnt(5)
    s_mov_b32 s32, 1375216
    ds_read_b64_tr_b16 a[24:25], v226 offset:51072
    ds_read_b64_tr_b16 a[26:27], v226 offset:51584
    ds_read_b128 v[180:183], v228 offset:272
    v_fma_mix_f32 v211, v5, v195, v203 op_sel:[1,0,0] op_sel_hi:[1,0,0]
    v_cvt_pk_bf16_f32 v220, v208, v209
    v_mfma_f32_32x32x16_bf16 v[160:175], a[12:15], v[216:219], 0
    s_waitcnt lgkmcnt(6)
    ds_read_b64_tr_b16 a[28:29], v226 offset:51136
    ds_read_b64_tr_b16 a[30:31], v226 offset:51648
    buffer_load_dwordx4 v225, s[12:15], s32 offen offset:1040  lds
    v_fma_mix_f32 v212, v6, v196, v204 op_sel:[0,0,0] op_sel_hi:[1,0,0]
    v_mfma_f32_32x32x16_bf16 a[192:207], a[16:19], v[216:219], 0
    s_waitcnt lgkmcnt(5)
    s_mov_b32 s32, 1439712
    ds_read_b64_tr_b16 a[0:1], v226 offset:52768
    ds_read_b64_tr_b16 a[2:3], v226 offset:53280
    ds_read_b128 v[184:187], v228 offset:288
    v_fma_mix_f32 v213, v6, v197, v205 op_sel:[1,0,0] op_sel_hi:[1,0,0]
    v_cvt_pk_bf16_f32 v221, v210, v211
    v_mfma_f32_32x32x16_bf16 a[208:223], a[20:23], v[216:219], 0
    s_waitcnt lgkmcnt(6)
    ds_read_b64_tr_b16 a[4:5], v226 offset:52832
    ds_read_b64_tr_b16 a[6:7], v226 offset:53344
    buffer_load_dwordx4 v225, s[12:15], s32 offen offset:2080  lds
    v_fma_mix_f32 v214, v7, v198, v206 op_sel:[0,0,0] op_sel_hi:[1,0,0]
    v_fma_mix_f32 v215, v7, v199, v207 op_sel:[1,0,0] op_sel_hi:[1,0,0]
    v_mfma_f32_32x32x16_bf16 a[224:239], a[24:27], v[216:219], 0
    s_waitcnt lgkmcnt(5)
    ds_read_b64_tr_b16 a[8:9], v226 offset:52896
    ds_read_b64_tr_b16 a[10:11], v226 offset:53408
    ds_read_b128 v[188:191], v228 offset:304
    v_cvt_pk_bf16_f32 v222, v212, v213
    v_cvt_pk_bf16_f32 v223, v214, v215
    v_mfma_f32_32x32x16_bf16 a[240:255], a[28:31], v[216:219], 0
    s_waitcnt lgkmcnt(6)
    ds_read_b64_tr_b16 a[12:13], v226 offset:52960
    ds_read_b64_tr_b16 a[14:15], v226 offset:53472
    v_lshlrev_b32 v208, 16, v8
    v_and_b32 v209, 0xffff0000, v8
    v_lshlrev_b32 v210, 16, v9
    v_and_b32 v211, 0xffff0000, v9
    v_mfma_f32_32x32x16_bf16 v[112:127], a[0:3], v[220:223], v[112:127]
    s_waitcnt lgkmcnt(5)
    s_mov_b32 s32, 1504208
    ds_read_b64_tr_b16 a[16:17], v226 offset:53024
    ds_read_b64_tr_b16 a[18:19], v226 offset:53536
    ds_read_b128 v[192:195], v228 offset:384
    v_fma_f32 v208, v208, v237, v238
    v_fma_f32 v209, v209, v237, v238
    v_fma_f32 v210, v210, v237, v238
    v_fma_f32 v211, v211, v237, v238
    v_mfma_f32_32x32x16_bf16 v[128:143], a[4:7], v[220:223], v[128:143]
    s_waitcnt lgkmcnt(6)
    ds_read_b64_tr_b16 a[20:21], v226 offset:53088
    ds_read_b64_tr_b16 a[22:23], v226 offset:53600
    buffer_load_dwordx4 v225, s[12:15], s32 offen offset:3120  lds
    v_lshlrev_b32 v212, 16, v10
    v_and_b32 v213, 0xffff0000, v10
    v_lshlrev_b32 v214, 16, v11
    v_mfma_f32_32x32x16_bf16 v[144:159], a[8:11], v[220:223], v[144:159]
    s_waitcnt lgkmcnt(5)
    s_add_u32 m0, s26, 0
    s_mov_b32 s32, 1572864
    ds_read_b64_tr_b16 a[24:25], v226 offset:53152
    ds_read_b64_tr_b16 a[26:27], v226 offset:53664
    ds_read_b128 v[196:199], v228 offset:400
    v_and_b32 v215, 0xffff0000, v11
    v_fma_f32 v208, v208, v176, v184
    v_fma_f32 v209, v209, v177, v185
    v_mfma_f32_32x32x16_bf16 v[160:175], a[12:15], v[220:223], v[160:175]
    s_waitcnt lgkmcnt(6)
    ds_read_b64_tr_b16 a[28:29], v226 offset:53216
    ds_read_b64_tr_b16 a[30:31], v226 offset:53728
    buffer_load_dwordx4 v225, s[12:15], s32 offen offset:0  lds
    v_fma_f32 v210, v210, v178, v186
    v_fma_f32 v211, v211, v179, v187
    v_fma_f32 v212, v212, v237, v238
    v_fma_f32 v213, v213, v237, v238
    v_mfma_f32_32x32x16_bf16 a[192:207], a[16:19], v[220:223], a[192:207]
    s_waitcnt lgkmcnt(5)
    s_mov_b32 s32, 1637360
    ds_read_b64_tr_b16 a[0:1], v227 offset:0
    ds_read_b64_tr_b16 a[2:3], v227 offset:512
    ds_read_b128 v[200:203], v228 offset:416
    v_fma_f32 v214, v214, v237, v238
    v_fma_f32 v215, v215, v237, v238
    v_cvt_pk_bf16_f32 v216, v208, v209
    v_cvt_pk_bf16_f32 v217, v210, v211
    v_mfma_f32_32x32x16_bf16 a[208:223], a[20:23], v[220:223], a[208:223]
    s_waitcnt lgkmcnt(6)
    ds_read_b64_tr_b16 a[4:5], v227 offset:64
    ds_read_b64_tr_b16 a[6:7], v227 offset:576
    buffer_load_dwordx4 v225, s[12:15], s32 offen offset:1040  lds
    v_fma_f32 v212, v212, v180, v188
    v_fma_f32 v213, v213, v181, v189
    v_fma_f32 v214, v214, v182, v190
    v_mfma_f32_32x32x16_bf16 a[224:239], a[24:27], v[220:223], a[224:239]
    s_waitcnt lgkmcnt(5)
    ds_read_b64_tr_b16 a[8:9], v227 offset:128
    ds_read_b64_tr_b16 a[10:11], v227 offset:640
    ds_read_b128 v[204:207], v228 offset:432
    v_fma_f32 v215, v215, v183, v191
    v_cvt_pk_bf16_f32 v218, v212, v213
    v_cvt_pk_bf16_f32 v219, v214, v215
    v_mfma_f32_32x32x16_bf16 a[240:255], a[28:31], v[220:223], a[240:255]
    s_waitcnt lgkmcnt(6)
    ds_read_b64_tr_b16 a[12:13], v227 offset:192
    ds_read_b64_tr_b16 a[14:15], v227 offset:704
    v_lshlrev_b32 v208, 16, v12
    v_and_b32 v209, 0xffff0000, v12
    v_lshlrev_b32 v210, 16, v13
    v_and_b32 v211, 0xffff0000, v13
    v_mfma_f32_32x32x16_bf16 v[112:127], a[0:3], v[216:219], v[112:127]
    s_waitcnt lgkmcnt(5)
    s_mov_b32 s32, 1701856
    ds_read_b64_tr_b16 a[16:17], v227 offset:256
    ds_read_b64_tr_b16 a[18:19], v227 offset:768
    ds_read_b128 v[176:179], v228 offset:512
    v_fma_f32 v208, v208, v237, v238
    v_fma_f32 v209, v209, v237, v238
    v_fma_f32 v210, v210, v237, v238
    v_fma_f32 v211, v211, v237, v238
    v_mfma_f32_32x32x16_bf16 v[128:143], a[4:7], v[216:219], v[128:143]
    s_waitcnt lgkmcnt(6)
    ds_read_b64_tr_b16 a[20:21], v227 offset:320
    ds_read_b64_tr_b16 a[22:23], v227 offset:832
    buffer_load_dwordx4 v225, s[12:15], s32 offen offset:2080  lds
    v_lshlrev_b32 v212, 16, v14
    v_and_b32 v213, 0xffff0000, v14
    v_lshlrev_b32 v214, 16, v15
    v_mfma_f32_32x32x16_bf16 v[144:159], a[8:11], v[216:219], v[144:159]
    s_waitcnt lgkmcnt(5)
    ds_read_b64_tr_b16 a[24:25], v227 offset:384
    ds_read_b64_tr_b16 a[26:27], v227 offset:896
    ds_read_b128 v[180:183], v228 offset:528
    v_and_b32 v215, 0xffff0000, v15
    v_fma_f32 v208, v208, v192, v200
    v_fma_f32 v209, v209, v193, v201
    v_mfma_f32_32x32x16_bf16 v[160:175], a[12:15], v[216:219], v[160:175]
    s_waitcnt lgkmcnt(6)
    ds_read_b64_tr_b16 a[28:29], v227 offset:448
    ds_read_b64_tr_b16 a[30:31], v227 offset:960
    v_fma_f32 v210, v210, v194, v202
    v_fma_f32 v211, v211, v195, v203
    v_fma_f32 v212, v212, v237, v238
    v_fma_f32 v213, v213, v237, v238
    v_mfma_f32_32x32x16_bf16 a[192:207], a[16:19], v[216:219], a[192:207]
    s_waitcnt lgkmcnt(5)
    s_mov_b32 s32, 1766352
    ds_read_b64_tr_b16 a[0:1], v227 offset:2080
    ds_read_b64_tr_b16 a[2:3], v227 offset:2592
    ds_read_b128 v[184:187], v228 offset:544
    v_fma_f32 v214, v214, v237, v238
    v_fma_f32 v215, v215, v237, v238
    v_cvt_pk_bf16_f32 v220, v208, v209
    v_cvt_pk_bf16_f32 v221, v210, v211
    v_mfma_f32_32x32x16_bf16 a[208:223], a[20:23], v[216:219], a[208:223]
    s_waitcnt lgkmcnt(6)
    ds_read_b64_tr_b16 a[4:5], v227 offset:2144
    ds_read_b64_tr_b16 a[6:7], v227 offset:2656
    buffer_load_dwordx4 v225, s[12:15], s32 offen offset:3120  lds
    v_fma_f32 v212, v212, v196, v204
    v_fma_f32 v213, v213, v197, v205
    v_fma_f32 v214, v214, v198, v206
    v_mfma_f32_32x32x16_bf16 a[224:239], a[24:27], v[216:219], a[224:239]
    s_waitcnt lgkmcnt(5)
    ds_read_b64_tr_b16 a[8:9], v227 offset:2208
    ds_read_b64_tr_b16 a[10:11], v227 offset:2720
    ds_read_b128 v[188:191], v228 offset:560
    v_fma_f32 v215, v215, v199, v207
    v_cvt_pk_bf16_f32 v222, v212, v213
    v_cvt_pk_bf16_f32 v223, v214, v215
    v_mfma_f32_32x32x16_bf16 a[240:255], a[28:31], v[216:219], a[240:255]
    s_waitcnt lgkmcnt(6)
    ds_read_b64_tr_b16 a[12:13], v227 offset:2272
    ds_read_b64_tr_b16 a[14:15], v227 offset:2784
    v_lshlrev_b32 v208, 16, v16
    v_and_b32 v209, 0xffff0000, v16
    v_lshlrev_b32 v210, 16, v17
    v_and_b32 v211, 0xffff0000, v17
    v_mfma_f32_32x32x16_bf16 v[112:127], a[0:3], v[220:223], v[112:127]
    s_waitcnt lgkmcnt(5)
    s_add_u32 m0, s26, 16896
    s_mov_b32 s32, 1835008
    ds_read_b64_tr_b16 a[16:17], v227 offset:2336
    ds_read_b64_tr_b16 a[18:19], v227 offset:2848
    ds_read_b128 v[192:195], v228 offset:640
    v_fma_f32 v208, v208, v237, v238
    v_fma_f32 v209, v209, v237, v238
    v_fma_f32 v210, v210, v237, v238
    v_fma_f32 v211, v211, v237, v238
    v_mfma_f32_32x32x16_bf16 v[128:143], a[4:7], v[220:223], v[128:143]
    s_waitcnt lgkmcnt(6)
    ds_read_b64_tr_b16 a[20:21], v227 offset:2400
    ds_read_b64_tr_b16 a[22:23], v227 offset:2912
    buffer_load_dwordx4 v225, s[12:15], s32 offen offset:0  lds
    v_lshlrev_b32 v212, 16, v18
    v_and_b32 v213, 0xffff0000, v18
    v_lshlrev_b32 v214, 16, v19
    v_mfma_f32_32x32x16_bf16 v[144:159], a[8:11], v[220:223], v[144:159]
    s_waitcnt lgkmcnt(5)
    ds_read_b64_tr_b16 a[24:25], v227 offset:2464
    ds_read_b64_tr_b16 a[26:27], v227 offset:2976
    ds_read_b128 v[196:199], v228 offset:656
    v_and_b32 v215, 0xffff0000, v19
    v_fma_f32 v208, v208, v176, v184
    v_fma_f32 v209, v209, v177, v185
    v_mfma_f32_32x32x16_bf16 v[160:175], a[12:15], v[220:223], v[160:175]
    s_waitcnt vmcnt(13) lgkmcnt(6)
    s_barrier
    ds_read_b64_tr_b16 a[28:29], v227 offset:2528
    ds_read_b64_tr_b16 a[30:31], v227 offset:3040
    v_fma_f32 v210, v210, v178, v186
    v_fma_f32 v211, v211, v179, v187
    v_fma_f32 v212, v212, v237, v238
    v_fma_f32 v213, v213, v237, v238
    v_mfma_f32_32x32x16_bf16 a[192:207], a[16:19], v[220:223], a[192:207]
    s_waitcnt lgkmcnt(5)
    s_mov_b32 s32, 1899504
    ds_read_b64_tr_b16 a[0:1], v226 offset:33792
    ds_read_b64_tr_b16 a[2:3], v226 offset:34304
    ds_read_b128 v[200:203], v228 offset:672
    v_fma_f32 v214, v214, v237, v238
    v_fma_f32 v215, v215, v237, v238
    v_cvt_pk_bf16_f32 v216, v208, v209
    v_cvt_pk_bf16_f32 v217, v210, v211
    v_mfma_f32_32x32x16_bf16 a[208:223], a[20:23], v[220:223], a[208:223]
    s_waitcnt lgkmcnt(6)
    ds_read_b64_tr_b16 a[4:5], v226 offset:33856
    ds_read_b64_tr_b16 a[6:7], v226 offset:34368
    buffer_load_dwordx4 v225, s[12:15], s32 offen offset:1040  lds
    v_fma_f32 v212, v212, v180, v188
    v_fma_f32 v213, v213, v181, v189
    v_fma_f32 v214, v214, v182, v190
    v_mfma_f32_32x32x16_bf16 a[224:239], a[24:27], v[220:223], a[224:239]
    s_waitcnt lgkmcnt(5)
    ds_read_b64_tr_b16 a[8:9], v226 offset:33920
    ds_read_b64_tr_b16 a[10:11], v226 offset:34432
    ds_read_b128 v[204:207], v228 offset:688
    v_fma_f32 v215, v215, v183, v191
    v_cvt_pk_bf16_f32 v218, v212, v213
    v_cvt_pk_bf16_f32 v219, v214, v215
    v_mfma_f32_32x32x16_bf16 a[240:255], a[28:31], v[220:223], a[240:255]
    s_waitcnt lgkmcnt(6)
    ds_read_b64_tr_b16 a[12:13], v226 offset:33984
    ds_read_b64_tr_b16 a[14:15], v226 offset:34496
    v_lshlrev_b32 v208, 16, v20
    v_and_b32 v209, 0xffff0000, v20
    v_lshlrev_b32 v210, 16, v21
    v_and_b32 v211, 0xffff0000, v21
    v_mfma_f32_32x32x16_bf16 v[112:127], a[0:3], v[216:219], v[112:127]
    s_waitcnt lgkmcnt(5)
    s_mov_b32 s32, 1964000
    ds_read_b64_tr_b16 a[16:17], v226 offset:34048
    ds_read_b64_tr_b16 a[18:19], v226 offset:34560
    ds_read_b128 v[176:179], v228 offset:768
    v_fma_f32 v208, v208, v237, v238
    v_fma_f32 v209, v209, v237, v238
    v_fma_f32 v210, v210, v237, v238
    v_fma_f32 v211, v211, v237, v238
    v_mfma_f32_32x32x16_bf16 v[128:143], a[4:7], v[216:219], v[128:143]
    s_waitcnt lgkmcnt(6)
    ds_read_b64_tr_b16 a[20:21], v226 offset:34112
    ds_read_b64_tr_b16 a[22:23], v226 offset:34624
    buffer_load_dwordx4 v225, s[12:15], s32 offen offset:2080  lds
    v_lshlrev_b32 v212, 16, v22
    v_and_b32 v213, 0xffff0000, v22
    v_lshlrev_b32 v214, 16, v23
    v_mfma_f32_32x32x16_bf16 v[144:159], a[8:11], v[216:219], v[144:159]
    s_waitcnt lgkmcnt(5)
    ds_read_b64_tr_b16 a[24:25], v226 offset:34176
    ds_read_b64_tr_b16 a[26:27], v226 offset:34688
    ds_read_b128 v[180:183], v228 offset:784
    v_and_b32 v215, 0xffff0000, v23
    v_fma_f32 v208, v208, v192, v200
    v_fma_f32 v209, v209, v193, v201
    v_mfma_f32_32x32x16_bf16 v[160:175], a[12:15], v[216:219], v[160:175]
    s_waitcnt lgkmcnt(6)
    ds_read_b64_tr_b16 a[28:29], v226 offset:34240
    ds_read_b64_tr_b16 a[30:31], v226 offset:34752
    v_fma_f32 v210, v210, v194, v202
    v_fma_f32 v211, v211, v195, v203
    v_fma_f32 v212, v212, v237, v238
    v_fma_f32 v213, v213, v237, v238
    v_mfma_f32_32x32x16_bf16 a[192:207], a[16:19], v[216:219], a[192:207]
    s_waitcnt lgkmcnt(5)
    s_mov_b32 s32, 2028496
    ds_read_b64_tr_b16 a[0:1], v226 offset:35872
    ds_read_b64_tr_b16 a[2:3], v226 offset:36384
    ds_read_b128 v[184:187], v228 offset:800
    v_fma_f32 v214, v214, v237, v238
    v_fma_f32 v215, v215, v237, v238
    v_cvt_pk_bf16_f32 v220, v208, v209
    v_cvt_pk_bf16_f32 v221, v210, v211
    v_mfma_f32_32x32x16_bf16 a[208:223], a[20:23], v[216:219], a[208:223]
    s_waitcnt lgkmcnt(6)
    ds_read_b64_tr_b16 a[4:5], v226 offset:35936
    ds_read_b64_tr_b16 a[6:7], v226 offset:36448
    buffer_load_dwordx4 v225, s[12:15], s32 offen offset:3120  lds
    v_fma_f32 v212, v212, v196, v204
    v_fma_f32 v213, v213, v197, v205
    v_fma_f32 v214, v214, v198, v206
    v_mfma_f32_32x32x16_bf16 a[224:239], a[24:27], v[216:219], a[224:239]
    s_waitcnt lgkmcnt(5)
    ds_read_b64_tr_b16 a[8:9], v226 offset:36000
    ds_read_b64_tr_b16 a[10:11], v226 offset:36512
    ds_read_b128 v[188:191], v228 offset:816
    v_fma_f32 v215, v215, v199, v207
    v_cvt_pk_bf16_f32 v222, v212, v213
    v_cvt_pk_bf16_f32 v223, v214, v215
    v_mfma_f32_32x32x16_bf16 a[240:255], a[28:31], v[216:219], a[240:255]
    s_waitcnt lgkmcnt(6)
    ds_read_b64_tr_b16 a[12:13], v226 offset:36064
    ds_read_b64_tr_b16 a[14:15], v226 offset:36576
    v_lshlrev_b32 v208, 16, v24
    v_and_b32 v209, 0xffff0000, v24
    v_lshlrev_b32 v210, 16, v25
    v_and_b32 v211, 0xffff0000, v25
    v_mfma_f32_32x32x16_bf16 v[112:127], a[0:3], v[220:223], v[112:127]
    s_waitcnt lgkmcnt(5)
    s_add_u32 m0, s26, 50688
    s_mov_b32 s32, 2097152
    ds_read_b64_tr_b16 a[16:17], v226 offset:36128
    ds_read_b64_tr_b16 a[18:19], v226 offset:36640
    ds_read_b128 v[192:195], v228 offset:896
    v_fma_f32 v208, v208, v237, v238
    v_fma_f32 v209, v209, v237, v238
    v_fma_f32 v210, v210, v237, v238
    v_fma_f32 v211, v211, v237, v238
    v_mfma_f32_32x32x16_bf16 v[128:143], a[4:7], v[220:223], v[128:143]
    s_waitcnt lgkmcnt(6)
    ds_read_b64_tr_b16 a[20:21], v226 offset:36192
    ds_read_b64_tr_b16 a[22:23], v226 offset:36704
    buffer_load_dwordx4 v225, s[12:15], s32 offen offset:0  lds
    v_lshlrev_b32 v212, 16, v26
    v_and_b32 v213, 0xffff0000, v26
    v_lshlrev_b32 v214, 16, v27
    v_mfma_f32_32x32x16_bf16 v[144:159], a[8:11], v[220:223], v[144:159]
    s_waitcnt lgkmcnt(5)
    ds_read_b64_tr_b16 a[24:25], v226 offset:36256
    ds_read_b64_tr_b16 a[26:27], v226 offset:36768
    ds_read_b128 v[196:199], v228 offset:912
    v_and_b32 v215, 0xffff0000, v27
    v_fma_f32 v208, v208, v176, v184
    v_fma_f32 v209, v209, v177, v185
    v_mfma_f32_32x32x16_bf16 v[160:175], a[12:15], v[220:223], v[160:175]
    s_waitcnt lgkmcnt(6)
    ds_read_b64_tr_b16 a[28:29], v226 offset:36320
    ds_read_b64_tr_b16 a[30:31], v226 offset:36832
    v_fma_f32 v210, v210, v178, v186
    v_fma_f32 v211, v211, v179, v187
    v_fma_f32 v212, v212, v237, v238
    v_fma_f32 v213, v213, v237, v238
    v_mfma_f32_32x32x16_bf16 a[192:207], a[16:19], v[220:223], a[192:207]
    s_waitcnt lgkmcnt(5)
    s_mov_b32 s32, 2161648
    ds_read_b64_tr_b16 a[0:1], v227 offset:16896
    ds_read_b64_tr_b16 a[2:3], v227 offset:17408
    ds_read_b128 v[200:203], v228 offset:928
    v_fma_f32 v214, v214, v237, v238
    v_fma_f32 v215, v215, v237, v238
    v_cvt_pk_bf16_f32 v216, v208, v209
    v_cvt_pk_bf16_f32 v217, v210, v211
    v_mfma_f32_32x32x16_bf16 a[208:223], a[20:23], v[220:223], a[208:223]
    s_waitcnt lgkmcnt(6)
    ds_read_b64_tr_b16 a[4:5], v227 offset:16960
    ds_read_b64_tr_b16 a[6:7], v227 offset:17472
    buffer_load_dwordx4 v225, s[12:15], s32 offen offset:1040  lds
    v_fma_f32 v212, v212, v180, v188
    v_fma_f32 v213, v213, v181, v189
    v_fma_f32 v214, v214, v182, v190
    v_mfma_f32_32x32x16_bf16 a[224:239], a[24:27], v[220:223], a[224:239]
    s_waitcnt lgkmcnt(5)
    ds_read_b64_tr_b16 a[8:9], v227 offset:17024
    ds_read_b64_tr_b16 a[10:11], v227 offset:17536
    ds_read_b128 v[204:207], v228 offset:944
    v_fma_f32 v215, v215, v183, v191
    v_cvt_pk_bf16_f32 v218, v212, v213
    v_cvt_pk_bf16_f32 v219, v214, v215
    v_mfma_f32_32x32x16_bf16 a[240:255], a[28:31], v[220:223], a[240:255]
    s_waitcnt lgkmcnt(6)
    ds_read_b64_tr_b16 a[12:13], v227 offset:17088
    ds_read_b64_tr_b16 a[14:15], v227 offset:17600
    v_lshlrev_b32 v208, 16, v28
    v_and_b32 v209, 0xffff0000, v28
    v_lshlrev_b32 v210, 16, v29
    v_and_b32 v211, 0xffff0000, v29
    v_mfma_f32_32x32x16_bf16 v[112:127], a[0:3], v[216:219], v[112:127]
    s_waitcnt lgkmcnt(5)
    s_mov_b32 s32, 2226144
    ds_read_b64_tr_b16 a[16:17], v227 offset:17152
    ds_read_b64_tr_b16 a[18:19], v227 offset:17664
    ds_read_b128 v[176:179], v228 offset:1024
    v_fma_f32 v208, v208, v237, v238
    v_fma_f32 v209, v209, v237, v238
    v_fma_f32 v210, v210, v237, v238
    v_fma_f32 v211, v211, v237, v238
    v_mfma_f32_32x32x16_bf16 v[128:143], a[4:7], v[216:219], v[128:143]
    s_waitcnt lgkmcnt(6)
    ds_read_b64_tr_b16 a[20:21], v227 offset:17216
    ds_read_b64_tr_b16 a[22:23], v227 offset:17728
    buffer_load_dwordx4 v225, s[12:15], s32 offen offset:2080  lds
    v_lshlrev_b32 v212, 16, v30
    v_and_b32 v213, 0xffff0000, v30
    v_lshlrev_b32 v214, 16, v31
    v_mfma_f32_32x32x16_bf16 v[144:159], a[8:11], v[216:219], v[144:159]
    s_waitcnt lgkmcnt(5)
    ds_read_b64_tr_b16 a[24:25], v227 offset:17280
    ds_read_b64_tr_b16 a[26:27], v227 offset:17792
    ds_read_b128 v[180:183], v228 offset:1040
    v_and_b32 v215, 0xffff0000, v31
    v_fma_f32 v208, v208, v192, v200
    v_fma_f32 v209, v209, v193, v201
    v_mfma_f32_32x32x16_bf16 v[160:175], a[12:15], v[216:219], v[160:175]
    s_waitcnt lgkmcnt(6)
    ds_read_b64_tr_b16 a[28:29], v227 offset:17344
    ds_read_b64_tr_b16 a[30:31], v227 offset:17856
    v_fma_f32 v210, v210, v194, v202
    v_fma_f32 v211, v211, v195, v203
    v_fma_f32 v212, v212, v237, v238
    v_fma_f32 v213, v213, v237, v238
    v_mfma_f32_32x32x16_bf16 a[192:207], a[16:19], v[216:219], a[192:207]
    s_waitcnt lgkmcnt(5)
    s_mov_b32 s32, 2290640
    ds_read_b64_tr_b16 a[0:1], v227 offset:18976
    ds_read_b64_tr_b16 a[2:3], v227 offset:19488
    ds_read_b128 v[184:187], v228 offset:1056
    v_fma_f32 v214, v214, v237, v238
    v_fma_f32 v215, v215, v237, v238
    v_cvt_pk_bf16_f32 v220, v208, v209
    v_cvt_pk_bf16_f32 v221, v210, v211
    v_mfma_f32_32x32x16_bf16 a[208:223], a[20:23], v[216:219], a[208:223]
    s_waitcnt lgkmcnt(6)
    ds_read_b64_tr_b16 a[4:5], v227 offset:19040
    ds_read_b64_tr_b16 a[6:7], v227 offset:19552
    buffer_load_dwordx4 v225, s[12:15], s32 offen offset:3120  lds
    v_fma_f32 v212, v212, v196, v204
    v_fma_f32 v213, v213, v197, v205
    v_fma_f32 v214, v214, v198, v206
    v_mfma_f32_32x32x16_bf16 a[224:239], a[24:27], v[216:219], a[224:239]
    s_waitcnt lgkmcnt(5)
    ds_read_b64_tr_b16 a[8:9], v227 offset:19104
    ds_read_b64_tr_b16 a[10:11], v227 offset:19616
    ds_read_b128 v[188:191], v228 offset:1072
    v_fma_f32 v215, v215, v199, v207
    v_cvt_pk_bf16_f32 v222, v212, v213
    v_cvt_pk_bf16_f32 v223, v214, v215
    v_mfma_f32_32x32x16_bf16 a[240:255], a[28:31], v[216:219], a[240:255]
    s_waitcnt lgkmcnt(6)
    ds_read_b64_tr_b16 a[12:13], v227 offset:19168
    ds_read_b64_tr_b16 a[14:15], v227 offset:19680
    v_lshlrev_b32 v208, 16, v32
    v_and_b32 v209, 0xffff0000, v32
    v_lshlrev_b32 v210, 16, v33
    v_and_b32 v211, 0xffff0000, v33
    v_mfma_f32_32x32x16_bf16 v[112:127], a[0:3], v[220:223], v[112:127]
    s_waitcnt lgkmcnt(5)
    ds_read_b64_tr_b16 a[16:17], v227 offset:19232
    ds_read_b64_tr_b16 a[18:19], v227 offset:19744
    ds_read_b128 v[192:195], v228 offset:1152
    v_fma_f32 v208, v208, v237, v238
    v_fma_f32 v209, v209, v237, v238
    v_fma_f32 v210, v210, v237, v238
    v_fma_f32 v211, v211, v237, v238
    v_mfma_f32_32x32x16_bf16 v[128:143], a[4:7], v[220:223], v[128:143]
    s_waitcnt lgkmcnt(6)
    ds_read_b64_tr_b16 a[20:21], v227 offset:19296
    ds_read_b64_tr_b16 a[22:23], v227 offset:19808
    v_lshlrev_b32 v212, 16, v34
    v_and_b32 v213, 0xffff0000, v34
    v_lshlrev_b32 v214, 16, v35
    v_mfma_f32_32x32x16_bf16 v[144:159], a[8:11], v[220:223], v[144:159]
    s_waitcnt lgkmcnt(5)
    ds_read_b64_tr_b16 a[24:25], v227 offset:19360
    ds_read_b64_tr_b16 a[26:27], v227 offset:19872
    ds_read_b128 v[196:199], v228 offset:1168
    v_and_b32 v215, 0xffff0000, v35
    v_fma_f32 v208, v208, v176, v184
    v_fma_f32 v209, v209, v177, v185
    v_mfma_f32_32x32x16_bf16 v[160:175], a[12:15], v[220:223], v[160:175]
    s_waitcnt vmcnt(12) lgkmcnt(6)
    s_barrier
    ds_read_b64_tr_b16 a[28:29], v227 offset:19424
    ds_read_b64_tr_b16 a[30:31], v227 offset:19936
    v_fma_f32 v210, v210, v178, v186
    v_fma_f32 v211, v211, v179, v187
    v_fma_f32 v212, v212, v237, v238
    v_fma_f32 v213, v213, v237, v238
    v_mfma_f32_32x32x16_bf16 a[192:207], a[16:19], v[220:223], a[192:207]
    s_waitcnt lgkmcnt(5)
    s_add_u32 m0, s26, 67584
    s_mov_b32 s32, 2359296
    ds_read_b64_tr_b16 a[0:1], v227 offset:33792
    ds_read_b64_tr_b16 a[2:3], v227 offset:34304
    ds_read_b128 v[200:203], v228 offset:1184
    v_fma_f32 v214, v214, v237, v238
    v_fma_f32 v215, v215, v237, v238
    v_cvt_pk_bf16_f32 v216, v208, v209
    v_cvt_pk_bf16_f32 v217, v210, v211
    v_mfma_f32_32x32x16_bf16 a[208:223], a[20:23], v[220:223], a[208:223]
    s_waitcnt lgkmcnt(6)
    ds_read_b64_tr_b16 a[4:5], v227 offset:33856
    ds_read_b64_tr_b16 a[6:7], v227 offset:34368
    buffer_load_dwordx4 v225, s[12:15], s32 offen offset:0  lds
    v_fma_f32 v212, v212, v180, v188
    v_fma_f32 v213, v213, v181, v189
    v_fma_f32 v214, v214, v182, v190
    v_mfma_f32_32x32x16_bf16 a[224:239], a[24:27], v[220:223], a[224:239]
    s_waitcnt lgkmcnt(5)
    ds_read_b64_tr_b16 a[8:9], v227 offset:33920
    ds_read_b64_tr_b16 a[10:11], v227 offset:34432
    ds_read_b128 v[204:207], v228 offset:1200
    v_fma_f32 v215, v215, v183, v191
    v_cvt_pk_bf16_f32 v218, v212, v213
    v_cvt_pk_bf16_f32 v219, v214, v215
    v_mfma_f32_32x32x16_bf16 a[240:255], a[28:31], v[220:223], a[240:255]
    s_waitcnt lgkmcnt(6)
    ds_read_b64_tr_b16 a[12:13], v227 offset:33984
    ds_read_b64_tr_b16 a[14:15], v227 offset:34496
    v_lshlrev_b32 v208, 16, v36
    v_and_b32 v209, 0xffff0000, v36
    v_lshlrev_b32 v210, 16, v37
    v_and_b32 v211, 0xffff0000, v37
    v_mfma_f32_32x32x16_bf16 v[112:127], a[0:3], v[216:219], v[112:127]
    s_waitcnt lgkmcnt(5)
    s_mov_b32 s32, 2423792
    ds_read_b64_tr_b16 a[16:17], v227 offset:34048
    ds_read_b64_tr_b16 a[18:19], v227 offset:34560
    ds_read_b128 v[176:179], v228 offset:1280
    v_fma_f32 v208, v208, v237, v238
    v_fma_f32 v209, v209, v237, v238
    v_fma_f32 v210, v210, v237, v238
    v_fma_f32 v211, v211, v237, v238
    v_mfma_f32_32x32x16_bf16 v[128:143], a[4:7], v[216:219], v[128:143]
    s_waitcnt lgkmcnt(6)
    ds_read_b64_tr_b16 a[20:21], v227 offset:34112
    ds_read_b64_tr_b16 a[22:23], v227 offset:34624
    buffer_load_dwordx4 v225, s[12:15], s32 offen offset:1040  lds
    v_lshlrev_b32 v212, 16, v38
    v_and_b32 v213, 0xffff0000, v38
    v_lshlrev_b32 v214, 16, v39
    v_mfma_f32_32x32x16_bf16 v[144:159], a[8:11], v[216:219], v[144:159]
    s_waitcnt lgkmcnt(5)
    ds_read_b64_tr_b16 a[24:25], v227 offset:34176
    ds_read_b64_tr_b16 a[26:27], v227 offset:34688
    ds_read_b128 v[180:183], v228 offset:1296
    v_and_b32 v215, 0xffff0000, v39
    v_fma_f32 v208, v208, v192, v200
    v_fma_f32 v209, v209, v193, v201
    v_mfma_f32_32x32x16_bf16 v[160:175], a[12:15], v[216:219], v[160:175]
    s_waitcnt lgkmcnt(6)
    ds_read_b64_tr_b16 a[28:29], v227 offset:34240
    ds_read_b64_tr_b16 a[30:31], v227 offset:34752
    v_fma_f32 v210, v210, v194, v202
    v_fma_f32 v211, v211, v195, v203
    v_fma_f32 v212, v212, v237, v238
    v_fma_f32 v213, v213, v237, v238
    v_mfma_f32_32x32x16_bf16 a[192:207], a[16:19], v[216:219], a[192:207]
    s_waitcnt lgkmcnt(5)
    s_mov_b32 s32, 2488288
    ds_read_b64_tr_b16 a[0:1], v227 offset:35872
    ds_read_b64_tr_b16 a[2:3], v227 offset:36384
    ds_read_b128 v[184:187], v228 offset:1312
    v_fma_f32 v214, v214, v237, v238
    v_fma_f32 v215, v215, v237, v238
    v_cvt_pk_bf16_f32 v220, v208, v209
    v_cvt_pk_bf16_f32 v221, v210, v211
    v_mfma_f32_32x32x16_bf16 a[208:223], a[20:23], v[216:219], a[208:223]
    s_waitcnt lgkmcnt(6)
    ds_read_b64_tr_b16 a[4:5], v227 offset:35936
    ds_read_b64_tr_b16 a[6:7], v227 offset:36448
    buffer_load_dwordx4 v225, s[12:15], s32 offen offset:2080  lds
    v_fma_f32 v212, v212, v196, v204
    v_fma_f32 v213, v213, v197, v205
    v_fma_f32 v214, v214, v198, v206
    v_mfma_f32_32x32x16_bf16 a[224:239], a[24:27], v[216:219], a[224:239]
    s_waitcnt lgkmcnt(5)
    ds_read_b64_tr_b16 a[8:9], v227 offset:36000
    ds_read_b64_tr_b16 a[10:11], v227 offset:36512
    ds_read_b128 v[188:191], v228 offset:1328
    v_fma_f32 v215, v215, v199, v207
    v_cvt_pk_bf16_f32 v222, v212, v213
    v_cvt_pk_bf16_f32 v223, v214, v215
    v_mfma_f32_32x32x16_bf16 a[240:255], a[28:31], v[216:219], a[240:255]
    s_waitcnt lgkmcnt(6)
    ds_read_b64_tr_b16 a[12:13], v227 offset:36064
    ds_read_b64_tr_b16 a[14:15], v227 offset:36576
    v_lshlrev_b32 v208, 16, v40
    v_and_b32 v209, 0xffff0000, v40
    v_lshlrev_b32 v210, 16, v41
    v_and_b32 v211, 0xffff0000, v41
    v_mfma_f32_32x32x16_bf16 v[112:127], a[0:3], v[220:223], v[112:127]
    s_waitcnt lgkmcnt(5)
    s_mov_b32 s32, 2552784
    ds_read_b64_tr_b16 a[16:17], v227 offset:36128
    ds_read_b64_tr_b16 a[18:19], v227 offset:36640
    ds_read_b128 v[192:195], v228 offset:1408
    v_fma_f32 v208, v208, v237, v238
    v_fma_f32 v209, v209, v237, v238
    v_fma_f32 v210, v210, v237, v238
    v_fma_f32 v211, v211, v237, v238
    v_mfma_f32_32x32x16_bf16 v[128:143], a[4:7], v[220:223], v[128:143]
    s_waitcnt lgkmcnt(6)
    ds_read_b64_tr_b16 a[20:21], v227 offset:36192
    ds_read_b64_tr_b16 a[22:23], v227 offset:36704
    buffer_load_dwordx4 v225, s[12:15], s32 offen offset:3120  lds
    v_lshlrev_b32 v212, 16, v42
    v_and_b32 v213, 0xffff0000, v42
    v_lshlrev_b32 v214, 16, v43
    v_mfma_f32_32x32x16_bf16 v[144:159], a[8:11], v[220:223], v[144:159]
    s_waitcnt lgkmcnt(5)
    ds_read_b64_tr_b16 a[24:25], v227 offset:36256
    ds_read_b64_tr_b16 a[26:27], v227 offset:36768
    ds_read_b128 v[196:199], v228 offset:1424
    v_and_b32 v215, 0xffff0000, v43
    v_fma_f32 v208, v208, v176, v184
    v_fma_f32 v209, v209, v177, v185
    v_mfma_f32_32x32x16_bf16 v[160:175], a[12:15], v[220:223], v[160:175]
    s_waitcnt lgkmcnt(6)
    ds_read_b64_tr_b16 a[28:29], v227 offset:36320
    ds_read_b64_tr_b16 a[30:31], v227 offset:36832
    v_fma_f32 v210, v210, v178, v186
    v_fma_f32 v211, v211, v179, v187
    v_fma_f32 v212, v212, v237, v238
    v_fma_f32 v213, v213, v237, v238
    v_mfma_f32_32x32x16_bf16 a[192:207], a[16:19], v[220:223], a[192:207]
    s_waitcnt lgkmcnt(5)
    s_add_u32 m0, s26, 33792
    s_mov_b32 s32, 2621440
    ds_read_b64_tr_b16 a[0:1], v227 offset:50688
    ds_read_b64_tr_b16 a[2:3], v227 offset:51200
    ds_read_b128 v[200:203], v228 offset:1440
    v_fma_f32 v214, v214, v237, v238
    v_fma_f32 v215, v215, v237, v238
    v_cvt_pk_bf16_f32 v216, v208, v209
    v_cvt_pk_bf16_f32 v217, v210, v211
    v_mfma_f32_32x32x16_bf16 a[208:223], a[20:23], v[220:223], a[208:223]
    s_waitcnt lgkmcnt(6)
    ds_read_b64_tr_b16 a[4:5], v227 offset:50752
    ds_read_b64_tr_b16 a[6:7], v227 offset:51264
    buffer_load_dwordx4 v225, s[12:15], s32 offen offset:0  lds
    v_fma_f32 v212, v212, v180, v188
    v_fma_f32 v213, v213, v181, v189
    v_fma_f32 v214, v214, v182, v190
    v_mfma_f32_32x32x16_bf16 a[224:239], a[24:27], v[220:223], a[224:239]
    s_waitcnt lgkmcnt(5)
    ds_read_b64_tr_b16 a[8:9], v227 offset:50816
    ds_read_b64_tr_b16 a[10:11], v227 offset:51328
    ds_read_b128 v[204:207], v228 offset:1456
    v_fma_f32 v215, v215, v183, v191
    v_cvt_pk_bf16_f32 v218, v212, v213
    v_cvt_pk_bf16_f32 v219, v214, v215
    v_mfma_f32_32x32x16_bf16 a[240:255], a[28:31], v[220:223], a[240:255]
    s_waitcnt lgkmcnt(6)
    ds_read_b64_tr_b16 a[12:13], v227 offset:50880
    ds_read_b64_tr_b16 a[14:15], v227 offset:51392
    v_lshlrev_b32 v208, 16, v44
    v_and_b32 v209, 0xffff0000, v44
    v_lshlrev_b32 v210, 16, v45
    v_and_b32 v211, 0xffff0000, v45
    v_mfma_f32_32x32x16_bf16 v[112:127], a[0:3], v[216:219], v[112:127]
    s_waitcnt lgkmcnt(5)
    s_mov_b32 s32, 2685936
    ds_read_b64_tr_b16 a[16:17], v227 offset:50944
    ds_read_b64_tr_b16 a[18:19], v227 offset:51456
    ds_read_b128 v[176:179], v228 offset:1536
    v_fma_f32 v208, v208, v237, v238
    v_fma_f32 v209, v209, v237, v238
    v_fma_f32 v210, v210, v237, v238
    v_fma_f32 v211, v211, v237, v238
    v_mfma_f32_32x32x16_bf16 v[128:143], a[4:7], v[216:219], v[128:143]
    s_waitcnt lgkmcnt(6)
    ds_read_b64_tr_b16 a[20:21], v227 offset:51008
    ds_read_b64_tr_b16 a[22:23], v227 offset:51520
    buffer_load_dwordx4 v225, s[12:15], s32 offen offset:1040  lds
    v_lshlrev_b32 v212, 16, v46
    v_and_b32 v213, 0xffff0000, v46
    v_lshlrev_b32 v214, 16, v47
    v_mfma_f32_32x32x16_bf16 v[144:159], a[8:11], v[216:219], v[144:159]
    s_waitcnt lgkmcnt(5)
    ds_read_b64_tr_b16 a[24:25], v227 offset:51072
    ds_read_b64_tr_b16 a[26:27], v227 offset:51584
    ds_read_b128 v[180:183], v228 offset:1552
    v_and_b32 v215, 0xffff0000, v47
    v_fma_f32 v208, v208, v192, v200
    v_fma_f32 v209, v209, v193, v201
    v_mfma_f32_32x32x16_bf16 v[160:175], a[12:15], v[216:219], v[160:175]
    s_waitcnt lgkmcnt(6)
    ds_read_b64_tr_b16 a[28:29], v227 offset:51136
    ds_read_b64_tr_b16 a[30:31], v227 offset:51648
    v_fma_f32 v210, v210, v194, v202
    v_fma_f32 v211, v211, v195, v203
    v_fma_f32 v212, v212, v237, v238
    v_fma_f32 v213, v213, v237, v238
    v_mfma_f32_32x32x16_bf16 a[192:207], a[16:19], v[216:219], a[192:207]
    s_waitcnt lgkmcnt(5)
    s_mov_b32 s32, 2750432
    ds_read_b64_tr_b16 a[0:1], v227 offset:52768
    ds_read_b64_tr_b16 a[2:3], v227 offset:53280
    ds_read_b128 v[184:187], v228 offset:1568
    v_fma_f32 v214, v214, v237, v238
    v_fma_f32 v215, v215, v237, v238
    v_cvt_pk_bf16_f32 v220, v208, v209
    v_cvt_pk_bf16_f32 v221, v210, v211
    v_mfma_f32_32x32x16_bf16 a[208:223], a[20:23], v[216:219], a[208:223]
    s_waitcnt lgkmcnt(6)
    ds_read_b64_tr_b16 a[4:5], v227 offset:52832
    ds_read_b64_tr_b16 a[6:7], v227 offset:53344
    buffer_load_dwordx4 v225, s[12:15], s32 offen offset:2080  lds
    v_fma_f32 v212, v212, v196, v204
    v_fma_f32 v213, v213, v197, v205
    v_fma_f32 v214, v214, v198, v206
    v_mfma_f32_32x32x16_bf16 a[224:239], a[24:27], v[216:219], a[224:239]
    s_waitcnt lgkmcnt(5)
    ds_read_b64_tr_b16 a[8:9], v227 offset:52896
    ds_read_b64_tr_b16 a[10:11], v227 offset:53408
    ds_read_b128 v[188:191], v228 offset:1584
    v_fma_f32 v215, v215, v199, v207
    v_cvt_pk_bf16_f32 v222, v212, v213
    v_cvt_pk_bf16_f32 v223, v214, v215
    v_mfma_f32_32x32x16_bf16 a[240:255], a[28:31], v[216:219], a[240:255]
    s_waitcnt lgkmcnt(6)
    ds_read_b64_tr_b16 a[12:13], v227 offset:52960
    ds_read_b64_tr_b16 a[14:15], v227 offset:53472
    v_lshlrev_b32 v208, 16, v48
    v_and_b32 v209, 0xffff0000, v48
    v_lshlrev_b32 v210, 16, v49
    v_and_b32 v211, 0xffff0000, v49
    v_mfma_f32_32x32x16_bf16 v[112:127], a[0:3], v[220:223], v[112:127]
    s_waitcnt lgkmcnt(5)
    s_mov_b32 s32, 2814928
    ds_read_b64_tr_b16 a[16:17], v227 offset:53024
    ds_read_b64_tr_b16 a[18:19], v227 offset:53536
    ds_read_b128 v[192:195], v228 offset:1664
    v_fma_f32 v208, v208, v237, v238
    v_fma_f32 v209, v209, v237, v238
    v_fma_f32 v210, v210, v237, v238
    v_fma_f32 v211, v211, v237, v238
    v_mfma_f32_32x32x16_bf16 v[128:143], a[4:7], v[220:223], v[128:143]
    s_waitcnt lgkmcnt(6)
    ds_read_b64_tr_b16 a[20:21], v227 offset:53088
    ds_read_b64_tr_b16 a[22:23], v227 offset:53600
    buffer_load_dwordx4 v225, s[12:15], s32 offen offset:3120  lds
    v_lshlrev_b32 v212, 16, v50
    v_and_b32 v213, 0xffff0000, v50
    v_lshlrev_b32 v214, 16, v51
    v_mfma_f32_32x32x16_bf16 v[144:159], a[8:11], v[220:223], v[144:159]
    s_waitcnt lgkmcnt(5)
    ds_read_b64_tr_b16 a[24:25], v227 offset:53152
    ds_read_b64_tr_b16 a[26:27], v227 offset:53664
    ds_read_b128 v[196:199], v228 offset:1680
    v_and_b32 v215, 0xffff0000, v51
    v_fma_f32 v208, v208, v176, v184
    v_fma_f32 v209, v209, v177, v185
    v_mfma_f32_32x32x16_bf16 v[160:175], a[12:15], v[220:223], v[160:175]
    s_waitcnt vmcnt(12) lgkmcnt(6)
    s_barrier
    ds_read_b64_tr_b16 a[28:29], v227 offset:53216
    ds_read_b64_tr_b16 a[30:31], v227 offset:53728
    v_fma_f32 v210, v210, v178, v186
    v_fma_f32 v211, v211, v179, v187
    v_fma_f32 v212, v212, v237, v238
    v_fma_f32 v213, v213, v237, v238
    v_mfma_f32_32x32x16_bf16 a[192:207], a[16:19], v[220:223], a[192:207]
    s_waitcnt lgkmcnt(5)
    s_add_u32 m0, s26, 84480
    s_mov_b32 s32, 2883584
    ds_read_b64_tr_b16 a[0:1], v226 offset:0
    ds_read_b64_tr_b16 a[2:3], v226 offset:512
    ds_read_b128 v[200:203], v228 offset:1696
    v_fma_f32 v214, v214, v237, v238
    v_fma_f32 v215, v215, v237, v238
    v_cvt_pk_bf16_f32 v216, v208, v209
    v_cvt_pk_bf16_f32 v217, v210, v211
    v_mfma_f32_32x32x16_bf16 a[208:223], a[20:23], v[220:223], a[208:223]
    s_waitcnt lgkmcnt(6)
    ds_read_b64_tr_b16 a[4:5], v226 offset:64
    ds_read_b64_tr_b16 a[6:7], v226 offset:576
    buffer_load_dwordx4 v225, s[12:15], s32 offen offset:0  lds
    v_fma_f32 v212, v212, v180, v188
    v_fma_f32 v213, v213, v181, v189
    v_fma_f32 v214, v214, v182, v190
    v_mfma_f32_32x32x16_bf16 a[224:239], a[24:27], v[220:223], a[224:239]
    s_waitcnt lgkmcnt(5)
    ds_read_b64_tr_b16 a[8:9], v226 offset:128
    ds_read_b64_tr_b16 a[10:11], v226 offset:640
    ds_read_b128 v[204:207], v228 offset:1712
    v_fma_f32 v215, v215, v183, v191
    v_cvt_pk_bf16_f32 v218, v212, v213
    v_cvt_pk_bf16_f32 v219, v214, v215
    v_mfma_f32_32x32x16_bf16 a[240:255], a[28:31], v[220:223], a[240:255]
    s_waitcnt lgkmcnt(6)
    ds_read_b64_tr_b16 a[12:13], v226 offset:192
    ds_read_b64_tr_b16 a[14:15], v226 offset:704
    v_lshlrev_b32 v208, 16, v52
    v_and_b32 v209, 0xffff0000, v52
    v_lshlrev_b32 v210, 16, v53
    v_and_b32 v211, 0xffff0000, v53
    v_mfma_f32_32x32x16_bf16 v[112:127], a[0:3], v[216:219], v[112:127]
    s_waitcnt lgkmcnt(5)
    s_mov_b32 s32, 2948080
    ds_read_b64_tr_b16 a[16:17], v226 offset:256
    ds_read_b64_tr_b16 a[18:19], v226 offset:768
    ds_read_b128 v[176:179], v228 offset:1792
    v_fma_f32 v208, v208, v237, v238
    v_fma_f32 v209, v209, v237, v238
    v_fma_f32 v210, v210, v237, v238
    v_fma_f32 v211, v211, v237, v238
    v_mfma_f32_32x32x16_bf16 v[128:143], a[4:7], v[216:219], v[128:143]
    s_waitcnt lgkmcnt(6)
    ds_read_b64_tr_b16 a[20:21], v226 offset:320
    ds_read_b64_tr_b16 a[22:23], v226 offset:832
    buffer_load_dwordx4 v225, s[12:15], s32 offen offset:1040  lds
    v_lshlrev_b32 v212, 16, v54
    v_and_b32 v213, 0xffff0000, v54
    v_lshlrev_b32 v214, 16, v55
    v_mfma_f32_32x32x16_bf16 v[144:159], a[8:11], v[216:219], v[144:159]
    s_waitcnt lgkmcnt(5)
    ds_read_b64_tr_b16 a[24:25], v226 offset:384
    ds_read_b64_tr_b16 a[26:27], v226 offset:896
    ds_read_b128 v[180:183], v228 offset:1808
    v_and_b32 v215, 0xffff0000, v55
    v_fma_f32 v208, v208, v192, v200
    v_fma_f32 v209, v209, v193, v201
    v_mfma_f32_32x32x16_bf16 v[160:175], a[12:15], v[216:219], v[160:175]
    s_waitcnt lgkmcnt(6)
    ds_read_b64_tr_b16 a[28:29], v226 offset:448
    ds_read_b64_tr_b16 a[30:31], v226 offset:960
    v_fma_f32 v210, v210, v194, v202
    v_fma_f32 v211, v211, v195, v203
    v_fma_f32 v212, v212, v237, v238
    v_fma_f32 v213, v213, v237, v238
    v_mfma_f32_32x32x16_bf16 a[192:207], a[16:19], v[216:219], a[192:207]
    s_waitcnt lgkmcnt(5)
    s_mov_b32 s32, 3012576
    ds_read_b64_tr_b16 a[0:1], v226 offset:2080
    ds_read_b64_tr_b16 a[2:3], v226 offset:2592
    ds_read_b128 v[184:187], v228 offset:1824
    v_fma_f32 v214, v214, v237, v238
    v_fma_f32 v215, v215, v237, v238
    v_cvt_pk_bf16_f32 v220, v208, v209
    v_cvt_pk_bf16_f32 v221, v210, v211
    v_mfma_f32_32x32x16_bf16 a[208:223], a[20:23], v[216:219], a[208:223]
    s_waitcnt lgkmcnt(6)
    ds_read_b64_tr_b16 a[4:5], v226 offset:2144
    ds_read_b64_tr_b16 a[6:7], v226 offset:2656
    buffer_load_dwordx4 v225, s[12:15], s32 offen offset:2080  lds
    v_fma_f32 v212, v212, v196, v204
    v_fma_f32 v213, v213, v197, v205
    v_fma_f32 v214, v214, v198, v206
    v_mfma_f32_32x32x16_bf16 a[224:239], a[24:27], v[216:219], a[224:239]
    s_waitcnt lgkmcnt(5)
    ds_read_b64_tr_b16 a[8:9], v226 offset:2208
    ds_read_b64_tr_b16 a[10:11], v226 offset:2720
    ds_read_b128 v[188:191], v228 offset:1840
    v_fma_f32 v215, v215, v199, v207
    v_cvt_pk_bf16_f32 v222, v212, v213
    v_cvt_pk_bf16_f32 v223, v214, v215
    v_mfma_f32_32x32x16_bf16 a[240:255], a[28:31], v[216:219], a[240:255]
    s_waitcnt lgkmcnt(6)
    ds_read_b64_tr_b16 a[12:13], v226 offset:2272
    ds_read_b64_tr_b16 a[14:15], v226 offset:2784
    v_lshlrev_b32 v208, 16, v56
    v_and_b32 v209, 0xffff0000, v56
    v_lshlrev_b32 v210, 16, v57
    v_and_b32 v211, 0xffff0000, v57
    v_mfma_f32_32x32x16_bf16 v[112:127], a[0:3], v[220:223], v[112:127]
    s_waitcnt lgkmcnt(5)
    s_mov_b32 s32, 3077072
    ds_read_b64_tr_b16 a[16:17], v226 offset:2336
    ds_read_b64_tr_b16 a[18:19], v226 offset:2848
    ds_read_b128 v[192:195], v228 offset:1920
    v_fma_f32 v208, v208, v237, v238
    v_fma_f32 v209, v209, v237, v238
    v_fma_f32 v210, v210, v237, v238
    v_fma_f32 v211, v211, v237, v238
    v_mfma_f32_32x32x16_bf16 v[128:143], a[4:7], v[220:223], v[128:143]
    s_waitcnt lgkmcnt(6)
    ds_read_b64_tr_b16 a[20:21], v226 offset:2400
    ds_read_b64_tr_b16 a[22:23], v226 offset:2912
    buffer_load_dwordx4 v225, s[12:15], s32 offen offset:3120  lds
    v_lshlrev_b32 v212, 16, v58
    v_and_b32 v213, 0xffff0000, v58
    v_lshlrev_b32 v214, 16, v59
    v_mfma_f32_32x32x16_bf16 v[144:159], a[8:11], v[220:223], v[144:159]
    s_waitcnt lgkmcnt(5)
    ds_read_b64_tr_b16 a[24:25], v226 offset:2464
    ds_read_b64_tr_b16 a[26:27], v226 offset:2976
    ds_read_b128 v[196:199], v228 offset:1936
    v_and_b32 v215, 0xffff0000, v59
    v_fma_f32 v208, v208, v176, v184
    v_fma_f32 v209, v209, v177, v185
    v_mfma_f32_32x32x16_bf16 v[160:175], a[12:15], v[220:223], v[160:175]
    s_waitcnt lgkmcnt(6)
    ds_read_b64_tr_b16 a[28:29], v226 offset:2528
    ds_read_b64_tr_b16 a[30:31], v226 offset:3040
    v_fma_f32 v210, v210, v178, v186
    v_fma_f32 v211, v211, v179, v187
    v_fma_f32 v212, v212, v237, v238
    v_fma_f32 v213, v213, v237, v238
    v_mfma_f32_32x32x16_bf16 a[192:207], a[16:19], v[220:223], a[192:207]
    s_waitcnt lgkmcnt(5)
    s_add_u32 m0, s26, 101376
    s_mov_b32 s32, 3145728
    ds_read_b64_tr_b16 a[0:1], v226 offset:16896
    ds_read_b64_tr_b16 a[2:3], v226 offset:17408
    ds_read_b128 v[200:203], v228 offset:1952
    v_fma_f32 v214, v214, v237, v238
    v_fma_f32 v215, v215, v237, v238
    v_cvt_pk_bf16_f32 v216, v208, v209
    v_cvt_pk_bf16_f32 v217, v210, v211
    v_mfma_f32_32x32x16_bf16 a[208:223], a[20:23], v[220:223], a[208:223]
    s_waitcnt lgkmcnt(6)
    ds_read_b64_tr_b16 a[4:5], v226 offset:16960
    ds_read_b64_tr_b16 a[6:7], v226 offset:17472
    buffer_load_dwordx4 v225, s[12:15], s32 offen offset:0  lds
    v_fma_f32 v212, v212, v180, v188
    v_fma_f32 v213, v213, v181, v189
    v_fma_f32 v214, v214, v182, v190
    v_mfma_f32_32x32x16_bf16 a[224:239], a[24:27], v[220:223], a[224:239]
    s_waitcnt lgkmcnt(5)
    ds_read_b64_tr_b16 a[8:9], v226 offset:17024
    ds_read_b64_tr_b16 a[10:11], v226 offset:17536
    ds_read_b128 v[204:207], v228 offset:1968
    v_fma_f32 v215, v215, v183, v191
    v_cvt_pk_bf16_f32 v218, v212, v213
    v_cvt_pk_bf16_f32 v219, v214, v215
    v_mfma_f32_32x32x16_bf16 a[240:255], a[28:31], v[220:223], a[240:255]
    s_waitcnt lgkmcnt(6)
    ds_read_b64_tr_b16 a[12:13], v226 offset:17088
    ds_read_b64_tr_b16 a[14:15], v226 offset:17600
    v_lshlrev_b32 v208, 16, v60
    v_and_b32 v209, 0xffff0000, v60
    v_lshlrev_b32 v210, 16, v61
    v_and_b32 v211, 0xffff0000, v61
    v_mfma_f32_32x32x16_bf16 v[112:127], a[0:3], v[216:219], v[112:127]
    s_waitcnt lgkmcnt(5)
    s_mov_b32 s32, 3210224
    ds_read_b64_tr_b16 a[16:17], v226 offset:17152
    ds_read_b64_tr_b16 a[18:19], v226 offset:17664
    ds_read_b128 v[176:179], v228 offset:2048
    v_fma_f32 v208, v208, v237, v238
    v_fma_f32 v209, v209, v237, v238
    v_fma_f32 v210, v210, v237, v238
    v_fma_f32 v211, v211, v237, v238
    v_mfma_f32_32x32x16_bf16 v[128:143], a[4:7], v[216:219], v[128:143]
    s_waitcnt lgkmcnt(6)
    ds_read_b64_tr_b16 a[20:21], v226 offset:17216
    ds_read_b64_tr_b16 a[22:23], v226 offset:17728
    buffer_load_dwordx4 v225, s[12:15], s32 offen offset:1040  lds
    v_lshlrev_b32 v212, 16, v62
    v_and_b32 v213, 0xffff0000, v62
    v_lshlrev_b32 v214, 16, v63
    v_mfma_f32_32x32x16_bf16 v[144:159], a[8:11], v[216:219], v[144:159]
    s_waitcnt lgkmcnt(5)
    ds_read_b64_tr_b16 a[24:25], v226 offset:17280
    ds_read_b64_tr_b16 a[26:27], v226 offset:17792
    ds_read_b128 v[180:183], v228 offset:2064
    v_and_b32 v215, 0xffff0000, v63
    v_fma_f32 v208, v208, v192, v200
    v_fma_f32 v209, v209, v193, v201
    v_mfma_f32_32x32x16_bf16 v[160:175], a[12:15], v[216:219], v[160:175]
    s_waitcnt lgkmcnt(6)
    ds_read_b64_tr_b16 a[28:29], v226 offset:17344
    ds_read_b64_tr_b16 a[30:31], v226 offset:17856
    v_fma_f32 v210, v210, v194, v202
    v_fma_f32 v211, v211, v195, v203
    v_fma_f32 v212, v212, v237, v238
    v_fma_f32 v213, v213, v237, v238
    v_mfma_f32_32x32x16_bf16 a[192:207], a[16:19], v[216:219], a[192:207]
    s_waitcnt lgkmcnt(5)
    s_mov_b32 s32, 3274720
    ds_read_b64_tr_b16 a[0:1], v226 offset:18976
    ds_read_b64_tr_b16 a[2:3], v226 offset:19488
    ds_read_b128 v[184:187], v228 offset:2080
    v_fma_f32 v214, v214, v237, v238
    v_fma_f32 v215, v215, v237, v238
    v_cvt_pk_bf16_f32 v220, v208, v209
    v_cvt_pk_bf16_f32 v221, v210, v211
    v_mfma_f32_32x32x16_bf16 a[208:223], a[20:23], v[216:219], a[208:223]
    s_waitcnt lgkmcnt(6)
    ds_read_b64_tr_b16 a[4:5], v226 offset:19040
    ds_read_b64_tr_b16 a[6:7], v226 offset:19552
    buffer_load_dwordx4 v225, s[12:15], s32 offen offset:2080  lds
    v_fma_f32 v212, v212, v196, v204
    v_fma_f32 v213, v213, v197, v205
    v_fma_f32 v214, v214, v198, v206
    v_mfma_f32_32x32x16_bf16 a[224:239], a[24:27], v[216:219], a[224:239]
    s_waitcnt lgkmcnt(5)
    ds_read_b64_tr_b16 a[8:9], v226 offset:19104
    ds_read_b64_tr_b16 a[10:11], v226 offset:19616
    ds_read_b128 v[188:191], v228 offset:2096
    v_fma_f32 v215, v215, v199, v207
    v_cvt_pk_bf16_f32 v222, v212, v213
    v_cvt_pk_bf16_f32 v223, v214, v215
    v_mfma_f32_32x32x16_bf16 a[240:255], a[28:31], v[216:219], a[240:255]
    s_waitcnt lgkmcnt(6)
    ds_read_b64_tr_b16 a[12:13], v226 offset:19168
    ds_read_b64_tr_b16 a[14:15], v226 offset:19680
    v_lshlrev_b32 v208, 16, v64
    v_and_b32 v209, 0xffff0000, v64
    v_lshlrev_b32 v210, 16, v65
    v_and_b32 v211, 0xffff0000, v65
    v_mfma_f32_32x32x16_bf16 v[112:127], a[0:3], v[220:223], v[112:127]
    s_waitcnt lgkmcnt(5)
    s_mov_b32 s32, 3339216
    ds_read_b64_tr_b16 a[16:17], v226 offset:19232
    ds_read_b64_tr_b16 a[18:19], v226 offset:19744
    ds_read_b128 v[192:195], v228 offset:2176
    v_fma_f32 v208, v208, v237, v238
    v_fma_f32 v209, v209, v237, v238
    v_fma_f32 v210, v210, v237, v238
    v_fma_f32 v211, v211, v237, v238
    v_mfma_f32_32x32x16_bf16 v[128:143], a[4:7], v[220:223], v[128:143]
    s_waitcnt lgkmcnt(6)
    ds_read_b64_tr_b16 a[20:21], v226 offset:19296
    ds_read_b64_tr_b16 a[22:23], v226 offset:19808
    buffer_load_dwordx4 v225, s[12:15], s32 offen offset:3120  lds
    v_lshlrev_b32 v212, 16, v66
    v_and_b32 v213, 0xffff0000, v66
    v_lshlrev_b32 v214, 16, v67
    v_mfma_f32_32x32x16_bf16 v[144:159], a[8:11], v[220:223], v[144:159]
    s_waitcnt lgkmcnt(5)
    ds_read_b64_tr_b16 a[24:25], v226 offset:19360
    ds_read_b64_tr_b16 a[26:27], v226 offset:19872
    ds_read_b128 v[196:199], v228 offset:2192
    v_and_b32 v215, 0xffff0000, v67
    v_fma_f32 v208, v208, v176, v184
    v_fma_f32 v209, v209, v177, v185
    v_mfma_f32_32x32x16_bf16 v[160:175], a[12:15], v[220:223], v[160:175]
    s_waitcnt vmcnt(12) lgkmcnt(6)
    s_barrier
    ds_read_b64_tr_b16 a[28:29], v226 offset:19424
    ds_read_b64_tr_b16 a[30:31], v226 offset:19936
    v_fma_f32 v210, v210, v178, v186
    v_fma_f32 v211, v211, v179, v187
    v_fma_f32 v212, v212, v237, v238
    v_fma_f32 v213, v213, v237, v238
    v_mfma_f32_32x32x16_bf16 a[192:207], a[16:19], v[220:223], a[192:207]
    s_waitcnt lgkmcnt(5)
    s_add_u32 m0, s26, 118272
    s_mov_b32 s32, 3407872
    ds_read_b64_tr_b16 a[0:1], v226 offset:50688
    ds_read_b64_tr_b16 a[2:3], v226 offset:51200
    ds_read_b128 v[200:203], v228 offset:2208
    v_fma_f32 v214, v214, v237, v238
    v_fma_f32 v215, v215, v237, v238
    v_cvt_pk_bf16_f32 v216, v208, v209
    v_cvt_pk_bf16_f32 v217, v210, v211
    v_mfma_f32_32x32x16_bf16 a[208:223], a[20:23], v[220:223], a[208:223]
    s_waitcnt lgkmcnt(6)
    ds_read_b64_tr_b16 a[4:5], v226 offset:50752
    ds_read_b64_tr_b16 a[6:7], v226 offset:51264
    buffer_load_dwordx4 v225, s[12:15], s32 offen offset:0  lds
    v_fma_f32 v212, v212, v180, v188
    v_fma_f32 v213, v213, v181, v189
    v_fma_f32 v214, v214, v182, v190
    v_mfma_f32_32x32x16_bf16 a[224:239], a[24:27], v[220:223], a[224:239]
    s_waitcnt lgkmcnt(5)
    ds_read_b64_tr_b16 a[8:9], v226 offset:50816
    ds_read_b64_tr_b16 a[10:11], v226 offset:51328
    ds_read_b128 v[204:207], v228 offset:2224
    v_fma_f32 v215, v215, v183, v191
    v_cvt_pk_bf16_f32 v218, v212, v213
    v_cvt_pk_bf16_f32 v219, v214, v215
    v_mfma_f32_32x32x16_bf16 a[240:255], a[28:31], v[220:223], a[240:255]
    s_waitcnt lgkmcnt(6)
    ds_read_b64_tr_b16 a[12:13], v226 offset:50880
    ds_read_b64_tr_b16 a[14:15], v226 offset:51392
    v_lshlrev_b32 v208, 16, v68
    v_and_b32 v209, 0xffff0000, v68
    v_lshlrev_b32 v210, 16, v69
    v_and_b32 v211, 0xffff0000, v69
    v_mfma_f32_32x32x16_bf16 v[112:127], a[0:3], v[216:219], v[112:127]
    s_waitcnt lgkmcnt(5)
    s_mov_b32 s32, 3472368
    ds_read_b64_tr_b16 a[16:17], v226 offset:50944
    ds_read_b64_tr_b16 a[18:19], v226 offset:51456
    ds_read_b128 v[176:179], v228 offset:2304
    v_fma_f32 v208, v208, v237, v238
    v_fma_f32 v209, v209, v237, v238
    v_fma_f32 v210, v210, v237, v238
    v_fma_f32 v211, v211, v237, v238
    v_mfma_f32_32x32x16_bf16 v[128:143], a[4:7], v[216:219], v[128:143]
    s_waitcnt lgkmcnt(6)
    ds_read_b64_tr_b16 a[20:21], v226 offset:51008
    ds_read_b64_tr_b16 a[22:23], v226 offset:51520
    buffer_load_dwordx4 v225, s[12:15], s32 offen offset:1040  lds
    v_lshlrev_b32 v212, 16, v70
    v_and_b32 v213, 0xffff0000, v70
    v_lshlrev_b32 v214, 16, v71
    v_mfma_f32_32x32x16_bf16 v[144:159], a[8:11], v[216:219], v[144:159]
    s_waitcnt lgkmcnt(5)
    ds_read_b64_tr_b16 a[24:25], v226 offset:51072
    ds_read_b64_tr_b16 a[26:27], v226 offset:51584
    ds_read_b128 v[180:183], v228 offset:2320
    v_and_b32 v215, 0xffff0000, v71
    v_fma_f32 v208, v208, v192, v200
    v_fma_f32 v209, v209, v193, v201
    v_mfma_f32_32x32x16_bf16 v[160:175], a[12:15], v[216:219], v[160:175]
    s_waitcnt lgkmcnt(6)
    ds_read_b64_tr_b16 a[28:29], v226 offset:51136
    ds_read_b64_tr_b16 a[30:31], v226 offset:51648
    v_fma_f32 v210, v210, v194, v202
    v_fma_f32 v211, v211, v195, v203
    v_fma_f32 v212, v212, v237, v238
    v_fma_f32 v213, v213, v237, v238
    v_mfma_f32_32x32x16_bf16 a[192:207], a[16:19], v[216:219], a[192:207]
    s_waitcnt lgkmcnt(5)
    s_mov_b32 s32, 3536864
    ds_read_b64_tr_b16 a[0:1], v226 offset:52768
    ds_read_b64_tr_b16 a[2:3], v226 offset:53280
    ds_read_b128 v[184:187], v228 offset:2336
    v_fma_f32 v214, v214, v237, v238
    v_fma_f32 v215, v215, v237, v238
    v_cvt_pk_bf16_f32 v220, v208, v209
    v_cvt_pk_bf16_f32 v221, v210, v211
    v_mfma_f32_32x32x16_bf16 a[208:223], a[20:23], v[216:219], a[208:223]
    s_waitcnt lgkmcnt(6)
    ds_read_b64_tr_b16 a[4:5], v226 offset:52832
    ds_read_b64_tr_b16 a[6:7], v226 offset:53344
    buffer_load_dwordx4 v225, s[12:15], s32 offen offset:2080  lds
    v_fma_f32 v212, v212, v196, v204
    v_fma_f32 v213, v213, v197, v205
    v_fma_f32 v214, v214, v198, v206
    v_mfma_f32_32x32x16_bf16 a[224:239], a[24:27], v[216:219], a[224:239]
    s_waitcnt lgkmcnt(5)
    ds_read_b64_tr_b16 a[8:9], v226 offset:52896
    ds_read_b64_tr_b16 a[10:11], v226 offset:53408
    ds_read_b128 v[188:191], v228 offset:2352
    v_fma_f32 v215, v215, v199, v207
    v_cvt_pk_bf16_f32 v222, v212, v213
    v_cvt_pk_bf16_f32 v223, v214, v215
    v_mfma_f32_32x32x16_bf16 a[240:255], a[28:31], v[216:219], a[240:255]
    s_waitcnt lgkmcnt(6)
    ds_read_b64_tr_b16 a[12:13], v226 offset:52960
    ds_read_b64_tr_b16 a[14:15], v226 offset:53472
    v_lshlrev_b32 v208, 16, v72
    v_and_b32 v209, 0xffff0000, v72
    v_lshlrev_b32 v210, 16, v73
    v_and_b32 v211, 0xffff0000, v73
    v_mfma_f32_32x32x16_bf16 v[112:127], a[0:3], v[220:223], v[112:127]
    s_waitcnt lgkmcnt(5)
    s_mov_b32 s32, 3601360
    ds_read_b64_tr_b16 a[16:17], v226 offset:53024
    ds_read_b64_tr_b16 a[18:19], v226 offset:53536
    ds_read_b128 v[192:195], v228 offset:2432
    v_fma_f32 v208, v208, v237, v238
    v_fma_f32 v209, v209, v237, v238
    v_fma_f32 v210, v210, v237, v238
    v_fma_f32 v211, v211, v237, v238
    v_mfma_f32_32x32x16_bf16 v[128:143], a[4:7], v[220:223], v[128:143]
    s_waitcnt lgkmcnt(6)
    ds_read_b64_tr_b16 a[20:21], v226 offset:53088
    ds_read_b64_tr_b16 a[22:23], v226 offset:53600
    buffer_load_dwordx4 v225, s[12:15], s32 offen offset:3120  lds
    v_lshlrev_b32 v212, 16, v74
    v_and_b32 v213, 0xffff0000, v74
    v_lshlrev_b32 v214, 16, v75
    v_mfma_f32_32x32x16_bf16 v[144:159], a[8:11], v[220:223], v[144:159]
    s_waitcnt lgkmcnt(5)
    ds_read_b64_tr_b16 a[24:25], v226 offset:53152
    ds_read_b64_tr_b16 a[26:27], v226 offset:53664
    ds_read_b128 v[196:199], v228 offset:2448
    v_and_b32 v215, 0xffff0000, v75
    v_fma_f32 v208, v208, v176, v184
    v_fma_f32 v209, v209, v177, v185
    v_mfma_f32_32x32x16_bf16 v[160:175], a[12:15], v[220:223], v[160:175]
    s_waitcnt lgkmcnt(6)
    ds_read_b64_tr_b16 a[28:29], v226 offset:53216
    ds_read_b64_tr_b16 a[30:31], v226 offset:53728
    v_fma_f32 v210, v210, v178, v186
    v_fma_f32 v211, v211, v179, v187
    v_fma_f32 v212, v212, v237, v238
    v_fma_f32 v213, v213, v237, v238
    v_mfma_f32_32x32x16_bf16 a[192:207], a[16:19], v[220:223], a[192:207]
    s_waitcnt lgkmcnt(5)
    s_add_u32 m0, s25, 0
    ds_read_b64_tr_b16 a[0:1], v227 offset:0
    ds_read_b64_tr_b16 a[2:3], v227 offset:512
    ds_read_b128 v[200:203], v228 offset:2464
    v_fma_f32 v214, v214, v237, v238
    v_fma_f32 v215, v215, v237, v238
    v_cvt_pk_bf16_f32 v216, v208, v209
    v_cvt_pk_bf16_f32 v217, v210, v211
    v_mfma_f32_32x32x16_bf16 a[208:223], a[20:23], v[220:223], a[208:223]
    s_waitcnt lgkmcnt(6)
    ds_read_b64_tr_b16 a[4:5], v227 offset:64
    ds_read_b64_tr_b16 a[6:7], v227 offset:576
    buffer_load_dwordx4 v246, s[4:7], s27 offen offset:0  lds
    v_fma_f32 v212, v212, v180, v188
    v_fma_f32 v213, v213, v181, v189
    v_fma_f32 v214, v214, v182, v190
    v_mfma_f32_32x32x16_bf16 a[224:239], a[24:27], v[220:223], a[224:239]
    s_waitcnt lgkmcnt(5)
    ds_read_b64_tr_b16 a[8:9], v227 offset:128
    ds_read_b64_tr_b16 a[10:11], v227 offset:640
    ds_read_b128 v[204:207], v228 offset:2480
    v_fma_f32 v215, v215, v183, v191
    v_cvt_pk_bf16_f32 v218, v212, v213
    v_cvt_pk_bf16_f32 v219, v214, v215
    v_mfma_f32_32x32x16_bf16 a[240:255], a[28:31], v[220:223], a[240:255]
    s_waitcnt lgkmcnt(6)
    ds_read_b64_tr_b16 a[12:13], v227 offset:192
    ds_read_b64_tr_b16 a[14:15], v227 offset:704
    v_lshlrev_b32 v208, 16, v76
    v_and_b32 v209, 0xffff0000, v76
    v_lshlrev_b32 v210, 16, v77
    v_and_b32 v211, 0xffff0000, v77
    v_mfma_f32_32x32x16_bf16 v[112:127], a[0:3], v[216:219], v[112:127]
    s_waitcnt lgkmcnt(5)
    s_add_u32 m0, s25, 544
    ds_read_b64_tr_b16 a[16:17], v227 offset:256
    ds_read_b64_tr_b16 a[18:19], v227 offset:768
    ds_read_b128 v[176:179], v228 offset:2560
    v_fma_f32 v208, v208, v237, v238
    v_fma_f32 v209, v209, v237, v238
    v_fma_f32 v210, v210, v237, v238
    v_fma_f32 v211, v211, v237, v238
    v_mfma_f32_32x32x16_bf16 v[128:143], a[4:7], v[216:219], v[128:143]
    s_waitcnt lgkmcnt(6)
    ds_read_b64_tr_b16 a[20:21], v227 offset:320
    ds_read_b64_tr_b16 a[22:23], v227 offset:832
    buffer_load_dwordx4 v246, s[4:7], s27 offen offset:512  lds
    v_lshlrev_b32 v212, 16, v78
    v_and_b32 v213, 0xffff0000, v78
    v_lshlrev_b32 v214, 16, v79
    v_mfma_f32_32x32x16_bf16 v[144:159], a[8:11], v[216:219], v[144:159]
    s_waitcnt lgkmcnt(5)
    ds_read_b64_tr_b16 a[24:25], v227 offset:384
    ds_read_b64_tr_b16 a[26:27], v227 offset:896
    ds_read_b128 v[180:183], v228 offset:2576
    v_and_b32 v215, 0xffff0000, v79
    v_fma_f32 v208, v208, v192, v200
    v_fma_f32 v209, v209, v193, v201
    v_mfma_f32_32x32x16_bf16 v[160:175], a[12:15], v[216:219], v[160:175]
    s_waitcnt lgkmcnt(6)
    ds_read_b64_tr_b16 a[28:29], v227 offset:448
    ds_read_b64_tr_b16 a[30:31], v227 offset:960
    v_fma_f32 v210, v210, v194, v202
    v_fma_f32 v211, v211, v195, v203
    v_fma_f32 v212, v212, v237, v238
    v_fma_f32 v213, v213, v237, v238
    v_mfma_f32_32x32x16_bf16 a[192:207], a[16:19], v[216:219], a[192:207]
    s_waitcnt lgkmcnt(5)
    s_add_u32 m0, s25, 1088
    ds_read_b64_tr_b16 a[0:1], v227 offset:2080
    ds_read_b64_tr_b16 a[2:3], v227 offset:2592
    ds_read_b128 v[184:187], v228 offset:2592
    v_fma_f32 v214, v214, v237, v238
    v_fma_f32 v215, v215, v237, v238
    v_cvt_pk_bf16_f32 v220, v208, v209
    v_cvt_pk_bf16_f32 v221, v210, v211
    v_mfma_f32_32x32x16_bf16 a[208:223], a[20:23], v[216:219], a[208:223]
    s_waitcnt lgkmcnt(6)
    ds_read_b64_tr_b16 a[4:5], v227 offset:2144
    ds_read_b64_tr_b16 a[6:7], v227 offset:2656
    buffer_load_dwordx4 v246, s[4:7], s27 offen offset:1024  lds
    v_fma_f32 v212, v212, v196, v204
    v_fma_f32 v213, v213, v197, v205
    v_fma_f32 v214, v214, v198, v206
    v_mfma_f32_32x32x16_bf16 a[224:239], a[24:27], v[216:219], a[224:239]
    s_waitcnt lgkmcnt(5)
    ds_read_b64_tr_b16 a[8:9], v227 offset:2208
    ds_read_b64_tr_b16 a[10:11], v227 offset:2720
    ds_read_b128 v[188:191], v228 offset:2608
    v_fma_f32 v215, v215, v199, v207
    v_cvt_pk_bf16_f32 v222, v212, v213
    v_cvt_pk_bf16_f32 v223, v214, v215
    v_mfma_f32_32x32x16_bf16 a[240:255], a[28:31], v[216:219], a[240:255]
    s_waitcnt lgkmcnt(6)
    ds_read_b64_tr_b16 a[12:13], v227 offset:2272
    ds_read_b64_tr_b16 a[14:15], v227 offset:2784
    v_lshlrev_b32 v208, 16, v80
    v_and_b32 v209, 0xffff0000, v80
    v_lshlrev_b32 v210, 16, v81
    v_and_b32 v211, 0xffff0000, v81
    v_mfma_f32_32x32x16_bf16 v[112:127], a[0:3], v[220:223], v[112:127]
    s_waitcnt lgkmcnt(5)
    s_add_u32 m0, s25, 1632
    ds_read_b64_tr_b16 a[16:17], v227 offset:2336
    ds_read_b64_tr_b16 a[18:19], v227 offset:2848
    ds_read_b128 v[192:195], v228 offset:2688
    v_fma_f32 v208, v208, v237, v238
    v_fma_f32 v209, v209, v237, v238
    v_fma_f32 v210, v210, v237, v238
    v_fma_f32 v211, v211, v237, v238
    v_mfma_f32_32x32x16_bf16 v[128:143], a[4:7], v[220:223], v[128:143]
    s_waitcnt lgkmcnt(6)
    ds_read_b64_tr_b16 a[20:21], v227 offset:2400
    ds_read_b64_tr_b16 a[22:23], v227 offset:2912
    buffer_load_dwordx4 v246, s[4:7], s27 offen offset:1536  lds
    v_lshlrev_b32 v212, 16, v82
    v_and_b32 v213, 0xffff0000, v82
    v_lshlrev_b32 v214, 16, v83
    v_mfma_f32_32x32x16_bf16 v[144:159], a[8:11], v[220:223], v[144:159]
    s_waitcnt lgkmcnt(5)
    s_add_u32 s27, s27, 8192
    ds_read_b64_tr_b16 a[24:25], v227 offset:2464
    ds_read_b64_tr_b16 a[26:27], v227 offset:2976
    ds_read_b128 v[196:199], v228 offset:2704
    v_and_b32 v215, 0xffff0000, v83
    v_fma_f32 v208, v208, v176, v184
    v_fma_f32 v209, v209, v177, v185
    v_mfma_f32_32x32x16_bf16 v[160:175], a[12:15], v[220:223], v[160:175]
    s_waitcnt vmcnt(12) lgkmcnt(6)
    s_barrier
    ds_read_b64_tr_b16 a[28:29], v227 offset:2528
    ds_read_b64_tr_b16 a[30:31], v227 offset:3040
    v_fma_f32 v210, v210, v178, v186
    v_fma_f32 v211, v211, v179, v187
    v_fma_f32 v212, v212, v237, v238
    v_fma_f32 v213, v213, v237, v238
    v_mfma_f32_32x32x16_bf16 a[192:207], a[16:19], v[220:223], a[192:207]
    s_waitcnt lgkmcnt(5)
    s_add_u32 m0, s25, 16896
    ds_read_b64_tr_b16 a[0:1], v226 offset:33792
    ds_read_b64_tr_b16 a[2:3], v226 offset:34304
    ds_read_b128 v[200:203], v228 offset:2720
    v_fma_f32 v214, v214, v237, v238
    v_fma_f32 v215, v215, v237, v238
    v_cvt_pk_bf16_f32 v216, v208, v209
    v_cvt_pk_bf16_f32 v217, v210, v211
    v_mfma_f32_32x32x16_bf16 a[208:223], a[20:23], v[220:223], a[208:223]
    s_waitcnt lgkmcnt(6)
    ds_read_b64_tr_b16 a[4:5], v226 offset:33856
    ds_read_b64_tr_b16 a[6:7], v226 offset:34368
    buffer_load_dwordx4 v246, s[4:7], s27 offen offset:0  lds
    v_fma_f32 v212, v212, v180, v188
    v_fma_f32 v213, v213, v181, v189
    v_fma_f32 v214, v214, v182, v190
    v_mfma_f32_32x32x16_bf16 a[224:239], a[24:27], v[220:223], a[224:239]
    s_waitcnt lgkmcnt(5)
    ds_read_b64_tr_b16 a[8:9], v226 offset:33920
    ds_read_b64_tr_b16 a[10:11], v226 offset:34432
    ds_read_b128 v[204:207], v228 offset:2736
    v_fma_f32 v215, v215, v183, v191
    v_cvt_pk_bf16_f32 v218, v212, v213
    v_cvt_pk_bf16_f32 v219, v214, v215
    v_mfma_f32_32x32x16_bf16 a[240:255], a[28:31], v[220:223], a[240:255]
    s_waitcnt lgkmcnt(6)
    ds_read_b64_tr_b16 a[12:13], v226 offset:33984
    ds_read_b64_tr_b16 a[14:15], v226 offset:34496
    v_lshlrev_b32 v208, 16, v84
    v_and_b32 v209, 0xffff0000, v84
    v_lshlrev_b32 v210, 16, v85
    v_and_b32 v211, 0xffff0000, v85
    v_mfma_f32_32x32x16_bf16 v[112:127], a[0:3], v[216:219], v[112:127]
    s_waitcnt lgkmcnt(5)
    s_add_u32 m0, s25, 17440
    ds_read_b64_tr_b16 a[16:17], v226 offset:34048
    ds_read_b64_tr_b16 a[18:19], v226 offset:34560
    ds_read_b128 v[176:179], v228 offset:2816
    v_fma_f32 v208, v208, v237, v238
    v_fma_f32 v209, v209, v237, v238
    v_fma_f32 v210, v210, v237, v238
    v_fma_f32 v211, v211, v237, v238
    v_mfma_f32_32x32x16_bf16 v[128:143], a[4:7], v[216:219], v[128:143]
    s_waitcnt lgkmcnt(6)
    ds_read_b64_tr_b16 a[20:21], v226 offset:34112
    ds_read_b64_tr_b16 a[22:23], v226 offset:34624
    buffer_load_dwordx4 v246, s[4:7], s27 offen offset:512  lds
    v_lshlrev_b32 v212, 16, v86
    v_and_b32 v213, 0xffff0000, v86
    v_lshlrev_b32 v214, 16, v87
    v_mfma_f32_32x32x16_bf16 v[144:159], a[8:11], v[216:219], v[144:159]
    s_waitcnt lgkmcnt(5)
    ds_read_b64_tr_b16 a[24:25], v226 offset:34176
    ds_read_b64_tr_b16 a[26:27], v226 offset:34688
    ds_read_b128 v[180:183], v228 offset:2832
    v_and_b32 v215, 0xffff0000, v87
    v_fma_f32 v208, v208, v192, v200
    v_fma_f32 v209, v209, v193, v201
    v_mfma_f32_32x32x16_bf16 v[160:175], a[12:15], v[216:219], v[160:175]
    s_waitcnt lgkmcnt(6)
    ds_read_b64_tr_b16 a[28:29], v226 offset:34240
    ds_read_b64_tr_b16 a[30:31], v226 offset:34752
    v_fma_f32 v210, v210, v194, v202
    v_fma_f32 v211, v211, v195, v203
    v_fma_f32 v212, v212, v237, v238
    v_fma_f32 v213, v213, v237, v238
    v_mfma_f32_32x32x16_bf16 a[192:207], a[16:19], v[216:219], a[192:207]
    s_waitcnt lgkmcnt(5)
    s_add_u32 m0, s25, 17984
    ds_read_b64_tr_b16 a[0:1], v226 offset:35872
    ds_read_b64_tr_b16 a[2:3], v226 offset:36384
    ds_read_b128 v[184:187], v228 offset:2848
    v_fma_f32 v214, v214, v237, v238
    v_fma_f32 v215, v215, v237, v238
    v_cvt_pk_bf16_f32 v220, v208, v209
    v_cvt_pk_bf16_f32 v221, v210, v211
    v_mfma_f32_32x32x16_bf16 a[208:223], a[20:23], v[216:219], a[208:223]
    s_waitcnt lgkmcnt(6)
    ds_read_b64_tr_b16 a[4:5], v226 offset:35936
    ds_read_b64_tr_b16 a[6:7], v226 offset:36448
    buffer_load_dwordx4 v246, s[4:7], s27 offen offset:1024  lds
    v_fma_f32 v212, v212, v196, v204
    v_fma_f32 v213, v213, v197, v205
    v_fma_f32 v214, v214, v198, v206
    v_mfma_f32_32x32x16_bf16 a[224:239], a[24:27], v[216:219], a[224:239]
    s_waitcnt lgkmcnt(5)
    ds_read_b64_tr_b16 a[8:9], v226 offset:36000
    ds_read_b64_tr_b16 a[10:11], v226 offset:36512
    ds_read_b128 v[188:191], v228 offset:2864
    v_fma_f32 v215, v215, v199, v207
    v_cvt_pk_bf16_f32 v222, v212, v213
    v_cvt_pk_bf16_f32 v223, v214, v215
    v_mfma_f32_32x32x16_bf16 a[240:255], a[28:31], v[216:219], a[240:255]
    s_waitcnt lgkmcnt(6)
    ds_read_b64_tr_b16 a[12:13], v226 offset:36064
    ds_read_b64_tr_b16 a[14:15], v226 offset:36576
    v_lshlrev_b32 v208, 16, v88
    v_and_b32 v209, 0xffff0000, v88
    v_lshlrev_b32 v210, 16, v89
    v_and_b32 v211, 0xffff0000, v89
    v_mfma_f32_32x32x16_bf16 v[112:127], a[0:3], v[220:223], v[112:127]
    s_waitcnt lgkmcnt(5)
    s_add_u32 m0, s25, 18528
    ds_read_b64_tr_b16 a[16:17], v226 offset:36128
    ds_read_b64_tr_b16 a[18:19], v226 offset:36640
    ds_read_b128 v[192:195], v228 offset:2944
    v_fma_f32 v208, v208, v237, v238
    v_fma_f32 v209, v209, v237, v238
    v_fma_f32 v210, v210, v237, v238
    v_fma_f32 v211, v211, v237, v238
    v_mfma_f32_32x32x16_bf16 v[128:143], a[4:7], v[220:223], v[128:143]
    s_waitcnt lgkmcnt(6)
    ds_read_b64_tr_b16 a[20:21], v226 offset:36192
    ds_read_b64_tr_b16 a[22:23], v226 offset:36704
    buffer_load_dwordx4 v246, s[4:7], s27 offen offset:1536  lds
    v_lshlrev_b32 v212, 16, v90
    v_and_b32 v213, 0xffff0000, v90
    v_lshlrev_b32 v214, 16, v91
    v_mfma_f32_32x32x16_bf16 v[144:159], a[8:11], v[220:223], v[144:159]
    s_waitcnt lgkmcnt(5)
    s_add_u32 s27, s27, 24576
    ds_read_b64_tr_b16 a[24:25], v226 offset:36256
    ds_read_b64_tr_b16 a[26:27], v226 offset:36768
    ds_read_b128 v[196:199], v228 offset:2960
    v_and_b32 v215, 0xffff0000, v91
    v_fma_f32 v208, v208, v176, v184
    v_fma_f32 v209, v209, v177, v185
    v_mfma_f32_32x32x16_bf16 v[160:175], a[12:15], v[220:223], v[160:175]
    s_waitcnt lgkmcnt(6)
    ds_read_b64_tr_b16 a[28:29], v226 offset:36320
    ds_read_b64_tr_b16 a[30:31], v226 offset:36832
    v_fma_f32 v210, v210, v178, v186
    v_fma_f32 v211, v211, v179, v187
    v_fma_f32 v212, v212, v237, v238
    v_fma_f32 v213, v213, v237, v238
    v_mfma_f32_32x32x16_bf16 a[192:207], a[16:19], v[220:223], a[192:207]
    s_waitcnt lgkmcnt(5)
    s_add_u32 m0, s25, 50688
    ds_read_b64_tr_b16 a[0:1], v227 offset:16896
    ds_read_b64_tr_b16 a[2:3], v227 offset:17408
    ds_read_b128 v[200:203], v228 offset:2976
    v_fma_f32 v214, v214, v237, v238
    v_fma_f32 v215, v215, v237, v238
    v_cvt_pk_bf16_f32 v216, v208, v209
    v_cvt_pk_bf16_f32 v217, v210, v211
    v_mfma_f32_32x32x16_bf16 a[208:223], a[20:23], v[220:223], a[208:223]
    s_waitcnt lgkmcnt(6)
    ds_read_b64_tr_b16 a[4:5], v227 offset:16960
    ds_read_b64_tr_b16 a[6:7], v227 offset:17472
    buffer_load_dwordx4 v246, s[4:7], s27 offen offset:0  lds
    v_fma_f32 v212, v212, v180, v188
    v_fma_f32 v213, v213, v181, v189
    v_fma_f32 v214, v214, v182, v190
    v_mfma_f32_32x32x16_bf16 a[224:239], a[24:27], v[220:223], a[224:239]
    s_waitcnt lgkmcnt(5)
    ds_read_b64_tr_b16 a[8:9], v227 offset:17024
    ds_read_b64_tr_b16 a[10:11], v227 offset:17536
    ds_read_b128 v[204:207], v228 offset:2992
    v_fma_f32 v215, v215, v183, v191
    v_cvt_pk_bf16_f32 v218, v212, v213
    v_cvt_pk_bf16_f32 v219, v214, v215
    v_mfma_f32_32x32x16_bf16 a[240:255], a[28:31], v[220:223], a[240:255]
    s_waitcnt lgkmcnt(6)
    ds_read_b64_tr_b16 a[12:13], v227 offset:17088
    ds_read_b64_tr_b16 a[14:15], v227 offset:17600
    v_lshlrev_b32 v208, 16, v92
    v_and_b32 v209, 0xffff0000, v92
    v_lshlrev_b32 v210, 16, v93
    v_and_b32 v211, 0xffff0000, v93
    v_mfma_f32_32x32x16_bf16 v[112:127], a[0:3], v[216:219], v[112:127]
    s_waitcnt lgkmcnt(5)
    s_add_u32 m0, s25, 51232
    ds_read_b64_tr_b16 a[16:17], v227 offset:17152
    ds_read_b64_tr_b16 a[18:19], v227 offset:17664
    ds_read_b128 v[176:179], v228 offset:3072
    v_fma_f32 v208, v208, v237, v238
    v_fma_f32 v209, v209, v237, v238
    v_fma_f32 v210, v210, v237, v238
    v_fma_f32 v211, v211, v237, v238
    v_mfma_f32_32x32x16_bf16 v[128:143], a[4:7], v[216:219], v[128:143]
    s_waitcnt lgkmcnt(6)
    ds_read_b64_tr_b16 a[20:21], v227 offset:17216
    ds_read_b64_tr_b16 a[22:23], v227 offset:17728
    buffer_load_dwordx4 v246, s[4:7], s27 offen offset:512  lds
    v_lshlrev_b32 v212, 16, v94
    v_and_b32 v213, 0xffff0000, v94
    v_lshlrev_b32 v214, 16, v95
    v_mfma_f32_32x32x16_bf16 v[144:159], a[8:11], v[216:219], v[144:159]
    s_waitcnt lgkmcnt(5)
    ds_read_b64_tr_b16 a[24:25], v227 offset:17280
    ds_read_b64_tr_b16 a[26:27], v227 offset:17792
    ds_read_b128 v[180:183], v228 offset:3088
    v_and_b32 v215, 0xffff0000, v95
    v_fma_f32 v208, v208, v192, v200
    v_fma_f32 v209, v209, v193, v201
    v_mfma_f32_32x32x16_bf16 v[160:175], a[12:15], v[216:219], v[160:175]
    s_waitcnt lgkmcnt(6)
    ds_read_b64_tr_b16 a[28:29], v227 offset:17344
    ds_read_b64_tr_b16 a[30:31], v227 offset:17856
    v_fma_f32 v210, v210, v194, v202
    v_fma_f32 v211, v211, v195, v203
    v_fma_f32 v212, v212, v237, v238
    v_fma_f32 v213, v213, v237, v238
    v_mfma_f32_32x32x16_bf16 a[192:207], a[16:19], v[216:219], a[192:207]
    s_waitcnt lgkmcnt(5)
    s_add_u32 m0, s25, 51776
    ds_read_b64_tr_b16 a[0:1], v227 offset:18976
    ds_read_b64_tr_b16 a[2:3], v227 offset:19488
    ds_read_b128 v[184:187], v228 offset:3104
    v_fma_f32 v214, v214, v237, v238
    v_fma_f32 v215, v215, v237, v238
    v_cvt_pk_bf16_f32 v220, v208, v209
    v_cvt_pk_bf16_f32 v221, v210, v211
    v_mfma_f32_32x32x16_bf16 a[208:223], a[20:23], v[216:219], a[208:223]
    s_waitcnt lgkmcnt(6)
    ds_read_b64_tr_b16 a[4:5], v227 offset:19040
    ds_read_b64_tr_b16 a[6:7], v227 offset:19552
    buffer_load_dwordx4 v246, s[4:7], s27 offen offset:1024  lds
    v_fma_f32 v212, v212, v196, v204
    v_fma_f32 v213, v213, v197, v205
    v_fma_f32 v214, v214, v198, v206
    v_mfma_f32_32x32x16_bf16 a[224:239], a[24:27], v[216:219], a[224:239]
    s_waitcnt lgkmcnt(5)
    ds_read_b64_tr_b16 a[8:9], v227 offset:19104
    ds_read_b64_tr_b16 a[10:11], v227 offset:19616
    ds_read_b128 v[188:191], v228 offset:3120
    v_fma_f32 v215, v215, v199, v207
    v_cvt_pk_bf16_f32 v222, v212, v213
    v_cvt_pk_bf16_f32 v223, v214, v215
    v_mfma_f32_32x32x16_bf16 a[240:255], a[28:31], v[216:219], a[240:255]
    s_waitcnt lgkmcnt(6)
    ds_read_b64_tr_b16 a[12:13], v227 offset:19168
    ds_read_b64_tr_b16 a[14:15], v227 offset:19680
    v_lshlrev_b32 v208, 16, v96
    v_and_b32 v209, 0xffff0000, v96
    v_lshlrev_b32 v210, 16, v97
    v_and_b32 v211, 0xffff0000, v97
    v_mfma_f32_32x32x16_bf16 v[112:127], a[0:3], v[220:223], v[112:127]
    s_waitcnt lgkmcnt(5)
    s_add_u32 m0, s25, 52320
    ds_read_b64_tr_b16 a[16:17], v227 offset:19232
    ds_read_b64_tr_b16 a[18:19], v227 offset:19744
    ds_read_b128 v[192:195], v228 offset:3200
    v_fma_f32 v208, v208, v237, v238
    v_fma_f32 v209, v209, v237, v238
    v_fma_f32 v210, v210, v237, v238
    v_fma_f32 v211, v211, v237, v238
    v_mfma_f32_32x32x16_bf16 v[128:143], a[4:7], v[220:223], v[128:143]
    s_waitcnt lgkmcnt(6)
    ds_read_b64_tr_b16 a[20:21], v227 offset:19296
    ds_read_b64_tr_b16 a[22:23], v227 offset:19808
    buffer_load_dwordx4 v246, s[4:7], s27 offen offset:1536  lds
    v_lshlrev_b32 v212, 16, v98
    v_and_b32 v213, 0xffff0000, v98
    v_lshlrev_b32 v214, 16, v99
    v_mfma_f32_32x32x16_bf16 v[144:159], a[8:11], v[220:223], v[144:159]
    s_waitcnt lgkmcnt(5)
    s_add_u32 s27, s27, 8192
    ds_read_b64_tr_b16 a[24:25], v227 offset:19360
    ds_read_b64_tr_b16 a[26:27], v227 offset:19872
    ds_read_b128 v[196:199], v228 offset:3216
    v_and_b32 v215, 0xffff0000, v99
    v_fma_f32 v208, v208, v176, v184
    v_fma_f32 v209, v209, v177, v185
    v_mfma_f32_32x32x16_bf16 v[160:175], a[12:15], v[220:223], v[160:175]
    s_waitcnt vmcnt(12) lgkmcnt(6)
    s_barrier
    ds_read_b64_tr_b16 a[28:29], v227 offset:19424
    ds_read_b64_tr_b16 a[30:31], v227 offset:19936
    v_fma_f32 v210, v210, v178, v186
    v_fma_f32 v211, v211, v179, v187
    v_fma_f32 v212, v212, v237, v238
    v_fma_f32 v213, v213, v237, v238
    v_mfma_f32_32x32x16_bf16 a[192:207], a[16:19], v[220:223], a[192:207]
    s_waitcnt lgkmcnt(5)
    s_add_u32 m0, s25, 67584
    ds_read_b64_tr_b16 a[0:1], v227 offset:33792
    ds_read_b64_tr_b16 a[2:3], v227 offset:34304
    ds_read_b128 v[200:203], v228 offset:3232
    v_fma_f32 v214, v214, v237, v238
    v_fma_f32 v215, v215, v237, v238
    v_cvt_pk_bf16_f32 v216, v208, v209
    v_cvt_pk_bf16_f32 v217, v210, v211
    v_mfma_f32_32x32x16_bf16 a[208:223], a[20:23], v[220:223], a[208:223]
    s_waitcnt lgkmcnt(6)
    ds_read_b64_tr_b16 a[4:5], v227 offset:33856
    ds_read_b64_tr_b16 a[6:7], v227 offset:34368
    buffer_load_dwordx4 v247, s[8:11], s28 offen offset:0  lds
    v_fma_f32 v212, v212, v180, v188
    v_fma_f32 v213, v213, v181, v189
    v_fma_f32 v214, v214, v182, v190
    v_mfma_f32_32x32x16_bf16 a[224:239], a[24:27], v[220:223], a[224:239]
    s_waitcnt lgkmcnt(5)
    ds_read_b64_tr_b16 a[8:9], v227 offset:33920
    ds_read_b64_tr_b16 a[10:11], v227 offset:34432
    ds_read_b128 v[204:207], v228 offset:3248
    v_fma_f32 v215, v215, v183, v191
    v_cvt_pk_bf16_f32 v218, v212, v213
    v_cvt_pk_bf16_f32 v219, v214, v215
    v_mfma_f32_32x32x16_bf16 a[240:255], a[28:31], v[220:223], a[240:255]
    s_waitcnt lgkmcnt(6)
    ds_read_b64_tr_b16 a[12:13], v227 offset:33984
    ds_read_b64_tr_b16 a[14:15], v227 offset:34496
    v_lshlrev_b32 v208, 16, v100
    v_and_b32 v209, 0xffff0000, v100
    v_lshlrev_b32 v210, 16, v101
    v_and_b32 v211, 0xffff0000, v101
    v_mfma_f32_32x32x16_bf16 v[112:127], a[0:3], v[216:219], v[112:127]
    s_waitcnt lgkmcnt(5)
    s_add_u32 m0, s25, 68128
    ds_read_b64_tr_b16 a[16:17], v227 offset:34048
    ds_read_b64_tr_b16 a[18:19], v227 offset:34560
    ds_read_b128 v[176:179], v228 offset:3328
    v_fma_f32 v208, v208, v237, v238
    v_fma_f32 v209, v209, v237, v238
    v_fma_f32 v210, v210, v237, v238
    v_fma_f32 v211, v211, v237, v238
    v_mfma_f32_32x32x16_bf16 v[128:143], a[4:7], v[216:219], v[128:143]
    s_waitcnt lgkmcnt(6)
    ds_read_b64_tr_b16 a[20:21], v227 offset:34112
    ds_read_b64_tr_b16 a[22:23], v227 offset:34624
    buffer_load_dwordx4 v247, s[8:11], s28 offen offset:512  lds
    v_lshlrev_b32 v212, 16, v102
    v_and_b32 v213, 0xffff0000, v102
    v_lshlrev_b32 v214, 16, v103
    v_mfma_f32_32x32x16_bf16 v[144:159], a[8:11], v[216:219], v[144:159]
    s_waitcnt lgkmcnt(5)
    ds_read_b64_tr_b16 a[24:25], v227 offset:34176
    ds_read_b64_tr_b16 a[26:27], v227 offset:34688
    ds_read_b128 v[180:183], v228 offset:3344
    v_and_b32 v215, 0xffff0000, v103
    v_fma_f32 v208, v208, v192, v200
    v_fma_f32 v209, v209, v193, v201
    v_mfma_f32_32x32x16_bf16 v[160:175], a[12:15], v[216:219], v[160:175]
    s_waitcnt lgkmcnt(6)
    ds_read_b64_tr_b16 a[28:29], v227 offset:34240
    ds_read_b64_tr_b16 a[30:31], v227 offset:34752
    v_fma_f32 v210, v210, v194, v202
    v_fma_f32 v211, v211, v195, v203
    v_fma_f32 v212, v212, v237, v238
    v_fma_f32 v213, v213, v237, v238
    v_mfma_f32_32x32x16_bf16 a[192:207], a[16:19], v[216:219], a[192:207]
    s_waitcnt lgkmcnt(5)
    s_add_u32 m0, s25, 68672
    ds_read_b64_tr_b16 a[0:1], v227 offset:35872
    ds_read_b64_tr_b16 a[2:3], v227 offset:36384
    ds_read_b128 v[184:187], v228 offset:3360
    v_fma_f32 v214, v214, v237, v238
    v_fma_f32 v215, v215, v237, v238
    v_cvt_pk_bf16_f32 v220, v208, v209
    v_cvt_pk_bf16_f32 v221, v210, v211
    v_mfma_f32_32x32x16_bf16 a[208:223], a[20:23], v[216:219], a[208:223]
    s_waitcnt lgkmcnt(6)
    ds_read_b64_tr_b16 a[4:5], v227 offset:35936
    ds_read_b64_tr_b16 a[6:7], v227 offset:36448
    buffer_load_dwordx4 v247, s[8:11], s28 offen offset:1024  lds
    v_fma_f32 v212, v212, v196, v204
    v_fma_f32 v213, v213, v197, v205
    v_fma_f32 v214, v214, v198, v206
    v_mfma_f32_32x32x16_bf16 a[224:239], a[24:27], v[216:219], a[224:239]
    s_waitcnt lgkmcnt(5)
    ds_read_b64_tr_b16 a[8:9], v227 offset:36000
    ds_read_b64_tr_b16 a[10:11], v227 offset:36512
    ds_read_b128 v[188:191], v228 offset:3376
    v_fma_f32 v215, v215, v199, v207
    v_cvt_pk_bf16_f32 v222, v212, v213
    v_cvt_pk_bf16_f32 v223, v214, v215
    v_mfma_f32_32x32x16_bf16 a[240:255], a[28:31], v[216:219], a[240:255]
    s_waitcnt lgkmcnt(6)
    ds_read_b64_tr_b16 a[12:13], v227 offset:36064
    ds_read_b64_tr_b16 a[14:15], v227 offset:36576
    v_lshlrev_b32 v208, 16, v104
    v_and_b32 v209, 0xffff0000, v104
    v_lshlrev_b32 v210, 16, v105
    v_and_b32 v211, 0xffff0000, v105
    v_mfma_f32_32x32x16_bf16 v[112:127], a[0:3], v[220:223], v[112:127]
    s_waitcnt lgkmcnt(5)
    s_add_u32 m0, s25, 69216
    ds_read_b64_tr_b16 a[16:17], v227 offset:36128
    ds_read_b64_tr_b16 a[18:19], v227 offset:36640
    ds_read_b128 v[192:195], v228 offset:3456
    v_fma_f32 v208, v208, v237, v238
    v_fma_f32 v209, v209, v237, v238
    v_fma_f32 v210, v210, v237, v238
    v_fma_f32 v211, v211, v237, v238
    v_mfma_f32_32x32x16_bf16 v[128:143], a[4:7], v[220:223], v[128:143]
    s_waitcnt lgkmcnt(6)
    ds_read_b64_tr_b16 a[20:21], v227 offset:36192
    ds_read_b64_tr_b16 a[22:23], v227 offset:36704
    buffer_load_dwordx4 v247, s[8:11], s28 offen offset:1536  lds
    v_lshlrev_b32 v212, 16, v106
    v_and_b32 v213, 0xffff0000, v106
    v_lshlrev_b32 v214, 16, v107
    v_mfma_f32_32x32x16_bf16 v[144:159], a[8:11], v[220:223], v[144:159]
    s_waitcnt lgkmcnt(5)
    s_add_u32 s28, s28, 256
    ds_read_b64_tr_b16 a[24:25], v227 offset:36256
    ds_read_b64_tr_b16 a[26:27], v227 offset:36768
    ds_read_b128 v[196:199], v228 offset:3472
    v_and_b32 v215, 0xffff0000, v107
    v_fma_f32 v208, v208, v176, v184
    v_fma_f32 v209, v209, v177, v185
    v_mfma_f32_32x32x16_bf16 v[160:175], a[12:15], v[220:223], v[160:175]
    s_waitcnt lgkmcnt(6)
    ds_read_b64_tr_b16 a[28:29], v227 offset:36320
    ds_read_b64_tr_b16 a[30:31], v227 offset:36832
    v_fma_f32 v210, v210, v178, v186
    v_fma_f32 v211, v211, v179, v187
    v_fma_f32 v212, v212, v237, v238
    v_fma_f32 v213, v213, v237, v238
    v_mfma_f32_32x32x16_bf16 a[192:207], a[16:19], v[220:223], a[192:207]
    s_waitcnt lgkmcnt(5)
    s_add_u32 m0, s25, 33792
    ds_read_b64_tr_b16 a[0:1], v227 offset:50688
    ds_read_b64_tr_b16 a[2:3], v227 offset:51200
    ds_read_b128 v[200:203], v228 offset:3488
    v_fma_f32 v214, v214, v237, v238
    v_fma_f32 v215, v215, v237, v238
    v_cvt_pk_bf16_f32 v216, v208, v209
    v_cvt_pk_bf16_f32 v217, v210, v211
    v_mfma_f32_32x32x16_bf16 a[208:223], a[20:23], v[220:223], a[208:223]
    s_waitcnt lgkmcnt(6)
    ds_read_b64_tr_b16 a[4:5], v227 offset:50752
    ds_read_b64_tr_b16 a[6:7], v227 offset:51264
    buffer_load_dwordx4 v246, s[4:7], s27 offen offset:0  lds
    v_fma_f32 v212, v212, v180, v188
    v_fma_f32 v213, v213, v181, v189
    v_fma_f32 v214, v214, v182, v190
    v_mfma_f32_32x32x16_bf16 a[224:239], a[24:27], v[220:223], a[224:239]
    s_waitcnt lgkmcnt(5)
    ds_read_b64_tr_b16 a[8:9], v227 offset:50816
    ds_read_b64_tr_b16 a[10:11], v227 offset:51328
    ds_read_b128 v[204:207], v228 offset:3504
    v_fma_f32 v215, v215, v183, v191
    v_cvt_pk_bf16_f32 v218, v212, v213
    v_cvt_pk_bf16_f32 v219, v214, v215
    v_mfma_f32_32x32x16_bf16 a[240:255], a[28:31], v[220:223], a[240:255]
    s_waitcnt lgkmcnt(6)
    ds_read_b64_tr_b16 a[12:13], v227 offset:50880
    ds_read_b64_tr_b16 a[14:15], v227 offset:51392
    v_lshlrev_b32 v208, 16, v108
    v_and_b32 v209, 0xffff0000, v108
    v_lshlrev_b32 v210, 16, v109
    v_and_b32 v211, 0xffff0000, v109
    v_mfma_f32_32x32x16_bf16 v[112:127], a[0:3], v[216:219], v[112:127]
    s_waitcnt lgkmcnt(5)
    s_add_u32 m0, s25, 34336
    ds_read_b64_tr_b16 a[16:17], v227 offset:50944
    ds_read_b64_tr_b16 a[18:19], v227 offset:51456
    v_fma_f32 v208, v208, v237, v238
    v_fma_f32 v209, v209, v237, v238
    v_fma_f32 v210, v210, v237, v238
    v_fma_f32 v211, v211, v237, v238
    v_mfma_f32_32x32x16_bf16 v[128:143], a[4:7], v[216:219], v[128:143]
    s_waitcnt lgkmcnt(5)
    ds_read_b64_tr_b16 a[20:21], v227 offset:51008
    ds_read_b64_tr_b16 a[22:23], v227 offset:51520
    buffer_load_dwordx4 v246, s[4:7], s27 offen offset:512  lds
    v_lshlrev_b32 v212, 16, v110
    v_and_b32 v213, 0xffff0000, v110
    v_lshlrev_b32 v214, 16, v111
    v_mfma_f32_32x32x16_bf16 v[144:159], a[8:11], v[216:219], v[144:159]
    s_waitcnt lgkmcnt(4)
    ds_read_b64_tr_b16 a[24:25], v227 offset:51072
    ds_read_b64_tr_b16 a[26:27], v227 offset:51584
    v_and_b32 v215, 0xffff0000, v111
    v_fma_f32 v208, v208, v192, v200
    v_fma_f32 v209, v209, v193, v201
    v_mfma_f32_32x32x16_bf16 v[160:175], a[12:15], v[216:219], v[160:175]
    s_waitcnt lgkmcnt(4)
    ds_read_b64_tr_b16 a[28:29], v227 offset:51136
    ds_read_b64_tr_b16 a[30:31], v227 offset:51648
    v_fma_f32 v210, v210, v194, v202
    v_fma_f32 v211, v211, v195, v203
    v_fma_f32 v212, v212, v237, v238
    v_fma_f32 v213, v213, v237, v238
    v_mfma_f32_32x32x16_bf16 a[192:207], a[16:19], v[216:219], a[192:207]
    s_waitcnt lgkmcnt(4)
    s_add_u32 m0, s25, 34880
    ds_read_b64_tr_b16 a[0:1], v227 offset:52768
    ds_read_b64_tr_b16 a[2:3], v227 offset:53280
    v_fma_f32 v214, v214, v237, v238
    v_fma_f32 v215, v215, v237, v238
    v_cvt_pk_bf16_f32 v220, v208, v209
    v_cvt_pk_bf16_f32 v221, v210, v211
    v_mfma_f32_32x32x16_bf16 a[208:223], a[20:23], v[216:219], a[208:223]
    s_waitcnt lgkmcnt(4)
    ds_read_b64_tr_b16 a[4:5], v227 offset:52832
    ds_read_b64_tr_b16 a[6:7], v227 offset:53344
    buffer_load_dwordx4 v246, s[4:7], s27 offen offset:1024  lds
    v_fma_f32 v212, v212, v196, v204
    v_fma_f32 v213, v213, v197, v205
    v_fma_f32 v214, v214, v198, v206
    v_mfma_f32_32x32x16_bf16 a[224:239], a[24:27], v[216:219], a[224:239]
    s_waitcnt lgkmcnt(4)
    ds_read_b64_tr_b16 a[8:9], v227 offset:52896
    ds_read_b64_tr_b16 a[10:11], v227 offset:53408
    v_fma_f32 v215, v215, v199, v207
    v_cvt_pk_bf16_f32 v222, v212, v213
    v_cvt_pk_bf16_f32 v223, v214, v215
    v_mfma_f32_32x32x16_bf16 a[240:255], a[28:31], v[216:219], a[240:255]
    s_waitcnt lgkmcnt(4)
    ds_read_b64_tr_b16 a[12:13], v227 offset:52960
    ds_read_b64_tr_b16 a[14:15], v227 offset:53472
    v_mfma_f32_32x32x16_bf16 v[112:127], a[0:3], v[220:223], v[112:127]
    s_waitcnt lgkmcnt(4)
    s_add_u32 m0, s25, 35424
    ds_read_b64_tr_b16 a[16:17], v227 offset:53024
    ds_read_b64_tr_b16 a[18:19], v227 offset:53536
    v_mfma_f32_32x32x16_bf16 v[128:143], a[4:7], v[220:223], v[128:143]
    s_waitcnt lgkmcnt(4)
    ds_read_b64_tr_b16 a[20:21], v227 offset:53088
    ds_read_b64_tr_b16 a[22:23], v227 offset:53600
    buffer_load_dwordx4 v246, s[4:7], s27 offen offset:1536  lds
    v_mfma_f32_32x32x16_bf16 v[144:159], a[8:11], v[220:223], v[144:159]
    s_waitcnt lgkmcnt(4)
    s_add_u32 s27, s27, 24576
    ds_read_b64_tr_b16 a[24:25], v227 offset:53152
    ds_read_b64_tr_b16 a[26:27], v227 offset:53664
    v_mfma_f32_32x32x16_bf16 v[160:175], a[12:15], v[220:223], v[160:175]
    s_waitcnt lgkmcnt(4)
    ds_read_b64_tr_b16 a[28:29], v227 offset:53216
    ds_read_b64_tr_b16 a[30:31], v227 offset:53728
    v_mfma_f32_32x32x16_bf16 a[192:207], a[16:19], v[220:223], a[192:207]
    s_waitcnt lgkmcnt(4)
    v_cvt_pk_bf16_f32 v112, v112, v113
    v_cvt_pk_bf16_f32 v113, v114, v115
    v_cvt_pk_bf16_f32 v114, v116, v117
    v_cvt_pk_bf16_f32 v115, v118, v119
    v_cvt_pk_bf16_f32 v120, v120, v121
    v_cvt_pk_bf16_f32 v121, v122, v123
    v_cvt_pk_bf16_f32 v122, v124, v125
    v_cvt_pk_bf16_f32 v123, v126, v127
    v_mfma_f32_32x32x16_bf16 a[208:223], a[20:23], v[220:223], a[208:223]
    s_waitcnt lgkmcnt(2)
    v_cvt_pk_bf16_f32 v128, v128, v129
    v_cvt_pk_bf16_f32 v129, v130, v131
    v_cvt_pk_bf16_f32 v130, v132, v133
    v_cvt_pk_bf16_f32 v131, v134, v135
    v_mfma_f32_32x32x16_bf16 a[224:239], a[24:27], v[220:223], a[224:239]
    s_waitcnt lgkmcnt(0)
    v_cvt_pk_bf16_f32 v136, v136, v137
    v_cvt_pk_bf16_f32 v137, v138, v139
    v_cvt_pk_bf16_f32 v138, v140, v141
    v_cvt_pk_bf16_f32 v139, v142, v143
    v_cvt_pk_bf16_f32 v144, v144, v145
    v_cvt_pk_bf16_f32 v145, v146, v147
    v_mfma_f32_32x32x16_bf16 a[240:255], a[28:31], v[220:223], a[240:255]
    v_cvt_pk_bf16_f32 v146, v148, v149
    v_cvt_pk_bf16_f32 v147, v150, v151
    v_cvt_pk_bf16_f32 v152, v152, v153
    v_cvt_pk_bf16_f32 v153, v154, v155
    v_cvt_pk_bf16_f32 v154, v156, v157
    v_cvt_pk_bf16_f32 v155, v158, v159
    v_mov_b32 v249, v232
    v_mov_b32 v250, v233
    s_barrier
    ds_write_b128 v253, v[112:115] offset:0
    ds_write_b128 v253, v[120:123] offset:32
    ds_write_b128 v253, v[128:131] offset:64
    ds_write_b128 v253, v[136:139] offset:96
    ds_write_b128 v253, v[144:147] offset:128
    ds_write_b128 v253, v[152:155] offset:160
    v_cvt_pk_bf16_f32 v160, v160, v161
    v_cvt_pk_bf16_f32 v161, v162, v163
    v_cvt_pk_bf16_f32 v162, v164, v165
    v_cvt_pk_bf16_f32 v163, v166, v167
    ds_write_b128 v253, v[160:163] offset:192
    v_cvt_pk_bf16_f32 v168, v168, v169
    v_cvt_pk_bf16_f32 v169, v170, v171
    v_cvt_pk_bf16_f32 v170, v172, v173
    v_cvt_pk_bf16_f32 v171, v174, v175
    ds_write_b128 v253, v[168:171] offset:224
    v_accvgpr_read_b32 v64, a192
    v_accvgpr_read_b32 v65, a193
    v_accvgpr_read_b32 v66, a194
    v_accvgpr_read_b32 v67, a195
    v_accvgpr_read_b32 v68, a196
    v_accvgpr_read_b32 v69, a197
    v_accvgpr_read_b32 v70, a198
    v_accvgpr_read_b32 v71, a199
    v_cvt_pk_bf16_f32 v64, v64, v65
    v_cvt_pk_bf16_f32 v65, v66, v67
    v_cvt_pk_bf16_f32 v66, v68, v69
    v_cvt_pk_bf16_f32 v67, v70, v71
    ds_write_b128 v253, v[64:67] offset:256
    v_accvgpr_read_b32 v72, a200
    v_accvgpr_read_b32 v73, a201
    v_accvgpr_read_b32 v74, a202
    v_accvgpr_read_b32 v75, a203
    v_accvgpr_read_b32 v76, a204
    v_accvgpr_read_b32 v77, a205
    v_accvgpr_read_b32 v78, a206
    v_accvgpr_read_b32 v79, a207
    v_cvt_pk_bf16_f32 v72, v72, v73
    v_cvt_pk_bf16_f32 v73, v74, v75
    v_cvt_pk_bf16_f32 v74, v76, v77
    v_cvt_pk_bf16_f32 v75, v78, v79
    ds_write_b128 v253, v[72:75] offset:288
    v_accvgpr_read_b32 v80, a208
    v_accvgpr_read_b32 v81, a209
    v_accvgpr_read_b32 v82, a210
    v_accvgpr_read_b32 v83, a211
    v_accvgpr_read_b32 v84, a212
    v_accvgpr_read_b32 v85, a213
    v_accvgpr_read_b32 v86, a214
    v_accvgpr_read_b32 v87, a215
    v_cvt_pk_bf16_f32 v80, v80, v81
    v_cvt_pk_bf16_f32 v81, v82, v83
    v_cvt_pk_bf16_f32 v82, v84, v85
    v_cvt_pk_bf16_f32 v83, v86, v87
    ds_write_b128 v253, v[80:83] offset:320
    v_accvgpr_read_b32 v88, a216
    v_accvgpr_read_b32 v89, a217
    v_accvgpr_read_b32 v90, a218
    v_accvgpr_read_b32 v91, a219
    v_accvgpr_read_b32 v92, a220
    v_accvgpr_read_b32 v93, a221
    v_accvgpr_read_b32 v94, a222
    v_accvgpr_read_b32 v95, a223
    v_cvt_pk_bf16_f32 v88, v88, v89
    v_cvt_pk_bf16_f32 v89, v90, v91
    v_cvt_pk_bf16_f32 v90, v92, v93
    v_cvt_pk_bf16_f32 v91, v94, v95
    ds_write_b128 v253, v[88:91] offset:352
    v_accvgpr_read_b32 v96, a224
    v_accvgpr_read_b32 v97, a225
    v_accvgpr_read_b32 v98, a226
    v_accvgpr_read_b32 v99, a227
    v_accvgpr_read_b32 v100, a228
    v_accvgpr_read_b32 v101, a229
    v_accvgpr_read_b32 v102, a230
    v_accvgpr_read_b32 v103, a231
    v_cvt_pk_bf16_f32 v96, v96, v97
    v_cvt_pk_bf16_f32 v97, v98, v99
    v_cvt_pk_bf16_f32 v98, v100, v101
    v_cvt_pk_bf16_f32 v99, v102, v103
    ds_write_b128 v253, v[96:99] offset:384
    v_accvgpr_read_b32 v104, a232
    v_accvgpr_read_b32 v105, a233
    v_accvgpr_read_b32 v106, a234
    v_accvgpr_read_b32 v107, a235
    v_accvgpr_read_b32 v108, a236
    v_accvgpr_read_b32 v109, a237
    v_accvgpr_read_b32 v110, a238
    v_accvgpr_read_b32 v111, a239
    v_cvt_pk_bf16_f32 v104, v104, v105
    v_cvt_pk_bf16_f32 v105, v106, v107
    v_cvt_pk_bf16_f32 v106, v108, v109
    v_cvt_pk_bf16_f32 v107, v110, v111
    ds_write_b128 v253, v[104:107] offset:416
    v_accvgpr_read_b32 v112, a240
    v_accvgpr_read_b32 v113, a241
    v_accvgpr_read_b32 v114, a242
    v_accvgpr_read_b32 v115, a243
    v_accvgpr_read_b32 v116, a244
    v_accvgpr_read_b32 v117, a245
    v_accvgpr_read_b32 v118, a246
    v_accvgpr_read_b32 v119, a247
    v_cvt_pk_bf16_f32 v112, v112, v113
    v_cvt_pk_bf16_f32 v113, v114, v115
    v_cvt_pk_bf16_f32 v114, v116, v117
    v_cvt_pk_bf16_f32 v115, v118, v119
    ds_write_b128 v253, v[112:115] offset:448
    v_accvgpr_read_b32 v120, a248
    v_accvgpr_read_b32 v121, a249
    v_accvgpr_read_b32 v122, a250
    v_accvgpr_read_b32 v123, a251
    v_accvgpr_read_b32 v124, a252
    v_accvgpr_read_b32 v125, a253
    v_accvgpr_read_b32 v126, a254
    v_accvgpr_read_b32 v127, a255
    v_cvt_pk_bf16_f32 v120, v120, v121
    v_cvt_pk_bf16_f32 v121, v122, v123
    v_cvt_pk_bf16_f32 v122, v124, v125
    v_cvt_pk_bf16_f32 v123, v126, v127
    ds_write_b128 v253, v[120:123] offset:480
    s_waitcnt vmcnt(8) lgkmcnt(0)
    s_barrier
    ds_read_b128 v[208:211], v244 offset:0
    ds_read_b128 a[0:3], v254 offset:0
    ds_read_b128 a[32:35], v254 offset:8704
    ds_read_b128 a[64:67], v255 offset:0
    ds_read_b128 a[96:99], v255 offset:8704
    ds_read_b128 v[212:215], v244 offset:64
    ds_read_b128 a[4:7], v254 offset:64
    ds_read_b128 a[36:39], v254 offset:8768
    ds_read_b128 a[68:71], v255 offset:64
    ds_read_b128 a[100:103], v255 offset:8768
    s_waitcnt lgkmcnt(8)
    v_mfma_f32_16x16x32_bf16 v[128:131], v[208:211], a[0:3], 0
    s_waitcnt lgkmcnt(7)
    ds_read_b128 v[216:219], v244 offset:128
    ds_read_b128 a[8:11], v254 offset:128
    v_mfma_f32_16x16x32_bf16 v[132:135], v[208:211], a[32:35], 0
    s_waitcnt lgkmcnt(8)
    ds_read_b128 a[40:43], v254 offset:8832
    v_mfma_f32_16x16x32_bf16 v[136:139], v[208:211], a[64:67], 0
    s_waitcnt lgkmcnt(8)
    ds_read_b128 a[72:75], v255 offset:128
    v_mfma_f32_16x16x32_bf16 v[140:143], v[208:211], a[96:99], 0
    s_waitcnt lgkmcnt(7)
    ds_read_b128 a[104:107], v255 offset:8832
    v_mfma_f32_16x16x32_bf16 v[128:131], v[212:215], a[4:7], v[128:131]
    s_waitcnt lgkmcnt(7)
    ds_read_b128 v[220:223], v244 offset:192
    ds_read_b128 a[12:15], v254 offset:192
    v_mfma_f32_16x16x32_bf16 v[132:135], v[212:215], a[36:39], v[132:135]
    s_waitcnt lgkmcnt(8)
    ds_read_b128 a[44:47], v254 offset:8896
    v_mfma_f32_16x16x32_bf16 v[136:139], v[212:215], a[68:71], v[136:139]
    s_waitcnt lgkmcnt(8)
    ds_read_b128 a[76:79], v255 offset:192
    v_mfma_f32_16x16x32_bf16 v[140:143], v[212:215], a[100:103], v[140:143]
    s_waitcnt lgkmcnt(7)
    ds_read_b128 a[108:111], v255 offset:8896
    v_mfma_f32_16x16x32_bf16 v[128:131], v[216:219], a[8:11], v[128:131]
    s_waitcnt lgkmcnt(7)
    s_lshl_b32 s46, s24, 10
    ds_read_b128 v[224:227], v244 offset:256
    ds_read_b128 a[16:19], v254 offset:256
    v_mfma_f32_16x16x32_bf16 v[132:135], v[216:219], a[40:43], v[132:135]
    s_waitcnt lgkmcnt(8)
    ds_read_b128 a[48:51], v254 offset:8960
    v_mfma_f32_16x16x32_bf16 v[136:139], v[216:219], a[72:75], v[136:139]
    s_waitcnt lgkmcnt(8)
    s_add_u32 s46, s46, 154112
    ds_read_b128 a[80:83], v255 offset:256
    v_mfma_f32_16x16x32_bf16 v[140:143], v[216:219], a[104:107], v[140:143]
    s_waitcnt lgkmcnt(7)
    ds_read_b128 a[112:115], v255 offset:8960
    v_mfma_f32_16x16x32_bf16 v[128:131], v[220:223], a[12:15], v[128:131]
    s_waitcnt lgkmcnt(7)
    s_xor_b32 s47, s46, 1024
    ds_read_b128 v[228:231], v244 offset:320
    ds_read_b128 a[20:23], v254 offset:320
    v_mfma_f32_16x16x32_bf16 v[132:135], v[220:223], a[44:47], v[132:135]
    s_waitcnt lgkmcnt(8)
    ds_read_b128 a[52:55], v254 offset:9024
    v_mfma_f32_16x16x32_bf16 v[136:139], v[220:223], a[76:79], v[136:139]
    s_waitcnt lgkmcnt(8)
    s_lshl_b32 s36, s2, 2
    ds_read_b128 a[84:87], v255 offset:320
    v_mfma_f32_16x16x32_bf16 v[140:143], v[220:223], a[108:111], v[140:143]
    s_waitcnt lgkmcnt(7)
    ds_read_b128 a[116:119], v255 offset:9024
    v_mfma_f32_16x16x32_bf16 v[128:131], v[224:227], a[16:19], v[128:131]
    s_waitcnt lgkmcnt(7)
    s_add_u32 s36, s36, s24
    ds_read_b128 v[232:235], v244 offset:384
    ds_read_b128 a[24:27], v254 offset:384
    v_mfma_f32_16x16x32_bf16 v[132:135], v[224:227], a[48:51], v[132:135]
    s_waitcnt lgkmcnt(8)
    ds_read_b128 a[56:59], v254 offset:9088
    v_mfma_f32_16x16x32_bf16 v[136:139], v[224:227], a[80:83], v[136:139]
    s_waitcnt lgkmcnt(8)
    s_lshl_b32 s36, s36, 10
    ds_read_b128 a[88:91], v255 offset:384
    v_mfma_f32_16x16x32_bf16 v[140:143], v[224:227], a[112:115], v[140:143]
    s_waitcnt lgkmcnt(7)
    ds_read_b128 a[120:123], v255 offset:9088
    v_mfma_f32_16x16x32_bf16 v[128:131], v[228:231], a[20:23], v[128:131]
    s_waitcnt lgkmcnt(7)
    s_add_u32 s36, s36, 2097152
    ds_read_b128 v[236:239], v244 offset:448
    ds_read_b128 a[28:31], v254 offset:448
    v_mfma_f32_16x16x32_bf16 v[132:135], v[228:231], a[52:55], v[132:135]
    s_waitcnt lgkmcnt(8)
    ds_read_b128 a[60:63], v254 offset:9152
    v_mfma_f32_16x16x32_bf16 v[136:139], v[228:231], a[84:87], v[136:139]
    s_waitcnt lgkmcnt(8)
    s_lshr_b32 s37, s24, 1
    ds_read_b128 a[92:95], v255 offset:448
    v_mfma_f32_16x16x32_bf16 v[140:143], v[228:231], a[116:119], v[140:143]
    s_waitcnt lgkmcnt(7)
    ds_read_b128 a[124:127], v255 offset:9152
    v_mfma_f32_16x16x32_bf16 v[128:131], v[232:235], a[24:27], v[128:131]
    s_waitcnt lgkmcnt(7)
    s_and_b32 s38, s24, 1
    ds_read_b128 v[208:211], v244 offset:16896
    v_mfma_f32_16x16x32_bf16 v[132:135], v[232:235], a[56:59], v[132:135]
    s_waitcnt lgkmcnt(7)
    v_mfma_f32_16x16x32_bf16 v[136:139], v[232:235], a[88:91], v[136:139]
    s_waitcnt lgkmcnt(6)
    s_mul_i32 s37, s37, 57344
    v_mfma_f32_16x16x32_bf16 v[140:143], v[232:235], a[120:123], v[140:143]
    s_waitcnt lgkmcnt(4)
    v_mfma_f32_16x16x32_bf16 v[128:131], v[236:239], a[28:31], v[128:131]
    s_waitcnt lgkmcnt(3)
    s_mul_i32 s38, s38, 3584
    ds_read_b128 v[212:215], v244 offset:16960
    v_mfma_f32_16x16x32_bf16 v[132:135], v[236:239], a[60:63], v[132:135]
    s_waitcnt lgkmcnt(3)
    v_mfma_f32_16x16x32_bf16 v[136:139], v[236:239], a[92:95], v[136:139]
    s_waitcnt lgkmcnt(2)
    s_add_u32 s37, s37, s38
    v_mfma_f32_16x16x32_bf16 v[140:143], v[236:239], a[124:127], v[140:143]
    s_waitcnt lgkmcnt(1)
    v_mfma_f32_16x16x32_bf16 v[144:147], v[208:211], a[0:3], 0
    ds_read_b128 v[216:219], v244 offset:17024
    v_mfma_f32_16x16x32_bf16 v[148:151], v[208:211], a[32:35], 0
    v_mfma_f32_16x16x32_bf16 v[152:155], v[208:211], a[64:67], 0
    v_mfma_f32_16x16x32_bf16 v[156:159], v[208:211], a[96:99], 0
    s_waitcnt lgkmcnt(1)
    v_lshrrev_b32 v251, 3, v248
    v_mul_u32_u24 v251, 7168, v251
    v_mfma_f32_16x16x32_bf16 v[144:147], v[212:215], a[4:7], v[144:147]
    ds_read_b128 v[220:223], v244 offset:17088
    v_and_b32 v255, 7, v248
    v_mfma_f32_16x16x32_bf16 v[148:151], v[212:215], a[36:39], v[148:151]
    v_lshl_add_u32 v255, v255, 4, v251
    v_add_u32 v255, s37, v255
    v_mfma_f32_16x16x32_bf16 v[152:155], v[212:215], a[68:71], v[152:155]
    v_lshlrev_b32 v251, 4, v248
    v_add_u32 v254, s47, v251
    v_mfma_f32_16x16x32_bf16 v[156:159], v[212:215], a[100:103], v[156:159]
    s_waitcnt lgkmcnt(1)
    v_add_u32 v253, s46, v251
    v_mov_b32 v240, 0
    v_mfma_f32_16x16x32_bf16 v[144:147], v[216:219], a[8:11], v[144:147]
    ds_read_b128 v[224:227], v244 offset:17152
    v_mov_b32 v241, 0
    v_mfma_f32_16x16x32_bf16 v[148:151], v[216:219], a[40:43], v[148:151]
    v_mov_b32 v242, 0
    v_mov_b32 v243, 0
    v_mfma_f32_16x16x32_bf16 v[152:155], v[216:219], a[72:75], v[152:155]
    v_max3_f32 v192, v128, v129, v130
    v_max3_f32 v193, v132, v133, v134
    v_mfma_f32_16x16x32_bf16 v[156:159], v[216:219], a[104:107], v[156:159]
    s_waitcnt lgkmcnt(1)
    v_max3_f32 v194, v136, v137, v138
    v_max3_f32 v195, v140, v141, v142
    v_mfma_f32_16x16x32_bf16 v[144:147], v[220:223], a[12:15], v[144:147]
    ds_read_b128 v[228:231], v244 offset:17216
    v_max_f32 v192, v192, v131
    v_mfma_f32_16x16x32_bf16 v[148:151], v[220:223], a[44:47], v[148:151]
    v_max_f32 v193, v193, v135
    v_max_f32 v194, v194, v139
    v_mfma_f32_16x16x32_bf16 v[152:155], v[220:223], a[76:79], v[152:155]
    v_max_f32 v195, v195, v143
    v_mfma_f32_16x16x32_bf16 v[156:159], v[220:223], a[108:111], v[156:159]
    s_waitcnt lgkmcnt(1)
    v_mfma_f32_16x16x32_bf16 v[144:147], v[224:227], a[16:19], v[144:147]
    ds_read_b128 v[232:235], v244 offset:17280
    v_mfma_f32_16x16x32_bf16 v[148:151], v[224:227], a[48:51], v[148:151]
    v_mfma_f32_16x16x32_bf16 v[152:155], v[224:227], a[80:83], v[152:155]
    v_mfma_f32_16x16x32_bf16 v[156:159], v[224:227], a[112:115], v[156:159]
    s_waitcnt lgkmcnt(1)
    v_mfma_f32_16x16x32_bf16 v[144:147], v[228:231], a[20:23], v[144:147]
    ds_read_b128 v[236:239], v244 offset:17344
    v_mfma_f32_16x16x32_bf16 v[148:151], v[228:231], a[52:55], v[148:151]
    v_mfma_f32_16x16x32_bf16 v[152:155], v[228:231], a[84:87], v[152:155]
    v_mfma_f32_16x16x32_bf16 v[156:159], v[228:231], a[116:119], v[156:159]
    s_waitcnt lgkmcnt(1)
    v_mfma_f32_16x16x32_bf16 v[144:147], v[232:235], a[24:27], v[144:147]
    ds_read_b128 v[208:211], v244 offset:50688
    v_mfma_f32_16x16x32_bf16 v[148:151], v[232:235], a[56:59], v[148:151]
    v_mfma_f32_16x16x32_bf16 v[152:155], v[232:235], a[88:91], v[152:155]
    v_mfma_f32_16x16x32_bf16 v[156:159], v[232:235], a[120:123], v[156:159]
    s_waitcnt lgkmcnt(1)
    buffer_store_dwordx4 v[240:243], v251, s[20:23], s36 offen
    v_mfma_f32_16x16x32_bf16 v[144:147], v[236:239], a[28:31], v[144:147]
    ds_read_b128 v[212:215], v244 offset:50752
    v_mfma_f32_16x16x32_bf16 v[148:151], v[236:239], a[60:63], v[148:151]
    v_mfma_f32_16x16x32_bf16 v[152:155], v[236:239], a[92:95], v[152:155]
    v_mfma_f32_16x16x32_bf16 v[156:159], v[236:239], a[124:127], v[156:159]
    s_waitcnt lgkmcnt(1)
    v_mfma_f32_16x16x32_bf16 v[32:35], v[208:211], a[0:3], 0
    ds_read_b128 v[216:219], v244 offset:50816
    v_mfma_f32_16x16x32_bf16 v[36:39], v[208:211], a[32:35], 0
    v_mfma_f32_16x16x32_bf16 v[40:43], v[208:211], a[64:67], 0
    v_max3_f32 v192, v192, v144, v145
    v_max3_f32 v193, v193, v148, v149
    v_mfma_f32_16x16x32_bf16 v[44:47], v[208:211], a[96:99], 0
    s_waitcnt lgkmcnt(1)
    v_max3_f32 v194, v194, v152, v153
    v_max3_f32 v195, v195, v156, v157
    v_mfma_f32_16x16x32_bf16 v[32:35], v[212:215], a[4:7], v[32:35]
    ds_read_b128 v[220:223], v244 offset:50880
    v_max3_f32 v192, v192, v146, v147
    v_mfma_f32_16x16x32_bf16 v[36:39], v[212:215], a[36:39], v[36:39]
    v_max3_f32 v193, v193, v150, v151
    v_max3_f32 v194, v194, v154, v155
    v_mfma_f32_16x16x32_bf16 v[40:43], v[212:215], a[68:71], v[40:43]
    v_max3_f32 v195, v195, v158, v159
    v_mfma_f32_16x16x32_bf16 v[44:47], v[212:215], a[100:103], v[44:47]
    s_waitcnt lgkmcnt(1)
    ds_write_b128 v253, v[192:195]
    v_mfma_f32_16x16x32_bf16 v[32:35], v[216:219], a[8:11], v[32:35]
    ds_read_b128 v[224:227], v244 offset:50944
    v_mfma_f32_16x16x32_bf16 v[36:39], v[216:219], a[40:43], v[36:39]
    s_waitcnt vmcnt(5) lgkmcnt(0)
    s_barrier
    s_add_u32 m0, s25, 84480
    ds_read_b128 v[196:199], v254
    v_mfma_f32_16x16x32_bf16 v[40:43], v[216:219], a[72:75], v[40:43]
    buffer_load_dwordx4 v247, s[8:11], s28 offen offset:0  lds
    v_mfma_f32_16x16x32_bf16 v[44:47], v[216:219], a[104:107], v[44:47]
    s_add_u32 m0, s25, 85024
    v_mfma_f32_16x16x32_bf16 v[32:35], v[220:223], a[12:15], v[32:35]
    ds_read_b128 v[228:231], v244 offset:51008
    buffer_load_dwordx4 v247, s[8:11], s28 offen offset:512  lds
    v_mfma_f32_16x16x32_bf16 v[36:39], v[220:223], a[44:47], v[36:39]
    s_add_u32 m0, s25, 85568
    v_mfma_f32_16x16x32_bf16 v[40:43], v[220:223], a[76:79], v[40:43]
    buffer_load_dwordx4 v247, s[8:11], s28 offen offset:1024  lds
    v_mfma_f32_16x16x32_bf16 v[44:47], v[220:223], a[108:111], v[44:47]
    s_waitcnt lgkmcnt(1)
    s_add_u32 m0, s25, 86112
    v_max_f32 v192, v192, v198
    v_max_f32 v193, v193, v199
    v_max_f32 v194, v194, v196
    v_mfma_f32_16x16x32_bf16 v[32:35], v[224:227], a[16:19], v[32:35]
    ds_read_b128 v[232:235], v244 offset:51072
    buffer_load_dwordx4 v247, s[8:11], s28 offen offset:1536  lds
    v_mfma_f32_16x16x32_bf16 v[36:39], v[224:227], a[48:51], v[36:39]
    s_add_u32 s28, s28, 32512
    ds_read_b64_tr_b16 v[208:209], v245 offset:0
    v_max_f32 v195, v195, v197
    v_mov_b32 v196, v192
    v_mfma_f32_16x16x32_bf16 v[40:43], v[224:227], a[80:83], v[40:43]
    s_mov_b32 s46, 3268149248
    ds_read_b64_tr_b16 v[210:211], v245 offset:512
    v_mov_b32 v197, v193
    v_mov_b32 v198, v194
    v_mfma_f32_16x16x32_bf16 v[44:47], v[224:227], a[112:115], v[44:47]
    s_waitcnt lgkmcnt(3)
    v_mov_b32 v199, v195
    v_permlane32_swap_b32 v192, v196
    v_permlane32_swap_b32 v193, v197
    v_mfma_f32_16x16x32_bf16 v[32:35], v[228:231], a[20:23], v[32:35]
    ds_read_b128 v[236:239], v244 offset:51136
    v_permlane32_swap_b32 v194, v198
    v_permlane32_swap_b32 v195, v199
    v_mfma_f32_16x16x32_bf16 v[36:39], v[228:231], a[52:55], v[36:39]
    ds_read_b64_tr_b16 v[212:213], v245 offset:32
    v_max_f32 v192, v192, v196
    v_max_f32 v193, v193, v197
    v_mfma_f32_16x16x32_bf16 v[40:43], v[228:231], a[84:87], v[40:43]
    ds_read_b64_tr_b16 v[214:215], v245 offset:544
    v_max_f32 v194, v194, v198
    v_max_f32 v195, v195, v199
    v_mfma_f32_16x16x32_bf16 v[44:47], v[228:231], a[116:119], v[44:47]
    s_waitcnt lgkmcnt(5)
    v_mov_b32 v196, v192
    v_mov_b32 v197, v193
    v_mov_b32 v198, v194
    v_mfma_f32_16x16x32_bf16 v[32:35], v[232:235], a[24:27], v[32:35]
    v_mov_b32 v199, v195
    v_permlane16_swap_b32 v192, v196
    v_permlane16_swap_b32 v193, v197
    v_mfma_f32_16x16x32_bf16 v[36:39], v[232:235], a[56:59], v[36:39]
    ds_read_b64_tr_b16 v[216:217], v245 offset:64
    v_permlane16_swap_b32 v194, v198
    v_permlane16_swap_b32 v195, v199
    v_mfma_f32_16x16x32_bf16 v[40:43], v[232:235], a[88:91], v[40:43]
    ds_read_b64_tr_b16 v[218:219], v245 offset:576
    v_max_f32 v192, v192, v196
    v_max_f32 v193, v193, v197
    v_mfma_f32_16x16x32_bf16 v[44:47], v[232:235], a[120:123], v[44:47]
    s_waitcnt lgkmcnt(4)
    v_max_f32 v194, v194, v198
    v_max_f32 v195, v195, v199
    v_sub_f32 v207, s46, v195
    v_mfma_f32_16x16x32_bf16 v[32:35], v[236:239], a[28:31], v[32:35]
    v_sub_f32 v206, s46, v195
    v_sub_f32 v205, s46, v195
    v_sub_f32 v204, s46, v195
    v_mfma_f32_16x16x32_bf16 v[36:39], v[236:239], a[60:63], v[36:39]
    ds_read_b64_tr_b16 v[220:221], v245 offset:96
    v_sub_f32 v203, s46, v194
    v_sub_f32 v202, s46, v194
    v_mfma_f32_16x16x32_bf16 v[40:43], v[236:239], a[92:95], v[40:43]
    ds_read_b64_tr_b16 v[222:223], v245 offset:608
    v_sub_f32 v201, s46, v194
    v_sub_f32 v200, s46, v194
    v_mfma_f32_16x16x32_bf16 v[44:47], v[236:239], a[124:127], v[44:47]
    v_sub_f32 v199, s46, v193
    v_sub_f32 v198, s46, v193
    v_sub_f32 v197, s46, v193
    v_sub_f32 v196, s46, v193
    v_sub_f32 v195, s46, v192
    v_sub_f32 v194, s46, v192
    v_sub_f32 v193, s46, v192
    v_sub_f32 v192, s46, v192
    v_add_f32 v128, v128, v192
    v_add_f32 v129, v129, v192
    v_add_f32 v130, v130, v192
    v_add_f32 v131, v131, v192
    v_add_f32 v144, v144, v192
    v_add_f32 v145, v145, v192
    v_add_f32 v146, v146, v192
    v_add_f32 v147, v147, v192
    v_add_f32 v32, v32, v192
    v_add_f32 v33, v33, v192
    v_add_f32 v34, v34, v192
    v_add_f32 v35, v35, v192
    s_add_u32 m0, s25, 0
    s_nop 0
    buffer_load_dwordx4 v246, s[4:7], s27 offen offset:0  lds
    s_add_u32 m0, s25, 544
    s_nop 0
    buffer_load_dwordx4 v246, s[4:7], s27 offen offset:512  lds
    v_add_f32 v132, v132, v196
    v_add_f32 v133, v133, v196
    v_add_f32 v134, v134, v196
    v_add_f32 v135, v135, v196
    v_add_f32 v148, v148, v196
    v_add_f32 v149, v149, v196
    v_add_f32 v150, v150, v196
    v_add_f32 v151, v151, v196
    v_add_f32 v36, v36, v196
    v_add_f32 v37, v37, v196
    v_add_f32 v38, v38, v196
    v_add_f32 v39, v39, v196
    s_add_u32 m0, s25, 1088
    s_nop 0
    buffer_load_dwordx4 v246, s[4:7], s27 offen offset:1024  lds
    s_add_u32 m0, s25, 1632
    s_nop 0
    buffer_load_dwordx4 v246, s[4:7], s27 offen offset:1536  lds
    s_add_u32 s27, s27, 8192
    v_add_f32 v136, v136, v200
    v_add_f32 v137, v137, v200
    v_add_f32 v138, v138, v200
    v_add_f32 v139, v139, v200
    v_add_f32 v152, v152, v200
    v_add_f32 v153, v153, v200
    v_add_f32 v154, v154, v200
    v_add_f32 v155, v155, v200
    v_add_f32 v40, v40, v200
    v_add_f32 v41, v41, v200
    v_add_f32 v42, v42, v200
    v_add_f32 v43, v43, v200
    s_add_u32 m0, s25, 101376
    s_nop 0
    buffer_load_dwordx4 v247, s[8:11], s28 offen offset:0  lds
    s_add_u32 m0, s25, 101920
    s_nop 0
    buffer_load_dwordx4 v247, s[8:11], s28 offen offset:512  lds
    v_add_f32 v140, v140, v204
    v_add_f32 v141, v141, v204
    v_add_f32 v142, v142, v204
    v_add_f32 v143, v143, v204
    v_add_f32 v156, v156, v204
    v_add_f32 v157, v157, v204
    v_add_f32 v158, v158, v204
    v_add_f32 v159, v159, v204
    v_add_f32 v44, v44, v204
    v_add_f32 v45, v45, v204
    v_add_f32 v46, v46, v204
    v_add_f32 v47, v47, v204
    s_add_u32 m0, s25, 102464
    s_nop 0
    buffer_load_dwordx4 v247, s[8:11], s28 offen offset:1024  lds
    s_add_u32 m0, s25, 103008
    s_nop 0
    buffer_load_dwordx4 v247, s[8:11], s28 offen offset:1536  lds
    s_add_u32 s28, s28, 256
    v_exp_f32 v128, v128
    v_exp_f32 v129, v129
    v_exp_f32 v130, v130
    v_exp_f32 v131, v131
    v_add_f32 v240, v240, v128
    v_add_f32 v240, v240, v129
    v_cvt_pk_bf16_f32 v160, v128, v129
    v_exp_f32 v132, v132
    v_exp_f32 v133, v133
    v_add_f32 v240, v240, v130
    v_add_f32 v240, v240, v131
    v_cvt_pk_bf16_f32 v161, v130, v131
    v_exp_f32 v134, v134
    v_exp_f32 v135, v135
    v_add_f32 v241, v241, v132
    v_add_f32 v241, v241, v133
    v_cvt_pk_bf16_f32 v164, v132, v133
    v_exp_f32 v136, v136
    v_exp_f32 v137, v137
    v_add_f32 v241, v241, v134
    v_add_f32 v241, v241, v135
    v_cvt_pk_bf16_f32 v165, v134, v135
    v_exp_f32 v138, v138
    v_exp_f32 v139, v139
    v_add_f32 v242, v242, v136
    v_add_f32 v242, v242, v137
    v_cvt_pk_bf16_f32 v168, v136, v137
    v_exp_f32 v140, v140
    v_exp_f32 v141, v141
    v_add_f32 v242, v242, v138
    v_add_f32 v242, v242, v139
    v_cvt_pk_bf16_f32 v169, v138, v139
    v_exp_f32 v142, v142
    v_exp_f32 v143, v143
    v_add_f32 v243, v243, v140
    v_add_f32 v243, v243, v141
    v_cvt_pk_bf16_f32 v172, v140, v141
    s_nop 0
    v_add_f32 v243, v243, v142
    v_add_f32 v243, v243, v143
    v_cvt_pk_bf16_f32 v173, v142, v143
    v_exp_f32 v144, v144
    v_exp_f32 v145, v145
    v_exp_f32 v146, v146
    v_exp_f32 v147, v147
    v_add_f32 v240, v240, v144
    v_add_f32 v240, v240, v145
    v_cvt_pk_bf16_f32 v162, v144, v145
    v_exp_f32 v148, v148
    v_exp_f32 v149, v149
    v_add_f32 v240, v240, v146
    v_add_f32 v240, v240, v147
    v_cvt_pk_bf16_f32 v163, v146, v147
    v_exp_f32 v150, v150
    v_exp_f32 v151, v151
    v_add_f32 v241, v241, v148
    v_add_f32 v241, v241, v149
    v_cvt_pk_bf16_f32 v166, v148, v149
    v_exp_f32 v152, v152
    v_exp_f32 v153, v153
    v_add_f32 v241, v241, v150
    v_add_f32 v241, v241, v151
    v_cvt_pk_bf16_f32 v167, v150, v151
    v_exp_f32 v154, v154
    v_exp_f32 v155, v155
    v_add_f32 v242, v242, v152
    v_add_f32 v242, v242, v153
    v_cvt_pk_bf16_f32 v170, v152, v153
    v_exp_f32 v156, v156
    v_exp_f32 v157, v157
    v_add_f32 v242, v242, v154
    v_add_f32 v242, v242, v155
    v_cvt_pk_bf16_f32 v171, v154, v155
    v_exp_f32 v158, v158
    v_exp_f32 v159, v159
    v_add_f32 v243, v243, v156
    v_add_f32 v243, v243, v157
    v_cvt_pk_bf16_f32 v174, v156, v157
    s_nop 0
    v_add_f32 v243, v243, v158
    v_add_f32 v243, v243, v159
    v_cvt_pk_bf16_f32 v175, v158, v159
    s_nop 1
    v_mfma_f32_16x16x32_bf16 v[0:3], v[208:211], v[160:163], 0
    ds_read_b64_tr_b16 v[224:225], v245 offset:128
    v_mfma_f32_16x16x32_bf16 v[64:67], v[208:211], v[164:167], 0
    s_add_u32 m0, s25, 16896
    ds_read_b64_tr_b16 v[226:227], v245 offset:640
    v_mfma_f32_16x16x32_bf16 a[128:131], v[208:211], v[168:171], 0
    buffer_load_dwordx4 v246, s[4:7], s27 offen offset:0  lds
    v_mfma_f32_16x16x32_bf16 a[192:195], v[208:211], v[172:175], 0
    s_waitcnt lgkmcnt(6)
    v_exp_f32 v32, v32
    v_mfma_f32_16x16x32_bf16 v[4:7], v[212:215], v[160:163], 0
    ds_read_b64_tr_b16 v[228:229], v245 offset:160
    v_add_f32 v240, v240, v32
    v_mfma_f32_16x16x32_bf16 v[68:71], v[212:215], v[164:167], 0
    s_add_u32 m0, s25, 17440
    ds_read_b64_tr_b16 v[230:231], v245 offset:672
    v_mfma_f32_16x16x32_bf16 a[132:135], v[212:215], v[168:171], 0
    buffer_load_dwordx4 v246, s[4:7], s27 offen offset:512  lds
    v_mfma_f32_16x16x32_bf16 a[196:199], v[212:215], v[172:175], 0
    s_waitcnt lgkmcnt(6)
    v_exp_f32 v33, v33
    v_mfma_f32_16x16x32_bf16 v[8:11], v[216:219], v[160:163], 0
    ds_read_b64_tr_b16 v[232:233], v245 offset:192
    v_add_f32 v240, v240, v33
    v_mfma_f32_16x16x32_bf16 v[72:75], v[216:219], v[164:167], 0
    s_add_u32 m0, s25, 17984
    ds_read_b64_tr_b16 v[234:235], v245 offset:704
    v_cvt_pk_bf16_f32 v176, v32, v33
    v_mfma_f32_16x16x32_bf16 a[136:139], v[216:219], v[168:171], 0
    buffer_load_dwordx4 v246, s[4:7], s27 offen offset:1024  lds
    v_mfma_f32_16x16x32_bf16 a[200:203], v[216:219], v[172:175], 0
    s_waitcnt lgkmcnt(6)
    v_mfma_f32_16x16x32_bf16 v[12:15], v[220:223], v[160:163], 0
    ds_read_b64_tr_b16 v[236:237], v245 offset:224
    v_mfma_f32_16x16x32_bf16 v[76:79], v[220:223], v[164:167], 0
    s_add_u32 m0, s25, 18528
    ds_read_b64_tr_b16 v[238:239], v245 offset:736
    v_mfma_f32_16x16x32_bf16 a[140:143], v[220:223], v[168:171], 0
    buffer_load_dwordx4 v246, s[4:7], s27 offen offset:1536  lds
    v_mfma_f32_16x16x32_bf16 a[204:207], v[220:223], v[172:175], 0
    s_waitcnt vmcnt(12) lgkmcnt(6)
    s_barrier
    v_mfma_f32_16x16x32_bf16 v[16:19], v[224:227], v[160:163], 0
    s_add_u32 s27, s27, 24576
    ds_read_b128 v[208:211], v244 offset:33792
    v_mfma_f32_16x16x32_bf16 v[80:83], v[224:227], v[164:167], 0
    v_exp_f32 v34, v34
    v_mfma_f32_16x16x32_bf16 a[144:147], v[224:227], v[168:171], 0
    v_add_f32 v240, v240, v34
    v_mfma_f32_16x16x32_bf16 a[208:211], v[224:227], v[172:175], 0
    s_waitcnt lgkmcnt(5)
    v_exp_f32 v35, v35
    v_mfma_f32_16x16x32_bf16 v[20:23], v[228:231], v[160:163], 0
    ds_read_b128 v[212:215], v244 offset:33856
    v_add_f32 v240, v240, v35
    v_mfma_f32_16x16x32_bf16 v[84:87], v[228:231], v[164:167], 0
    v_exp_f32 v36, v36
    v_mfma_f32_16x16x32_bf16 a[148:151], v[228:231], v[168:171], 0
    v_cvt_pk_bf16_f32 v177, v34, v35
    v_mfma_f32_16x16x32_bf16 a[212:215], v[228:231], v[172:175], 0
    s_waitcnt lgkmcnt(4)
    v_exp_f32 v37, v37
    v_mfma_f32_16x16x32_bf16 v[24:27], v[232:235], v[160:163], 0
    ds_read_b128 v[216:219], v244 offset:33920
    v_add_f32 v241, v241, v36
    v_mfma_f32_16x16x32_bf16 v[88:91], v[232:235], v[164:167], 0
    v_add_f32 v241, v241, v37
    v_mfma_f32_16x16x32_bf16 a[152:155], v[232:235], v[168:171], 0
    v_exp_f32 v38, v38
    v_mfma_f32_16x16x32_bf16 a[216:219], v[232:235], v[172:175], 0
    s_waitcnt lgkmcnt(3)
    v_exp_f32 v39, v39
    v_mfma_f32_16x16x32_bf16 v[28:31], v[236:239], v[160:163], 0
    ds_read_b128 v[220:223], v244 offset:33984
    v_cvt_pk_bf16_f32 v180, v36, v37
    v_mfma_f32_16x16x32_bf16 v[92:95], v[236:239], v[164:167], 0
    v_add_f32 v241, v241, v38
    v_mfma_f32_16x16x32_bf16 a[156:159], v[236:239], v[168:171], 0
    v_exp_f32 v40, v40
    v_mfma_f32_16x16x32_bf16 a[220:223], v[236:239], v[172:175], 0
    s_waitcnt lgkmcnt(3)
    v_add_f32 v241, v241, v39
    v_mfma_f32_16x16x32_bf16 v[144:147], v[208:211], a[0:3], v[192:195]
    ds_read_b128 v[224:227], v244 offset:34048
    v_cvt_pk_bf16_f32 v181, v38, v39
    v_mfma_f32_16x16x32_bf16 v[148:151], v[208:211], a[32:35], v[196:199]
    s_add_u32 m0, s25, 118272
    v_exp_f32 v41, v41
    v_mfma_f32_16x16x32_bf16 v[152:155], v[208:211], a[64:67], v[200:203]
    buffer_load_dwordx4 v247, s[8:11], s28 offen offset:0  lds
    v_mfma_f32_16x16x32_bf16 v[156:159], v[208:211], a[96:99], v[204:207]
    s_waitcnt lgkmcnt(3)
    v_exp_f32 v42, v42
    v_mfma_f32_16x16x32_bf16 v[144:147], v[212:215], a[4:7], v[144:147]
    ds_read_b128 v[228:231], v244 offset:34112
    v_add_f32 v242, v242, v40
    v_mfma_f32_16x16x32_bf16 v[148:151], v[212:215], a[36:39], v[148:151]
    s_add_u32 m0, s25, 118816
    v_add_f32 v242, v242, v41
    v_mfma_f32_16x16x32_bf16 v[152:155], v[212:215], a[68:71], v[152:155]
    buffer_load_dwordx4 v247, s[8:11], s28 offen offset:512  lds
    v_mfma_f32_16x16x32_bf16 v[156:159], v[212:215], a[100:103], v[156:159]
    s_waitcnt lgkmcnt(3)
    v_exp_f32 v43, v43
    v_mfma_f32_16x16x32_bf16 v[144:147], v[216:219], a[8:11], v[144:147]
    ds_read_b128 v[232:235], v244 offset:34176
    v_cvt_pk_bf16_f32 v184, v40, v41
    v_mfma_f32_16x16x32_bf16 v[148:151], v[216:219], a[40:43], v[148:151]
    s_add_u32 m0, s25, 119360
    v_add_f32 v242, v242, v42
    v_mfma_f32_16x16x32_bf16 v[152:155], v[216:219], a[72:75], v[152:155]
    buffer_load_dwordx4 v247, s[8:11], s28 offen offset:1024  lds
    v_mfma_f32_16x16x32_bf16 v[156:159], v[216:219], a[104:107], v[156:159]
    s_waitcnt lgkmcnt(3)
    v_exp_f32 v44, v44
    v_mfma_f32_16x16x32_bf16 v[144:147], v[220:223], a[12:15], v[144:147]
    ds_read_b128 v[236:239], v244 offset:34240
    v_add_f32 v242, v242, v43
    v_mfma_f32_16x16x32_bf16 v[148:151], v[220:223], a[44:47], v[148:151]
    s_add_u32 m0, s25, 119904
    v_exp_f32 v45, v45
    v_mfma_f32_16x16x32_bf16 v[152:155], v[220:223], a[76:79], v[152:155]
    buffer_load_dwordx4 v247, s[8:11], s28 offen offset:1536  lds
    v_mfma_f32_16x16x32_bf16 v[156:159], v[220:223], a[108:111], v[156:159]
    s_waitcnt lgkmcnt(3)
    v_cvt_pk_bf16_f32 v185, v42, v43
    v_mfma_f32_16x16x32_bf16 v[144:147], v[224:227], a[16:19], v[144:147]
    s_add_u32 s28, s28, 32512
    ds_read_b64_tr_b16 v[208:209], v245 offset:16896
    v_add_f32 v243, v243, v44
    v_mfma_f32_16x16x32_bf16 v[148:151], v[224:227], a[48:51], v[148:151]
    ds_read_b64_tr_b16 v[210:211], v245 offset:17408
    v_add_f32 v243, v243, v45
    v_mfma_f32_16x16x32_bf16 v[152:155], v[224:227], a[80:83], v[152:155]
    v_exp_f32 v46, v46
    v_mfma_f32_16x16x32_bf16 v[156:159], v[224:227], a[112:115], v[156:159]
    s_waitcnt lgkmcnt(4)
    v_cvt_pk_bf16_f32 v188, v44, v45
    v_mfma_f32_16x16x32_bf16 v[144:147], v[228:231], a[20:23], v[144:147]
    ds_read_b64_tr_b16 v[212:213], v245 offset:16928
    v_add_f32 v243, v243, v46
    v_mfma_f32_16x16x32_bf16 v[148:151], v[228:231], a[52:55], v[148:151]
    ds_read_b64_tr_b16 v[214:215], v245 offset:17440
    v_mfma_f32_16x16x32_bf16 v[152:155], v[228:231], a[84:87], v[152:155]
    v_exp_f32 v47, v47
    v_mfma_f32_16x16x32_bf16 v[156:159], v[228:231], a[116:119], v[156:159]
    s_waitcnt lgkmcnt(5)
    v_add_f32 v243, v243, v47
    v_cvt_pk_bf16_f32 v189, v46, v47
    v_mfma_f32_16x16x32_bf16 v[144:147], v[232:235], a[24:27], v[144:147]
    ds_read_b64_tr_b16 v[216:217], v245 offset:16960
    v_mfma_f32_16x16x32_bf16 v[148:151], v[232:235], a[56:59], v[148:151]
    ds_read_b64_tr_b16 v[218:219], v245 offset:17472
    v_mfma_f32_16x16x32_bf16 v[152:155], v[232:235], a[88:91], v[152:155]
    v_mfma_f32_16x16x32_bf16 v[156:159], v[232:235], a[120:123], v[156:159]
    s_waitcnt lgkmcnt(6)
    v_mfma_f32_16x16x32_bf16 v[144:147], v[236:239], a[28:31], v[144:147]
    ds_read_b64_tr_b16 v[220:221], v245 offset:16992
    v_mfma_f32_16x16x32_bf16 v[148:151], v[236:239], a[60:63], v[148:151]
    ds_read_b64_tr_b16 v[222:223], v245 offset:17504
    v_mfma_f32_16x16x32_bf16 v[152:155], v[236:239], a[92:95], v[152:155]
    v_mfma_f32_16x16x32_bf16 v[156:159], v[236:239], a[124:127], v[156:159]
    s_waitcnt lgkmcnt(6)
    v_mfma_f32_16x16x32_bf16 v[32:35], v[208:211], v[160:163], 0
    ds_read_b64_tr_b16 v[224:225], v245 offset:17024
    v_mfma_f32_16x16x32_bf16 v[96:99], v[208:211], v[164:167], 0
    s_add_u32 m0, s25, 50688
    ds_read_b64_tr_b16 v[226:227], v245 offset:17536
    v_mfma_f32_16x16x32_bf16 a[160:163], v[208:211], v[168:171], 0
    buffer_load_dwordx4 v246, s[4:7], s27 offen offset:0  lds
    v_mfma_f32_16x16x32_bf16 a[224:227], v[208:211], v[172:175], 0
    s_waitcnt lgkmcnt(6)
    v_exp_f32 v144, v144
    v_mfma_f32_16x16x32_bf16 v[36:39], v[212:215], v[160:163], 0
    ds_read_b64_tr_b16 v[228:229], v245 offset:17056
    v_add_f32 v240, v240, v144
    v_mfma_f32_16x16x32_bf16 v[100:103], v[212:215], v[164:167], 0
    s_add_u32 m0, s25, 51232
    ds_read_b64_tr_b16 v[230:231], v245 offset:17568
    v_mfma_f32_16x16x32_bf16 a[164:167], v[212:215], v[168:171], 0
    buffer_load_dwordx4 v246, s[4:7], s27 offen offset:512  lds
    v_mfma_f32_16x16x32_bf16 a[228:231], v[212:215], v[172:175], 0
    s_waitcnt lgkmcnt(6)
    v_exp_f32 v145, v145
    v_mfma_f32_16x16x32_bf16 v[40:43], v[216:219], v[160:163], 0
    ds_read_b64_tr_b16 v[232:233], v245 offset:17088
    v_add_f32 v240, v240, v145
    v_mfma_f32_16x16x32_bf16 v[104:107], v[216:219], v[164:167], 0
    s_add_u32 m0, s25, 51776
    ds_read_b64_tr_b16 v[234:235], v245 offset:17600
    v_cvt_pk_bf16_f32 v178, v144, v145
    v_mfma_f32_16x16x32_bf16 a[168:171], v[216:219], v[168:171], 0
    buffer_load_dwordx4 v246, s[4:7], s27 offen offset:1024  lds
    v_mfma_f32_16x16x32_bf16 a[232:235], v[216:219], v[172:175], 0
    s_waitcnt lgkmcnt(6)
    v_mfma_f32_16x16x32_bf16 v[44:47], v[220:223], v[160:163], 0
    ds_read_b64_tr_b16 v[236:237], v245 offset:17120
    v_mfma_f32_16x16x32_bf16 v[108:111], v[220:223], v[164:167], 0
    s_add_u32 m0, s25, 52320
    ds_read_b64_tr_b16 v[238:239], v245 offset:17632
    v_mfma_f32_16x16x32_bf16 a[172:175], v[220:223], v[168:171], 0
    buffer_load_dwordx4 v246, s[4:7], s27 offen offset:1536  lds
    v_mfma_f32_16x16x32_bf16 a[236:239], v[220:223], v[172:175], 0
    s_waitcnt vmcnt(12) lgkmcnt(6)
    s_barrier
    v_mfma_f32_16x16x32_bf16 v[48:51], v[224:227], v[160:163], 0
    s_add_u32 s27, s27, 8192
    ds_read_b128 v[208:211], v244 offset:0
    v_mfma_f32_16x16x32_bf16 v[112:115], v[224:227], v[164:167], 0
    v_exp_f32 v146, v146
    v_mfma_f32_16x16x32_bf16 a[176:179], v[224:227], v[168:171], 0
    v_exp_f32 v147, v147
    v_mfma_f32_16x16x32_bf16 a[240:243], v[224:227], v[172:175], 0
    s_waitcnt lgkmcnt(5)
    v_add_f32 v240, v240, v146
    v_mfma_f32_16x16x32_bf16 v[52:55], v[228:231], v[160:163], 0
    s_mov_b32 s29, 14
    ds_read_b128 v[212:215], v244 offset:64
    v_add_f32 v240, v240, v147
    v_mfma_f32_16x16x32_bf16 v[116:119], v[228:231], v[164:167], 0
    v_exp_f32 v148, v148
    v_mfma_f32_16x16x32_bf16 a[180:183], v[228:231], v[168:171], 0
    v_cvt_pk_bf16_f32 v179, v146, v147
    v_mfma_f32_16x16x32_bf16 a[244:247], v[228:231], v[172:175], 0
    s_waitcnt lgkmcnt(4)
    v_exp_f32 v149, v149
    v_mfma_f32_16x16x32_bf16 v[56:59], v[232:235], v[160:163], 0
    ds_read_b128 v[216:219], v244 offset:128
    v_add_f32 v241, v241, v148
    v_mfma_f32_16x16x32_bf16 v[120:123], v[232:235], v[164:167], 0
    v_exp_f32 v150, v150
    v_mfma_f32_16x16x32_bf16 a[184:187], v[232:235], v[168:171], 0
    v_add_f32 v241, v241, v149
    v_mfma_f32_16x16x32_bf16 a[248:251], v[232:235], v[172:175], 0
    s_waitcnt lgkmcnt(3)
    v_exp_f32 v151, v151
    v_mfma_f32_16x16x32_bf16 v[60:63], v[236:239], v[160:163], 0
    ds_read_b128 v[220:223], v244 offset:192
    v_cvt_pk_bf16_f32 v182, v148, v149
    v_mfma_f32_16x16x32_bf16 v[124:127], v[236:239], v[164:167], 0
    v_add_f32 v241, v241, v150
    v_mfma_f32_16x16x32_bf16 a[188:191], v[236:239], v[168:171], 0
    v_exp_f32 v152, v152
    v_mfma_f32_16x16x32_bf16 a[252:255], v[236:239], v[172:175], 0
    s_waitcnt lgkmcnt(3)
.p2align 6
k1_loop:
    v_mfma_f32_16x16x32_bf16 v[128:131], v[208:211], a[0:3], v[192:195]
    ds_read_b128 v[224:227], v244 offset:256
    v_add_f32 v241, v241, v151
    v_mfma_f32_16x16x32_bf16 v[132:135], v[208:211], a[32:35], v[196:199]
    s_add_u32 m0, s25, 67584
    v_exp_f32 v153, v153
    v_mfma_f32_16x16x32_bf16 v[136:139], v[208:211], a[64:67], v[200:203]
    buffer_load_dwordx4 v247, s[8:11], s28 offen offset:0  lds
    v_mfma_f32_16x16x32_bf16 v[140:143], v[208:211], a[96:99], v[204:207]
    s_waitcnt lgkmcnt(3)
    v_cvt_pk_bf16_f32 v183, v150, v151
    v_mfma_f32_16x16x32_bf16 v[128:131], v[212:215], a[4:7], v[128:131]
    ds_read_b128 v[228:231], v244 offset:320
    v_add_f32 v242, v242, v152
    v_mfma_f32_16x16x32_bf16 v[132:135], v[212:215], a[36:39], v[132:135]
    s_add_u32 m0, s25, 68128
    v_exp_f32 v154, v154
    v_mfma_f32_16x16x32_bf16 v[136:139], v[212:215], a[68:71], v[136:139]
    buffer_load_dwordx4 v247, s[8:11], s28 offen offset:512  lds
    v_mfma_f32_16x16x32_bf16 v[140:143], v[212:215], a[100:103], v[140:143]
    s_waitcnt lgkmcnt(3)
    v_exp_f32 v155, v155
    v_mfma_f32_16x16x32_bf16 v[128:131], v[216:219], a[8:11], v[128:131]
    ds_read_b128 v[232:235], v244 offset:384
    v_add_f32 v242, v242, v153
    v_mfma_f32_16x16x32_bf16 v[132:135], v[216:219], a[40:43], v[132:135]
    s_add_u32 m0, s25, 68672
    v_cvt_pk_bf16_f32 v186, v152, v153
    v_mfma_f32_16x16x32_bf16 v[136:139], v[216:219], a[72:75], v[136:139]
    buffer_load_dwordx4 v247, s[8:11], s28 offen offset:1024  lds
    v_mfma_f32_16x16x32_bf16 v[140:143], v[216:219], a[104:107], v[140:143]
    s_waitcnt lgkmcnt(3)
    v_exp_f32 v156, v156
    v_mfma_f32_16x16x32_bf16 v[128:131], v[220:223], a[12:15], v[128:131]
    ds_read_b128 v[236:239], v244 offset:448
    v_add_f32 v242, v242, v154
    v_mfma_f32_16x16x32_bf16 v[132:135], v[220:223], a[44:47], v[132:135]
    s_add_u32 m0, s25, 69216
    v_add_f32 v242, v242, v155
    v_mfma_f32_16x16x32_bf16 v[136:139], v[220:223], a[76:79], v[136:139]
    buffer_load_dwordx4 v247, s[8:11], s28 offen offset:1536  lds
    v_mfma_f32_16x16x32_bf16 v[140:143], v[220:223], a[108:111], v[140:143]
    s_waitcnt lgkmcnt(3)
    v_exp_f32 v157, v157
    v_mfma_f32_16x16x32_bf16 v[128:131], v[224:227], a[16:19], v[128:131]
    s_add_u32 s28, s28, 256
    ds_read_b64_tr_b16 v[208:209], v245 offset:33792
    v_cvt_pk_bf16_f32 v187, v154, v155
    v_mfma_f32_16x16x32_bf16 v[132:135], v[224:227], a[48:51], v[132:135]
    ds_read_b64_tr_b16 v[210:211], v245 offset:34304
    v_add_f32 v243, v243, v156
    v_mfma_f32_16x16x32_bf16 v[136:139], v[224:227], a[80:83], v[136:139]
    v_exp_f32 v158, v158
    v_mfma_f32_16x16x32_bf16 v[140:143], v[224:227], a[112:115], v[140:143]
    s_waitcnt lgkmcnt(4)
    v_add_f32 v243, v243, v157
    v_mfma_f32_16x16x32_bf16 v[128:131], v[228:231], a[20:23], v[128:131]
    ds_read_b64_tr_b16 v[212:213], v245 offset:33824
    v_cvt_pk_bf16_f32 v190, v156, v157
    v_mfma_f32_16x16x32_bf16 v[132:135], v[228:231], a[52:55], v[132:135]
    ds_read_b64_tr_b16 v[214:215], v245 offset:34336
    v_add_f32 v243, v243, v158
    v_mfma_f32_16x16x32_bf16 v[136:139], v[228:231], a[84:87], v[136:139]
    v_exp_f32 v159, v159
    v_mfma_f32_16x16x32_bf16 v[140:143], v[228:231], a[116:119], v[140:143]
    s_waitcnt lgkmcnt(5)
    v_add_f32 v243, v243, v159
    v_cvt_pk_bf16_f32 v191, v158, v159
    v_mfma_f32_16x16x32_bf16 v[128:131], v[232:235], a[24:27], v[128:131]
    ds_read_b64_tr_b16 v[216:217], v245 offset:33856
    v_mfma_f32_16x16x32_bf16 v[132:135], v[232:235], a[56:59], v[132:135]
    ds_read_b64_tr_b16 v[218:219], v245 offset:34368
    v_mfma_f32_16x16x32_bf16 v[136:139], v[232:235], a[88:91], v[136:139]
    v_mfma_f32_16x16x32_bf16 v[140:143], v[232:235], a[120:123], v[140:143]
    s_waitcnt lgkmcnt(6)
    v_mfma_f32_16x16x32_bf16 v[128:131], v[236:239], a[28:31], v[128:131]
    ds_read_b64_tr_b16 v[220:221], v245 offset:33888
    v_mfma_f32_16x16x32_bf16 v[132:135], v[236:239], a[60:63], v[132:135]
    ds_read_b64_tr_b16 v[222:223], v245 offset:34400
    v_mfma_f32_16x16x32_bf16 v[136:139], v[236:239], a[92:95], v[136:139]
    v_mfma_f32_16x16x32_bf16 v[140:143], v[236:239], a[124:127], v[140:143]
    s_waitcnt lgkmcnt(6)
    v_mfma_f32_16x16x32_bf16 v[0:3], v[208:211], v[176:179], v[0:3]
    ds_read_b64_tr_b16 v[224:225], v245 offset:33920
    v_mfma_f32_16x16x32_bf16 v[64:67], v[208:211], v[180:183], v[64:67]
    s_add_u32 m0, s25, 33792
    ds_read_b64_tr_b16 v[226:227], v245 offset:34432
    buffer_load_dword v251, v249, s[4:7], s96 offen
    v_mfma_f32_16x16x32_bf16 a[128:131], v[208:211], v[184:187], a[128:131]
    buffer_load_dwordx4 v246, s[4:7], s27 offen offset:0  lds
    v_mfma_f32_16x16x32_bf16 a[192:195], v[208:211], v[188:191], a[192:195]
    s_waitcnt lgkmcnt(6)
    v_exp_f32 v128, v128
    v_mfma_f32_16x16x32_bf16 v[4:7], v[212:215], v[176:179], v[4:7]
    ds_read_b64_tr_b16 v[228:229], v245 offset:33952
    v_add_f32 v240, v240, v128
    v_mfma_f32_16x16x32_bf16 v[68:71], v[212:215], v[180:183], v[68:71]
    s_add_u32 m0, s25, 34336
    ds_read_b64_tr_b16 v[230:231], v245 offset:34464
    v_mfma_f32_16x16x32_bf16 a[132:135], v[212:215], v[184:187], a[132:135]
    buffer_load_dwordx4 v246, s[4:7], s27 offen offset:512  lds
    v_mfma_f32_16x16x32_bf16 a[196:199], v[212:215], v[188:191], a[196:199]
    s_waitcnt lgkmcnt(6)
    v_exp_f32 v129, v129
    v_mfma_f32_16x16x32_bf16 v[8:11], v[216:219], v[176:179], v[8:11]
    ds_read_b64_tr_b16 v[232:233], v245 offset:33984
    v_add_f32 v240, v240, v129
    v_mfma_f32_16x16x32_bf16 v[72:75], v[216:219], v[180:183], v[72:75]
    s_add_u32 m0, s25, 34880
    ds_read_b64_tr_b16 v[234:235], v245 offset:34496
    v_cvt_pk_bf16_f32 v160, v128, v129
    v_mfma_f32_16x16x32_bf16 a[136:139], v[216:219], v[184:187], a[136:139]
    buffer_load_dwordx4 v246, s[4:7], s27 offen offset:1024  lds
    v_mfma_f32_16x16x32_bf16 a[200:203], v[216:219], v[188:191], a[200:203]
    s_waitcnt lgkmcnt(6)
    v_mfma_f32_16x16x32_bf16 v[12:15], v[220:223], v[176:179], v[12:15]
    ds_read_b64_tr_b16 v[236:237], v245 offset:34016
    v_mfma_f32_16x16x32_bf16 v[76:79], v[220:223], v[180:183], v[76:79]
    s_add_u32 m0, s25, 35424
    ds_read_b64_tr_b16 v[238:239], v245 offset:34528
    v_mfma_f32_16x16x32_bf16 a[140:143], v[220:223], v[184:187], a[140:143]
    buffer_load_dwordx4 v246, s[4:7], s27 offen offset:1536  lds
    v_mfma_f32_16x16x32_bf16 a[204:207], v[220:223], v[188:191], a[204:207]
    s_waitcnt vmcnt(13) lgkmcnt(6)
    s_barrier
    v_mfma_f32_16x16x32_bf16 v[16:19], v[224:227], v[176:179], v[16:19]
    s_add_u32 s27, s27, 24576
    ds_read_b128 v[208:211], v244 offset:16896
    v_mfma_f32_16x16x32_bf16 v[80:83], v[224:227], v[180:183], v[80:83]
    v_exp_f32 v130, v130
    v_mfma_f32_16x16x32_bf16 a[144:147], v[224:227], v[184:187], a[144:147]
    v_add_f32 v240, v240, v130
    v_mfma_f32_16x16x32_bf16 a[208:211], v[224:227], v[188:191], a[208:211]
    s_waitcnt lgkmcnt(5)
    v_exp_f32 v131, v131
    v_mfma_f32_16x16x32_bf16 v[20:23], v[228:231], v[176:179], v[20:23]
    ds_read_b128 v[212:215], v244 offset:16960
    v_add_f32 v240, v240, v131
    v_mfma_f32_16x16x32_bf16 v[84:87], v[228:231], v[180:183], v[84:87]
    v_exp_f32 v132, v132
    v_mfma_f32_16x16x32_bf16 a[148:151], v[228:231], v[184:187], a[148:151]
    v_cvt_pk_bf16_f32 v161, v130, v131
    v_mfma_f32_16x16x32_bf16 a[212:215], v[228:231], v[188:191], a[212:215]
    s_waitcnt lgkmcnt(4)
    v_exp_f32 v133, v133
    v_mfma_f32_16x16x32_bf16 v[24:27], v[232:235], v[176:179], v[24:27]
    ds_read_b128 v[216:219], v244 offset:17024
    v_add_f32 v241, v241, v132
    v_mfma_f32_16x16x32_bf16 v[88:91], v[232:235], v[180:183], v[88:91]
    v_add_f32 v241, v241, v133
    v_mfma_f32_16x16x32_bf16 a[152:155], v[232:235], v[184:187], a[152:155]
    v_exp_f32 v134, v134
    v_mfma_f32_16x16x32_bf16 a[216:219], v[232:235], v[188:191], a[216:219]
    s_waitcnt lgkmcnt(3)
    v_exp_f32 v135, v135
    v_mfma_f32_16x16x32_bf16 v[28:31], v[236:239], v[176:179], v[28:31]
    ds_read_b128 v[220:223], v244 offset:17088
    v_cvt_pk_bf16_f32 v164, v132, v133
    v_mfma_f32_16x16x32_bf16 v[92:95], v[236:239], v[180:183], v[92:95]
    v_add_f32 v241, v241, v134
    v_mfma_f32_16x16x32_bf16 a[156:159], v[236:239], v[184:187], a[156:159]
    v_exp_f32 v136, v136
    v_mfma_f32_16x16x32_bf16 a[220:223], v[236:239], v[188:191], a[220:223]
    s_waitcnt lgkmcnt(3)
    v_add_f32 v241, v241, v135
    v_mfma_f32_16x16x32_bf16 v[144:147], v[208:211], a[0:3], v[192:195]
    ds_read_b128 v[224:227], v244 offset:17152
    v_cvt_pk_bf16_f32 v165, v134, v135
    v_mfma_f32_16x16x32_bf16 v[148:151], v[208:211], a[32:35], v[196:199]
    s_add_u32 m0, s25, 84480
    v_exp_f32 v137, v137
    v_mfma_f32_16x16x32_bf16 v[152:155], v[208:211], a[64:67], v[200:203]
    buffer_load_dwordx4 v247, s[8:11], s28 offen offset:0  lds
    v_mfma_f32_16x16x32_bf16 v[156:159], v[208:211], a[96:99], v[204:207]
    s_waitcnt lgkmcnt(3)
    v_exp_f32 v138, v138
    v_mfma_f32_16x16x32_bf16 v[144:147], v[212:215], a[4:7], v[144:147]
    ds_read_b128 v[228:231], v244 offset:17216
    v_add_f32 v242, v242, v136
    v_mfma_f32_16x16x32_bf16 v[148:151], v[212:215], a[36:39], v[148:151]
    s_add_u32 m0, s25, 85024
    v_add_f32 v242, v242, v137
    v_mfma_f32_16x16x32_bf16 v[152:155], v[212:215], a[68:71], v[152:155]
    buffer_load_dwordx4 v247, s[8:11], s28 offen offset:512  lds
    v_mfma_f32_16x16x32_bf16 v[156:159], v[212:215], a[100:103], v[156:159]
    s_waitcnt lgkmcnt(3)
    v_exp_f32 v139, v139
    v_mfma_f32_16x16x32_bf16 v[144:147], v[216:219], a[8:11], v[144:147]
    ds_read_b128 v[232:235], v244 offset:17280
    v_cvt_pk_bf16_f32 v168, v136, v137
    v_mfma_f32_16x16x32_bf16 v[148:151], v[216:219], a[40:43], v[148:151]
    s_add_u32 m0, s25, 85568
    v_add_f32 v242, v242, v138
    v_mfma_f32_16x16x32_bf16 v[152:155], v[216:219], a[72:75], v[152:155]
    buffer_load_dwordx4 v247, s[8:11], s28 offen offset:1024  lds
    v_mfma_f32_16x16x32_bf16 v[156:159], v[216:219], a[104:107], v[156:159]
    s_waitcnt lgkmcnt(3)
    v_exp_f32 v140, v140
    v_mfma_f32_16x16x32_bf16 v[144:147], v[220:223], a[12:15], v[144:147]
    ds_read_b128 v[236:239], v244 offset:17344
    v_add_f32 v242, v242, v139
    v_mfma_f32_16x16x32_bf16 v[148:151], v[220:223], a[44:47], v[148:151]
    s_add_u32 m0, s25, 86112
    v_exp_f32 v141, v141
    v_mfma_f32_16x16x32_bf16 v[152:155], v[220:223], a[76:79], v[152:155]
    buffer_load_dwordx4 v247, s[8:11], s28 offen offset:1536  lds
    v_mfma_f32_16x16x32_bf16 v[156:159], v[220:223], a[108:111], v[156:159]
    s_waitcnt lgkmcnt(3)
    v_cvt_pk_bf16_f32 v169, v138, v139
    v_mfma_f32_16x16x32_bf16 v[144:147], v[224:227], a[16:19], v[144:147]
    s_add_u32 s28, s28, 32512
    ds_read_b64_tr_b16 v[208:209], v245 offset:50688
    v_add_f32 v243, v243, v140
    v_mfma_f32_16x16x32_bf16 v[148:151], v[224:227], a[48:51], v[148:151]
    ds_read_b64_tr_b16 v[210:211], v245 offset:51200
    v_add_f32 v243, v243, v141
    v_mfma_f32_16x16x32_bf16 v[152:155], v[224:227], a[80:83], v[152:155]
    v_exp_f32 v142, v142
    v_mfma_f32_16x16x32_bf16 v[156:159], v[224:227], a[112:115], v[156:159]
    s_waitcnt lgkmcnt(4)
    v_cvt_pk_bf16_f32 v172, v140, v141
    v_mfma_f32_16x16x32_bf16 v[144:147], v[228:231], a[20:23], v[144:147]
    ds_read_b64_tr_b16 v[212:213], v245 offset:50720
    v_add_f32 v243, v243, v142
    v_mfma_f32_16x16x32_bf16 v[148:151], v[228:231], a[52:55], v[148:151]
    ds_read_b64_tr_b16 v[214:215], v245 offset:51232
    v_mfma_f32_16x16x32_bf16 v[152:155], v[228:231], a[84:87], v[152:155]
    v_exp_f32 v143, v143
    v_mfma_f32_16x16x32_bf16 v[156:159], v[228:231], a[116:119], v[156:159]
    s_waitcnt lgkmcnt(5)
    v_add_f32 v243, v243, v143
    v_cvt_pk_bf16_f32 v173, v142, v143
    v_mfma_f32_16x16x32_bf16 v[144:147], v[232:235], a[24:27], v[144:147]
    ds_read_b64_tr_b16 v[216:217], v245 offset:50752
    v_mfma_f32_16x16x32_bf16 v[148:151], v[232:235], a[56:59], v[148:151]
    ds_read_b64_tr_b16 v[218:219], v245 offset:51264
    v_mfma_f32_16x16x32_bf16 v[152:155], v[232:235], a[88:91], v[152:155]
    v_mfma_f32_16x16x32_bf16 v[156:159], v[232:235], a[120:123], v[156:159]
    s_waitcnt lgkmcnt(6)
    v_mfma_f32_16x16x32_bf16 v[144:147], v[236:239], a[28:31], v[144:147]
    ds_read_b64_tr_b16 v[220:221], v245 offset:50784
    v_mfma_f32_16x16x32_bf16 v[148:151], v[236:239], a[60:63], v[148:151]
    ds_read_b64_tr_b16 v[222:223], v245 offset:51296
    v_mfma_f32_16x16x32_bf16 v[152:155], v[236:239], a[92:95], v[152:155]
    v_mfma_f32_16x16x32_bf16 v[156:159], v[236:239], a[124:127], v[156:159]
    s_waitcnt lgkmcnt(6)
    v_mfma_f32_16x16x32_bf16 v[32:35], v[208:211], v[176:179], v[32:35]
    ds_read_b64_tr_b16 v[224:225], v245 offset:50816
    v_mfma_f32_16x16x32_bf16 v[96:99], v[208:211], v[180:183], v[96:99]
    s_add_u32 m0, s25, 0
    ds_read_b64_tr_b16 v[226:227], v245 offset:51328
    v_mfma_f32_16x16x32_bf16 a[160:163], v[208:211], v[184:187], a[160:163]
    buffer_load_dwordx4 v246, s[4:7], s27 offen offset:0  lds
    v_mfma_f32_16x16x32_bf16 a[224:227], v[208:211], v[188:191], a[224:227]
    s_waitcnt lgkmcnt(6)
    v_exp_f32 v144, v144
    v_mfma_f32_16x16x32_bf16 v[36:39], v[212:215], v[176:179], v[36:39]
    ds_read_b64_tr_b16 v[228:229], v245 offset:50848
    v_add_f32 v240, v240, v144
    v_mfma_f32_16x16x32_bf16 v[100:103], v[212:215], v[180:183], v[100:103]
    s_add_u32 m0, s25, 544
    ds_read_b64_tr_b16 v[230:231], v245 offset:51360
    v_mfma_f32_16x16x32_bf16 a[164:167], v[212:215], v[184:187], a[164:167]
    buffer_load_dwordx4 v246, s[4:7], s27 offen offset:512  lds
    v_mfma_f32_16x16x32_bf16 a[228:231], v[212:215], v[188:191], a[228:231]
    s_waitcnt lgkmcnt(6)
    v_exp_f32 v145, v145
    v_mfma_f32_16x16x32_bf16 v[40:43], v[216:219], v[176:179], v[40:43]
    ds_read_b64_tr_b16 v[232:233], v245 offset:50880
    v_add_f32 v240, v240, v145
    v_mfma_f32_16x16x32_bf16 v[104:107], v[216:219], v[180:183], v[104:107]
    s_add_u32 m0, s25, 1088
    ds_read_b64_tr_b16 v[234:235], v245 offset:51392
    v_cvt_pk_bf16_f32 v162, v144, v145
    v_mfma_f32_16x16x32_bf16 a[168:171], v[216:219], v[184:187], a[168:171]
    buffer_load_dwordx4 v246, s[4:7], s27 offen offset:1024  lds
    v_mfma_f32_16x16x32_bf16 a[232:235], v[216:219], v[188:191], a[232:235]
    s_waitcnt lgkmcnt(6)
    v_mfma_f32_16x16x32_bf16 v[44:47], v[220:223], v[176:179], v[44:47]
    ds_read_b64_tr_b16 v[236:237], v245 offset:50912
    v_mfma_f32_16x16x32_bf16 v[108:111], v[220:223], v[180:183], v[108:111]
    s_add_u32 m0, s25, 1632
    ds_read_b64_tr_b16 v[238:239], v245 offset:51424
    v_mfma_f32_16x16x32_bf16 a[172:175], v[220:223], v[184:187], a[172:175]
    buffer_load_dwordx4 v246, s[4:7], s27 offen offset:1536  lds
    v_mfma_f32_16x16x32_bf16 a[236:239], v[220:223], v[188:191], a[236:239]
    s_waitcnt vmcnt(13) lgkmcnt(6)
    s_barrier
    v_mfma_f32_16x16x32_bf16 v[48:51], v[224:227], v[176:179], v[48:51]
    s_add_u32 s27, s27, 8192
    ds_read_b128 v[208:211], v244 offset:50688
    v_mfma_f32_16x16x32_bf16 v[112:115], v[224:227], v[180:183], v[112:115]
    v_exp_f32 v146, v146
    v_mfma_f32_16x16x32_bf16 a[176:179], v[224:227], v[184:187], a[176:179]
    v_exp_f32 v147, v147
    v_mfma_f32_16x16x32_bf16 a[240:243], v[224:227], v[188:191], a[240:243]
    s_waitcnt lgkmcnt(5)
    v_add_f32 v240, v240, v146
    v_mfma_f32_16x16x32_bf16 v[52:55], v[228:231], v[176:179], v[52:55]
    ds_read_b128 v[212:215], v244 offset:50752
    v_add_f32 v240, v240, v147
    v_mfma_f32_16x16x32_bf16 v[116:119], v[228:231], v[180:183], v[116:119]
    v_exp_f32 v148, v148
    v_mfma_f32_16x16x32_bf16 a[180:183], v[228:231], v[184:187], a[180:183]
    v_cvt_pk_bf16_f32 v163, v146, v147
    v_mfma_f32_16x16x32_bf16 a[244:247], v[228:231], v[188:191], a[244:247]
    s_waitcnt lgkmcnt(4)
    v_exp_f32 v149, v149
    v_mfma_f32_16x16x32_bf16 v[56:59], v[232:235], v[176:179], v[56:59]
    ds_read_b128 v[216:219], v244 offset:50816
    v_add_f32 v241, v241, v148
    v_mfma_f32_16x16x32_bf16 v[120:123], v[232:235], v[180:183], v[120:123]
    v_exp_f32 v150, v150
    v_mfma_f32_16x16x32_bf16 a[184:187], v[232:235], v[184:187], a[184:187]
    v_add_f32 v241, v241, v149
    v_mfma_f32_16x16x32_bf16 a[248:251], v[232:235], v[188:191], a[248:251]
    s_waitcnt lgkmcnt(3)
    v_exp_f32 v151, v151
    v_mfma_f32_16x16x32_bf16 v[60:63], v[236:239], v[176:179], v[60:63]
    ds_read_b128 v[220:223], v244 offset:50880
    v_cvt_pk_bf16_f32 v166, v148, v149
    v_mfma_f32_16x16x32_bf16 v[124:127], v[236:239], v[180:183], v[124:127]
    v_add_f32 v241, v241, v150
    v_mfma_f32_16x16x32_bf16 a[188:191], v[236:239], v[184:187], a[188:191]
    v_exp_f32 v152, v152
    v_mfma_f32_16x16x32_bf16 a[252:255], v[236:239], v[188:191], a[252:255]
    s_waitcnt lgkmcnt(3)
    v_mfma_f32_16x16x32_bf16 v[128:131], v[208:211], a[0:3], v[192:195]
    ds_read_b128 v[224:227], v244 offset:50944
    v_add_f32 v241, v241, v151
    v_mfma_f32_16x16x32_bf16 v[132:135], v[208:211], a[32:35], v[196:199]
    s_add_u32 m0, s25, 101376
    v_exp_f32 v153, v153
    v_mfma_f32_16x16x32_bf16 v[136:139], v[208:211], a[64:67], v[200:203]
    buffer_load_dwordx4 v247, s[8:11], s28 offen offset:0  lds
    v_mfma_f32_16x16x32_bf16 v[140:143], v[208:211], a[96:99], v[204:207]
    s_waitcnt lgkmcnt(3)
    v_cvt_pk_bf16_f32 v167, v150, v151
    v_mfma_f32_16x16x32_bf16 v[128:131], v[212:215], a[4:7], v[128:131]
    ds_read_b128 v[228:231], v244 offset:51008
    v_add_f32 v242, v242, v152
    v_mfma_f32_16x16x32_bf16 v[132:135], v[212:215], a[36:39], v[132:135]
    s_add_u32 m0, s25, 101920
    v_exp_f32 v154, v154
    v_mfma_f32_16x16x32_bf16 v[136:139], v[212:215], a[68:71], v[136:139]
    buffer_load_dwordx4 v247, s[8:11], s28 offen offset:512  lds
    v_mfma_f32_16x16x32_bf16 v[140:143], v[212:215], a[100:103], v[140:143]
    s_waitcnt lgkmcnt(3)
    v_exp_f32 v155, v155
    v_mfma_f32_16x16x32_bf16 v[128:131], v[216:219], a[8:11], v[128:131]
    ds_read_b128 v[232:235], v244 offset:51072
    v_add_f32 v242, v242, v153
    v_mfma_f32_16x16x32_bf16 v[132:135], v[216:219], a[40:43], v[132:135]
    s_add_u32 m0, s25, 102464
    v_cvt_pk_bf16_f32 v170, v152, v153
    v_mfma_f32_16x16x32_bf16 v[136:139], v[216:219], a[72:75], v[136:139]
    buffer_load_dwordx4 v247, s[8:11], s28 offen offset:1024  lds
    v_mfma_f32_16x16x32_bf16 v[140:143], v[216:219], a[104:107], v[140:143]
    s_waitcnt lgkmcnt(3)
    v_exp_f32 v156, v156
    v_mfma_f32_16x16x32_bf16 v[128:131], v[220:223], a[12:15], v[128:131]
    ds_read_b128 v[236:239], v244 offset:51136
    v_add_f32 v242, v242, v154
    v_mfma_f32_16x16x32_bf16 v[132:135], v[220:223], a[44:47], v[132:135]
    s_add_u32 m0, s25, 103008
    v_add_f32 v242, v242, v155
    v_mfma_f32_16x16x32_bf16 v[136:139], v[220:223], a[76:79], v[136:139]
    buffer_load_dwordx4 v247, s[8:11], s28 offen offset:1536  lds
    v_mfma_f32_16x16x32_bf16 v[140:143], v[220:223], a[108:111], v[140:143]
    s_waitcnt lgkmcnt(3)
    v_exp_f32 v157, v157
    v_mfma_f32_16x16x32_bf16 v[128:131], v[224:227], a[16:19], v[128:131]
    s_add_u32 s28, s28, 256
    ds_read_b64_tr_b16 v[208:209], v245 offset:0
    v_cvt_pk_bf16_f32 v171, v154, v155
    v_mfma_f32_16x16x32_bf16 v[132:135], v[224:227], a[48:51], v[132:135]
    ds_read_b64_tr_b16 v[210:211], v245 offset:512
    v_add_f32 v243, v243, v156
    v_mfma_f32_16x16x32_bf16 v[136:139], v[224:227], a[80:83], v[136:139]
    v_exp_f32 v158, v158
    v_mfma_f32_16x16x32_bf16 v[140:143], v[224:227], a[112:115], v[140:143]
    s_waitcnt lgkmcnt(4)
    v_add_f32 v243, v243, v157
    v_mfma_f32_16x16x32_bf16 v[128:131], v[228:231], a[20:23], v[128:131]
    ds_read_b64_tr_b16 v[212:213], v245 offset:32
    v_cvt_pk_bf16_f32 v174, v156, v157
    v_mfma_f32_16x16x32_bf16 v[132:135], v[228:231], a[52:55], v[132:135]
    ds_read_b64_tr_b16 v[214:215], v245 offset:544
    v_add_f32 v243, v243, v158
    v_mfma_f32_16x16x32_bf16 v[136:139], v[228:231], a[84:87], v[136:139]
    v_exp_f32 v159, v159
    v_mfma_f32_16x16x32_bf16 v[140:143], v[228:231], a[116:119], v[140:143]
    s_waitcnt lgkmcnt(5)
    v_add_f32 v243, v243, v159
    v_cvt_pk_bf16_f32 v175, v158, v159
    v_mfma_f32_16x16x32_bf16 v[128:131], v[232:235], a[24:27], v[128:131]
    ds_read_b64_tr_b16 v[216:217], v245 offset:64
    v_mfma_f32_16x16x32_bf16 v[132:135], v[232:235], a[56:59], v[132:135]
    ds_read_b64_tr_b16 v[218:219], v245 offset:576
    v_mfma_f32_16x16x32_bf16 v[136:139], v[232:235], a[88:91], v[136:139]
    v_mfma_f32_16x16x32_bf16 v[140:143], v[232:235], a[120:123], v[140:143]
    s_waitcnt lgkmcnt(6)
    v_mfma_f32_16x16x32_bf16 v[128:131], v[236:239], a[28:31], v[128:131]
    ds_read_b64_tr_b16 v[220:221], v245 offset:96
    v_mfma_f32_16x16x32_bf16 v[132:135], v[236:239], a[60:63], v[132:135]
    ds_read_b64_tr_b16 v[222:223], v245 offset:608
    v_mfma_f32_16x16x32_bf16 v[136:139], v[236:239], a[92:95], v[136:139]
    v_mfma_f32_16x16x32_bf16 v[140:143], v[236:239], a[124:127], v[140:143]
    s_waitcnt lgkmcnt(6)
    v_mfma_f32_16x16x32_bf16 v[0:3], v[208:211], v[160:163], v[0:3]
    ds_read_b64_tr_b16 v[224:225], v245 offset:128
    v_mfma_f32_16x16x32_bf16 v[64:67], v[208:211], v[164:167], v[64:67]
    s_add_u32 m0, s25, 16896
    ds_read_b64_tr_b16 v[226:227], v245 offset:640
    buffer_load_dword v251, v249, s[8:11], s96 offen
    v_mfma_f32_16x16x32_bf16 a[128:131], v[208:211], v[168:171], a[128:131]
    buffer_load_dwordx4 v246, s[4:7], s27 offen offset:0  lds
    v_mfma_f32_16x16x32_bf16 a[192:195], v[208:211], v[172:175], a[192:195]
    s_waitcnt lgkmcnt(6)
    v_exp_f32 v128, v128
    v_mfma_f32_16x16x32_bf16 v[4:7], v[212:215], v[160:163], v[4:7]
    ds_read_b64_tr_b16 v[228:229], v245 offset:160
    v_add_f32 v240, v240, v128
    v_mfma_f32_16x16x32_bf16 v[68:71], v[212:215], v[164:167], v[68:71]
    s_add_u32 m0, s25, 17440
    ds_read_b64_tr_b16 v[230:231], v245 offset:672
    v_mfma_f32_16x16x32_bf16 a[132:135], v[212:215], v[168:171], a[132:135]
    buffer_load_dwordx4 v246, s[4:7], s27 offen offset:512  lds
    v_mfma_f32_16x16x32_bf16 a[196:199], v[212:215], v[172:175], a[196:199]
    s_waitcnt lgkmcnt(6)
    v_exp_f32 v129, v129
    v_mfma_f32_16x16x32_bf16 v[8:11], v[216:219], v[160:163], v[8:11]
    ds_read_b64_tr_b16 v[232:233], v245 offset:192
    v_add_f32 v240, v240, v129
    v_mfma_f32_16x16x32_bf16 v[72:75], v[216:219], v[164:167], v[72:75]
    s_add_u32 m0, s25, 17984
    ds_read_b64_tr_b16 v[234:235], v245 offset:704
    v_cvt_pk_bf16_f32 v176, v128, v129
    v_mfma_f32_16x16x32_bf16 a[136:139], v[216:219], v[168:171], a[136:139]
    buffer_load_dwordx4 v246, s[4:7], s27 offen offset:1024  lds
    v_mfma_f32_16x16x32_bf16 a[200:203], v[216:219], v[172:175], a[200:203]
    s_waitcnt lgkmcnt(6)
    v_mfma_f32_16x16x32_bf16 v[12:15], v[220:223], v[160:163], v[12:15]
    ds_read_b64_tr_b16 v[236:237], v245 offset:224
    v_mfma_f32_16x16x32_bf16 v[76:79], v[220:223], v[164:167], v[76:79]
    s_add_u32 m0, s25, 18528
    ds_read_b64_tr_b16 v[238:239], v245 offset:736
    v_mfma_f32_16x16x32_bf16 a[140:143], v[220:223], v[168:171], a[140:143]
    buffer_load_dwordx4 v246, s[4:7], s27 offen offset:1536  lds
    v_mfma_f32_16x16x32_bf16 a[204:207], v[220:223], v[172:175], a[204:207]
    s_waitcnt vmcnt(13) lgkmcnt(6)
    s_barrier
    v_mfma_f32_16x16x32_bf16 v[16:19], v[224:227], v[160:163], v[16:19]
    s_add_u32 s27, s27, 24576
    ds_read_b128 v[208:211], v244 offset:33792
    v_mfma_f32_16x16x32_bf16 v[80:83], v[224:227], v[164:167], v[80:83]
    v_exp_f32 v130, v130
    v_mfma_f32_16x16x32_bf16 a[144:147], v[224:227], v[168:171], a[144:147]
    v_add_f32 v240, v240, v130
    v_mfma_f32_16x16x32_bf16 a[208:211], v[224:227], v[172:175], a[208:211]
    s_waitcnt lgkmcnt(5)
    v_exp_f32 v131, v131
    v_mfma_f32_16x16x32_bf16 v[20:23], v[228:231], v[160:163], v[20:23]
    s_add_u32 s96, s96, 65536
    ds_read_b128 v[212:215], v244 offset:33856
    v_add_f32 v240, v240, v131
    v_mfma_f32_16x16x32_bf16 v[84:87], v[228:231], v[164:167], v[84:87]
    v_exp_f32 v132, v132
    v_mfma_f32_16x16x32_bf16 a[148:151], v[228:231], v[168:171], a[148:151]
    v_cvt_pk_bf16_f32 v177, v130, v131
    v_mfma_f32_16x16x32_bf16 a[212:215], v[228:231], v[172:175], a[212:215]
    s_waitcnt lgkmcnt(4)
    v_exp_f32 v133, v133
    v_mfma_f32_16x16x32_bf16 v[24:27], v[232:235], v[160:163], v[24:27]
    ds_read_b128 v[216:219], v244 offset:33920
    v_add_f32 v241, v241, v132
    v_mfma_f32_16x16x32_bf16 v[88:91], v[232:235], v[164:167], v[88:91]
    v_add_f32 v241, v241, v133
    v_mfma_f32_16x16x32_bf16 a[152:155], v[232:235], v[168:171], a[152:155]
    v_exp_f32 v134, v134
    v_mfma_f32_16x16x32_bf16 a[216:219], v[232:235], v[172:175], a[216:219]
    s_waitcnt lgkmcnt(3)
    v_exp_f32 v135, v135
    v_mfma_f32_16x16x32_bf16 v[28:31], v[236:239], v[160:163], v[28:31]
    ds_read_b128 v[220:223], v244 offset:33984
    v_cvt_pk_bf16_f32 v180, v132, v133
    v_mfma_f32_16x16x32_bf16 v[92:95], v[236:239], v[164:167], v[92:95]
    v_add_f32 v241, v241, v134
    v_mfma_f32_16x16x32_bf16 a[156:159], v[236:239], v[168:171], a[156:159]
    v_exp_f32 v136, v136
    v_mfma_f32_16x16x32_bf16 a[220:223], v[236:239], v[172:175], a[220:223]
    s_waitcnt lgkmcnt(3)
    v_add_f32 v241, v241, v135
    v_mfma_f32_16x16x32_bf16 v[144:147], v[208:211], a[0:3], v[192:195]
    ds_read_b128 v[224:227], v244 offset:34048
    v_cvt_pk_bf16_f32 v181, v134, v135
    v_mfma_f32_16x16x32_bf16 v[148:151], v[208:211], a[32:35], v[196:199]
    s_add_u32 m0, s25, 118272
    v_exp_f32 v137, v137
    v_mfma_f32_16x16x32_bf16 v[152:155], v[208:211], a[64:67], v[200:203]
    buffer_load_dwordx4 v247, s[8:11], s28 offen offset:0  lds
    v_mfma_f32_16x16x32_bf16 v[156:159], v[208:211], a[96:99], v[204:207]
    s_waitcnt lgkmcnt(3)
    v_exp_f32 v138, v138
    v_mfma_f32_16x16x32_bf16 v[144:147], v[212:215], a[4:7], v[144:147]
    ds_read_b128 v[228:231], v244 offset:34112
    v_add_f32 v242, v242, v136
    v_mfma_f32_16x16x32_bf16 v[148:151], v[212:215], a[36:39], v[148:151]
    s_add_u32 m0, s25, 118816
    v_add_f32 v242, v242, v137
    v_mfma_f32_16x16x32_bf16 v[152:155], v[212:215], a[68:71], v[152:155]
    buffer_load_dwordx4 v247, s[8:11], s28 offen offset:512  lds
    v_mfma_f32_16x16x32_bf16 v[156:159], v[212:215], a[100:103], v[156:159]
    s_waitcnt lgkmcnt(3)
    v_exp_f32 v139, v139
    v_mfma_f32_16x16x32_bf16 v[144:147], v[216:219], a[8:11], v[144:147]
    ds_read_b128 v[232:235], v244 offset:34176
    v_cvt_pk_bf16_f32 v184, v136, v137
    v_mfma_f32_16x16x32_bf16 v[148:151], v[216:219], a[40:43], v[148:151]
    s_add_u32 m0, s25, 119360
    v_add_f32 v242, v242, v138
    v_mfma_f32_16x16x32_bf16 v[152:155], v[216:219], a[72:75], v[152:155]
    buffer_load_dwordx4 v247, s[8:11], s28 offen offset:1024  lds
    v_mfma_f32_16x16x32_bf16 v[156:159], v[216:219], a[104:107], v[156:159]
    s_waitcnt lgkmcnt(3)
    v_exp_f32 v140, v140
    v_mfma_f32_16x16x32_bf16 v[144:147], v[220:223], a[12:15], v[144:147]
    ds_read_b128 v[236:239], v244 offset:34240
    v_add_f32 v242, v242, v139
    v_mfma_f32_16x16x32_bf16 v[148:151], v[220:223], a[44:47], v[148:151]
    s_add_u32 m0, s25, 119904
    v_exp_f32 v141, v141
    v_mfma_f32_16x16x32_bf16 v[152:155], v[220:223], a[76:79], v[152:155]
    buffer_load_dwordx4 v247, s[8:11], s28 offen offset:1536  lds
    v_mfma_f32_16x16x32_bf16 v[156:159], v[220:223], a[108:111], v[156:159]
    s_waitcnt lgkmcnt(3)
    v_cvt_pk_bf16_f32 v185, v138, v139
    v_mfma_f32_16x16x32_bf16 v[144:147], v[224:227], a[16:19], v[144:147]
    s_add_u32 s28, s28, 32512
    ds_read_b64_tr_b16 v[208:209], v245 offset:16896
    v_add_f32 v243, v243, v140
    v_mfma_f32_16x16x32_bf16 v[148:151], v[224:227], a[48:51], v[148:151]
    ds_read_b64_tr_b16 v[210:211], v245 offset:17408
    v_add_f32 v243, v243, v141
    v_mfma_f32_16x16x32_bf16 v[152:155], v[224:227], a[80:83], v[152:155]
    v_exp_f32 v142, v142
    v_mfma_f32_16x16x32_bf16 v[156:159], v[224:227], a[112:115], v[156:159]
    s_waitcnt lgkmcnt(4)
    v_cvt_pk_bf16_f32 v188, v140, v141
    v_mfma_f32_16x16x32_bf16 v[144:147], v[228:231], a[20:23], v[144:147]
    ds_read_b64_tr_b16 v[212:213], v245 offset:16928
    v_add_f32 v243, v243, v142
    v_mfma_f32_16x16x32_bf16 v[148:151], v[228:231], a[52:55], v[148:151]
    ds_read_b64_tr_b16 v[214:215], v245 offset:17440
    v_mfma_f32_16x16x32_bf16 v[152:155], v[228:231], a[84:87], v[152:155]
    v_exp_f32 v143, v143
    v_mfma_f32_16x16x32_bf16 v[156:159], v[228:231], a[116:119], v[156:159]
    s_waitcnt lgkmcnt(5)
    v_add_f32 v243, v243, v143
    v_cvt_pk_bf16_f32 v189, v142, v143
    v_mfma_f32_16x16x32_bf16 v[144:147], v[232:235], a[24:27], v[144:147]
    ds_read_b64_tr_b16 v[216:217], v245 offset:16960
    v_mfma_f32_16x16x32_bf16 v[148:151], v[232:235], a[56:59], v[148:151]
    ds_read_b64_tr_b16 v[218:219], v245 offset:17472
    v_mfma_f32_16x16x32_bf16 v[152:155], v[232:235], a[88:91], v[152:155]
    v_mfma_f32_16x16x32_bf16 v[156:159], v[232:235], a[120:123], v[156:159]
    s_waitcnt lgkmcnt(6)
    v_mfma_f32_16x16x32_bf16 v[144:147], v[236:239], a[28:31], v[144:147]
    ds_read_b64_tr_b16 v[220:221], v245 offset:16992
    v_mfma_f32_16x16x32_bf16 v[148:151], v[236:239], a[60:63], v[148:151]
    ds_read_b64_tr_b16 v[222:223], v245 offset:17504
    v_mfma_f32_16x16x32_bf16 v[152:155], v[236:239], a[92:95], v[152:155]
    v_mfma_f32_16x16x32_bf16 v[156:159], v[236:239], a[124:127], v[156:159]
    s_waitcnt lgkmcnt(6)
    v_mfma_f32_16x16x32_bf16 v[32:35], v[208:211], v[160:163], v[32:35]
    ds_read_b64_tr_b16 v[224:225], v245 offset:17024
    v_mfma_f32_16x16x32_bf16 v[96:99], v[208:211], v[164:167], v[96:99]
    s_add_u32 m0, s25, 50688
    ds_read_b64_tr_b16 v[226:227], v245 offset:17536
    buffer_load_dword v251, v250, s[92:95], s97 offen
    v_mfma_f32_16x16x32_bf16 a[160:163], v[208:211], v[168:171], a[160:163]
    buffer_load_dwordx4 v246, s[4:7], s27 offen offset:0  lds
    v_mfma_f32_16x16x32_bf16 a[224:227], v[208:211], v[172:175], a[224:227]
    s_waitcnt lgkmcnt(6)
    v_exp_f32 v144, v144
    v_mfma_f32_16x16x32_bf16 v[36:39], v[212:215], v[160:163], v[36:39]
    ds_read_b64_tr_b16 v[228:229], v245 offset:17056
    v_add_f32 v240, v240, v144
    v_mfma_f32_16x16x32_bf16 v[100:103], v[212:215], v[164:167], v[100:103]
    s_add_u32 m0, s25, 51232
    ds_read_b64_tr_b16 v[230:231], v245 offset:17568
    v_mfma_f32_16x16x32_bf16 a[164:167], v[212:215], v[168:171], a[164:167]
    buffer_load_dwordx4 v246, s[4:7], s27 offen offset:512  lds
    v_mfma_f32_16x16x32_bf16 a[228:231], v[212:215], v[172:175], a[228:231]
    s_waitcnt lgkmcnt(6)
    v_exp_f32 v145, v145
    v_mfma_f32_16x16x32_bf16 v[40:43], v[216:219], v[160:163], v[40:43]
    ds_read_b64_tr_b16 v[232:233], v245 offset:17088
    v_add_f32 v240, v240, v145
    v_mfma_f32_16x16x32_bf16 v[104:107], v[216:219], v[164:167], v[104:107]
    s_add_u32 m0, s25, 51776
    ds_read_b64_tr_b16 v[234:235], v245 offset:17600
    v_cvt_pk_bf16_f32 v178, v144, v145
    v_mfma_f32_16x16x32_bf16 a[168:171], v[216:219], v[168:171], a[168:171]
    buffer_load_dwordx4 v246, s[4:7], s27 offen offset:1024  lds
    v_mfma_f32_16x16x32_bf16 a[232:235], v[216:219], v[172:175], a[232:235]
    s_waitcnt lgkmcnt(6)
    v_mfma_f32_16x16x32_bf16 v[44:47], v[220:223], v[160:163], v[44:47]
    ds_read_b64_tr_b16 v[236:237], v245 offset:17120
    v_mfma_f32_16x16x32_bf16 v[108:111], v[220:223], v[164:167], v[108:111]
    s_add_u32 m0, s25, 52320
    ds_read_b64_tr_b16 v[238:239], v245 offset:17632
    v_mfma_f32_16x16x32_bf16 a[172:175], v[220:223], v[168:171], a[172:175]
    buffer_load_dwordx4 v246, s[4:7], s27 offen offset:1536  lds
    v_mfma_f32_16x16x32_bf16 a[236:239], v[220:223], v[172:175], a[236:239]
    s_waitcnt vmcnt(14) lgkmcnt(6)
    s_barrier
    v_mfma_f32_16x16x32_bf16 v[48:51], v[224:227], v[160:163], v[48:51]
    s_add_u32 s27, s27, 8192
    ds_read_b128 v[208:211], v244 offset:0
    v_mfma_f32_16x16x32_bf16 v[112:115], v[224:227], v[164:167], v[112:115]
    v_exp_f32 v146, v146
    v_mfma_f32_16x16x32_bf16 a[176:179], v[224:227], v[168:171], a[176:179]
    v_exp_f32 v147, v147
    v_mfma_f32_16x16x32_bf16 a[240:243], v[224:227], v[172:175], a[240:243]
    s_waitcnt lgkmcnt(5)
    v_add_f32 v240, v240, v146
    v_mfma_f32_16x16x32_bf16 v[52:55], v[228:231], v[160:163], v[52:55]
    s_add_u32 s97, s97, 1024
    ds_read_b128 v[212:215], v244 offset:64
    v_add_f32 v240, v240, v147
    v_mfma_f32_16x16x32_bf16 v[116:119], v[228:231], v[164:167], v[116:119]
    v_exp_f32 v148, v148
    v_mfma_f32_16x16x32_bf16 a[180:183], v[228:231], v[168:171], a[180:183]
    v_cvt_pk_bf16_f32 v179, v146, v147
    v_mfma_f32_16x16x32_bf16 a[244:247], v[228:231], v[172:175], a[244:247]
    s_waitcnt lgkmcnt(4)
    v_exp_f32 v149, v149
    v_mfma_f32_16x16x32_bf16 v[56:59], v[232:235], v[160:163], v[56:59]
    ds_read_b128 v[216:219], v244 offset:128
    v_add_f32 v241, v241, v148
    v_mfma_f32_16x16x32_bf16 v[120:123], v[232:235], v[164:167], v[120:123]
    v_exp_f32 v150, v150
    v_mfma_f32_16x16x32_bf16 a[184:187], v[232:235], v[168:171], a[184:187]
    v_add_f32 v241, v241, v149
    v_mfma_f32_16x16x32_bf16 a[248:251], v[232:235], v[172:175], a[248:251]
    s_waitcnt lgkmcnt(3)
    v_exp_f32 v151, v151
    v_mfma_f32_16x16x32_bf16 v[60:63], v[236:239], v[160:163], v[60:63]
    ds_read_b128 v[220:223], v244 offset:192
    v_cvt_pk_bf16_f32 v182, v148, v149
    v_mfma_f32_16x16x32_bf16 v[124:127], v[236:239], v[164:167], v[124:127]
    v_add_f32 v241, v241, v150
    v_mfma_f32_16x16x32_bf16 a[188:191], v[236:239], v[168:171], a[188:191]
    s_sub_u32 s29, s29, 1
    v_exp_f32 v152, v152
    v_mfma_f32_16x16x32_bf16 a[252:255], v[236:239], v[172:175], a[252:255]
    s_waitcnt lgkmcnt(3)
    s_cmp_lg_u32 s29, 0
    s_cbranch_scc1 k1_loop
    v_mfma_f32_16x16x32_bf16 v[128:131], v[208:211], a[0:3], v[192:195]
    ds_read_b128 v[224:227], v244 offset:256
    v_add_f32 v241, v241, v151
    v_mfma_f32_16x16x32_bf16 v[132:135], v[208:211], a[32:35], v[196:199]
    s_add_u32 m0, s25, 67584
    v_exp_f32 v153, v153
    v_mfma_f32_16x16x32_bf16 v[136:139], v[208:211], a[64:67], v[200:203]
    buffer_load_dwordx4 v247, s[8:11], s28 offen offset:0  lds
    v_mfma_f32_16x16x32_bf16 v[140:143], v[208:211], a[96:99], v[204:207]
    s_waitcnt lgkmcnt(3)
    v_cvt_pk_bf16_f32 v183, v150, v151
    v_mfma_f32_16x16x32_bf16 v[128:131], v[212:215], a[4:7], v[128:131]
    s_lshl_b32 s46, s24, 13
    ds_read_b128 v[228:231], v244 offset:320
    v_add_f32 v242, v242, v152
    v_mfma_f32_16x16x32_bf16 v[132:135], v[212:215], a[36:39], v[132:135]
    s_add_u32 m0, s25, 68128
    v_exp_f32 v154, v154
    v_mfma_f32_16x16x32_bf16 v[136:139], v[212:215], a[68:71], v[136:139]
    buffer_load_dwordx4 v247, s[8:11], s28 offen offset:512  lds
    v_mfma_f32_16x16x32_bf16 v[140:143], v[212:215], a[100:103], v[140:143]
    s_waitcnt lgkmcnt(3)
    v_exp_f32 v155, v155
    v_mfma_f32_16x16x32_bf16 v[128:131], v[216:219], a[8:11], v[128:131]
    s_add_u32 s46, s46, k1_s30-k1_pc
    ds_read_b128 v[232:235], v244 offset:384
    v_add_f32 v242, v242, v153
    v_mfma_f32_16x16x32_bf16 v[132:135], v[216:219], a[40:43], v[132:135]
    s_add_u32 m0, s25, 68672
    v_cvt_pk_bf16_f32 v186, v152, v153
    v_mfma_f32_16x16x32_bf16 v[136:139], v[216:219], a[72:75], v[136:139]
    buffer_load_dwordx4 v247, s[8:11], s28 offen offset:1024  lds
    v_mfma_f32_16x16x32_bf16 v[140:143], v[216:219], a[104:107], v[140:143]
    s_waitcnt lgkmcnt(3)
    v_exp_f32 v156, v156
    v_mfma_f32_16x16x32_bf16 v[128:131], v[220:223], a[12:15], v[128:131]
    ds_read_b128 v[236:239], v244 offset:448
    v_add_f32 v242, v242, v154
    v_mfma_f32_16x16x32_bf16 v[132:135], v[220:223], a[44:47], v[132:135]
    s_add_u32 m0, s25, 69216
    v_add_f32 v242, v242, v155
    v_mfma_f32_16x16x32_bf16 v[136:139], v[220:223], a[76:79], v[136:139]
    buffer_load_dwordx4 v247, s[8:11], s28 offen offset:1536  lds
    v_mfma_f32_16x16x32_bf16 v[140:143], v[220:223], a[108:111], v[140:143]
    s_waitcnt lgkmcnt(3)
    v_exp_f32 v157, v157
    v_mfma_f32_16x16x32_bf16 v[128:131], v[224:227], a[16:19], v[128:131]
    s_add_u32 s28, s28, 256
    ds_read_b64_tr_b16 v[208:209], v245 offset:33792
    v_cvt_pk_bf16_f32 v187, v154, v155
    v_mfma_f32_16x16x32_bf16 v[132:135], v[224:227], a[48:51], v[132:135]
    ds_read_b64_tr_b16 v[210:211], v245 offset:34304
    v_add_f32 v243, v243, v156
    v_mfma_f32_16x16x32_bf16 v[136:139], v[224:227], a[80:83], v[136:139]
    v_exp_f32 v158, v158
    v_mfma_f32_16x16x32_bf16 v[140:143], v[224:227], a[112:115], v[140:143]
    s_waitcnt lgkmcnt(4)
    v_add_f32 v243, v243, v157
    v_mfma_f32_16x16x32_bf16 v[128:131], v[228:231], a[20:23], v[128:131]
    ds_read_b64_tr_b16 v[212:213], v245 offset:33824
    v_cvt_pk_bf16_f32 v190, v156, v157
    v_mfma_f32_16x16x32_bf16 v[132:135], v[228:231], a[52:55], v[132:135]
    ds_read_b64_tr_b16 v[214:215], v245 offset:34336
    v_add_f32 v243, v243, v158
    v_mfma_f32_16x16x32_bf16 v[136:139], v[228:231], a[84:87], v[136:139]
    v_exp_f32 v159, v159
    v_mfma_f32_16x16x32_bf16 v[140:143], v[228:231], a[116:119], v[140:143]
    s_waitcnt lgkmcnt(5)
    v_add_f32 v243, v243, v159
    v_cvt_pk_bf16_f32 v191, v158, v159
    v_mfma_f32_16x16x32_bf16 v[128:131], v[232:235], a[24:27], v[128:131]
    ds_read_b64_tr_b16 v[216:217], v245 offset:33856
    v_mfma_f32_16x16x32_bf16 v[132:135], v[232:235], a[56:59], v[132:135]
    ds_read_b64_tr_b16 v[218:219], v245 offset:34368
    v_mfma_f32_16x16x32_bf16 v[136:139], v[232:235], a[88:91], v[136:139]
    v_mfma_f32_16x16x32_bf16 v[140:143], v[232:235], a[120:123], v[140:143]
    s_waitcnt lgkmcnt(6)
    v_lshlrev_b32 v250, 7, v248
    v_mfma_f32_16x16x32_bf16 v[128:131], v[236:239], a[28:31], v[128:131]
    ds_read_b64_tr_b16 v[220:221], v245 offset:33888
    v_mfma_f32_16x16x32_bf16 v[132:135], v[236:239], a[60:63], v[132:135]
    ds_read_b64_tr_b16 v[222:223], v245 offset:34400
    v_mfma_f32_16x16x32_bf16 v[136:139], v[236:239], a[92:95], v[136:139]
    v_mfma_f32_16x16x32_bf16 v[140:143], v[236:239], a[124:127], v[140:143]
    s_waitcnt lgkmcnt(6)
    v_mfma_f32_16x16x32_bf16 v[0:3], v[208:211], v[176:179], v[0:3]
    ds_read_b64_tr_b16 v[224:225], v245 offset:33920
    v_mfma_f32_16x16x32_bf16 v[64:67], v[208:211], v[180:183], v[64:67]
    s_add_u32 m0, s25, 33792
    ds_read_b64_tr_b16 v[226:227], v245 offset:34432
    buffer_load_dword v251, v250, s[88:91], s46 offen
    v_mfma_f32_16x16x32_bf16 a[128:131], v[208:211], v[184:187], a[128:131]
    buffer_load_dwordx4 v246, s[4:7], s27 offen offset:0  lds
    v_mfma_f32_16x16x32_bf16 a[192:195], v[208:211], v[188:191], a[192:195]
    s_waitcnt lgkmcnt(6)
    v_exp_f32 v128, v128
    v_mfma_f32_16x16x32_bf16 v[4:7], v[212:215], v[176:179], v[4:7]
    ds_read_b64_tr_b16 v[228:229], v245 offset:33952
    v_add_f32 v240, v240, v128
    v_mfma_f32_16x16x32_bf16 v[68:71], v[212:215], v[180:183], v[68:71]
    s_add_u32 m0, s25, 34336
    ds_read_b64_tr_b16 v[230:231], v245 offset:34464
    v_mfma_f32_16x16x32_bf16 a[132:135], v[212:215], v[184:187], a[132:135]
    buffer_load_dwordx4 v246, s[4:7], s27 offen offset:512  lds
    v_mfma_f32_16x16x32_bf16 a[196:199], v[212:215], v[188:191], a[196:199]
    s_waitcnt lgkmcnt(6)
    v_exp_f32 v129, v129
    v_mfma_f32_16x16x32_bf16 v[8:11], v[216:219], v[176:179], v[8:11]
    ds_read_b64_tr_b16 v[232:233], v245 offset:33984
    v_add_f32 v240, v240, v129
    v_mfma_f32_16x16x32_bf16 v[72:75], v[216:219], v[180:183], v[72:75]
    s_add_u32 m0, s25, 34880
    ds_read_b64_tr_b16 v[234:235], v245 offset:34496
    v_cvt_pk_bf16_f32 v160, v128, v129
    v_mfma_f32_16x16x32_bf16 a[136:139], v[216:219], v[184:187], a[136:139]
    buffer_load_dwordx4 v246, s[4:7], s27 offen offset:1024  lds
    v_mfma_f32_16x16x32_bf16 a[200:203], v[216:219], v[188:191], a[200:203]
    s_waitcnt lgkmcnt(6)
    v_mfma_f32_16x16x32_bf16 v[12:15], v[220:223], v[176:179], v[12:15]
    ds_read_b64_tr_b16 v[236:237], v245 offset:34016
    v_mfma_f32_16x16x32_bf16 v[76:79], v[220:223], v[180:183], v[76:79]
    s_add_u32 m0, s25, 35424
    ds_read_b64_tr_b16 v[238:239], v245 offset:34528
    v_mfma_f32_16x16x32_bf16 a[140:143], v[220:223], v[184:187], a[140:143]
    buffer_load_dwordx4 v246, s[4:7], s27 offen offset:1536  lds
    v_mfma_f32_16x16x32_bf16 a[204:207], v[220:223], v[188:191], a[204:207]
    s_waitcnt vmcnt(14) lgkmcnt(6)
    s_barrier
    v_mfma_f32_16x16x32_bf16 v[16:19], v[224:227], v[176:179], v[16:19]
    s_add_u32 s27, s27, 24576
    ds_read_b128 v[208:211], v244 offset:16896
    v_mfma_f32_16x16x32_bf16 v[80:83], v[224:227], v[180:183], v[80:83]
    v_exp_f32 v130, v130
    v_mfma_f32_16x16x32_bf16 a[144:147], v[224:227], v[184:187], a[144:147]
    v_add_f32 v240, v240, v130
    v_mfma_f32_16x16x32_bf16 a[208:211], v[224:227], v[188:191], a[208:211]
    s_waitcnt lgkmcnt(5)
    v_exp_f32 v131, v131
    v_mfma_f32_16x16x32_bf16 v[20:23], v[228:231], v[176:179], v[20:23]
    ds_read_b128 v[212:215], v244 offset:16960
    v_add_f32 v240, v240, v131
    v_mfma_f32_16x16x32_bf16 v[84:87], v[228:231], v[180:183], v[84:87]
    v_exp_f32 v132, v132
    v_mfma_f32_16x16x32_bf16 a[148:151], v[228:231], v[184:187], a[148:151]
    v_cvt_pk_bf16_f32 v161, v130, v131
    v_mfma_f32_16x16x32_bf16 a[212:215], v[228:231], v[188:191], a[212:215]
    s_waitcnt lgkmcnt(4)
    v_exp_f32 v133, v133
    v_mfma_f32_16x16x32_bf16 v[24:27], v[232:235], v[176:179], v[24:27]
    ds_read_b128 v[216:219], v244 offset:17024
    v_add_f32 v241, v241, v132
    v_mfma_f32_16x16x32_bf16 v[88:91], v[232:235], v[180:183], v[88:91]
    v_add_f32 v241, v241, v133
    v_mfma_f32_16x16x32_bf16 a[152:155], v[232:235], v[184:187], a[152:155]
    v_exp_f32 v134, v134
    v_mfma_f32_16x16x32_bf16 a[216:219], v[232:235], v[188:191], a[216:219]
    s_waitcnt lgkmcnt(3)
    v_exp_f32 v135, v135
    v_mfma_f32_16x16x32_bf16 v[28:31], v[236:239], v[176:179], v[28:31]
    ds_read_b128 v[220:223], v244 offset:17088
    v_cvt_pk_bf16_f32 v164, v132, v133
    v_mfma_f32_16x16x32_bf16 v[92:95], v[236:239], v[180:183], v[92:95]
    v_add_f32 v241, v241, v134
    v_mfma_f32_16x16x32_bf16 a[156:159], v[236:239], v[184:187], a[156:159]
    v_exp_f32 v136, v136
    v_mfma_f32_16x16x32_bf16 a[220:223], v[236:239], v[188:191], a[220:223]
    s_waitcnt lgkmcnt(3)
    v_add_f32 v241, v241, v135
    v_mfma_f32_16x16x32_bf16 v[144:147], v[208:211], a[0:3], v[192:195]
    ds_read_b128 v[224:227], v244 offset:17152
    v_cvt_pk_bf16_f32 v165, v134, v135
    v_mfma_f32_16x16x32_bf16 v[148:151], v[208:211], a[32:35], v[196:199]
    s_add_u32 m0, s25, 84480
    v_exp_f32 v137, v137
    v_mfma_f32_16x16x32_bf16 v[152:155], v[208:211], a[64:67], v[200:203]
    buffer_load_dwordx4 v247, s[8:11], s28 offen offset:0  lds
    v_mfma_f32_16x16x32_bf16 v[156:159], v[208:211], a[96:99], v[204:207]
    s_waitcnt lgkmcnt(3)
    v_exp_f32 v138, v138
    v_mfma_f32_16x16x32_bf16 v[144:147], v[212:215], a[4:7], v[144:147]
    ds_read_b128 v[228:231], v244 offset:17216
    v_add_f32 v242, v242, v136
    v_mfma_f32_16x16x32_bf16 v[148:151], v[212:215], a[36:39], v[148:151]
    s_add_u32 m0, s25, 85024
    v_add_f32 v242, v242, v137
    v_mfma_f32_16x16x32_bf16 v[152:155], v[212:215], a[68:71], v[152:155]
    buffer_load_dwordx4 v247, s[8:11], s28 offen offset:512  lds
    v_mfma_f32_16x16x32_bf16 v[156:159], v[212:215], a[100:103], v[156:159]
    s_waitcnt lgkmcnt(3)
    v_exp_f32 v139, v139
    v_mfma_f32_16x16x32_bf16 v[144:147], v[216:219], a[8:11], v[144:147]
    ds_read_b128 v[232:235], v244 offset:17280
    v_cvt_pk_bf16_f32 v168, v136, v137
    v_mfma_f32_16x16x32_bf16 v[148:151], v[216:219], a[40:43], v[148:151]
    s_add_u32 m0, s25, 85568
    v_add_f32 v242, v242, v138
    v_mfma_f32_16x16x32_bf16 v[152:155], v[216:219], a[72:75], v[152:155]
    buffer_load_dwordx4 v247, s[8:11], s28 offen offset:1024  lds
    v_mfma_f32_16x16x32_bf16 v[156:159], v[216:219], a[104:107], v[156:159]
    s_waitcnt lgkmcnt(3)
    v_exp_f32 v140, v140
    v_mfma_f32_16x16x32_bf16 v[144:147], v[220:223], a[12:15], v[144:147]
    ds_read_b128 v[236:239], v244 offset:17344
    v_add_f32 v242, v242, v139
    v_mfma_f32_16x16x32_bf16 v[148:151], v[220:223], a[44:47], v[148:151]
    s_add_u32 m0, s25, 86112
    v_exp_f32 v141, v141
    v_mfma_f32_16x16x32_bf16 v[152:155], v[220:223], a[76:79], v[152:155]
    buffer_load_dwordx4 v247, s[8:11], s28 offen offset:1536  lds
    v_mfma_f32_16x16x32_bf16 v[156:159], v[220:223], a[108:111], v[156:159]
    s_waitcnt lgkmcnt(3)
    v_cvt_pk_bf16_f32 v169, v138, v139
    v_mfma_f32_16x16x32_bf16 v[144:147], v[224:227], a[16:19], v[144:147]
    s_add_u32 s28, s28, 32512
    ds_read_b64_tr_b16 v[208:209], v245 offset:50688
    v_add_f32 v243, v243, v140
    v_mfma_f32_16x16x32_bf16 v[148:151], v[224:227], a[48:51], v[148:151]
    ds_read_b64_tr_b16 v[210:211], v245 offset:51200
    v_add_f32 v243, v243, v141
    v_mfma_f32_16x16x32_bf16 v[152:155], v[224:227], a[80:83], v[152:155]
    v_exp_f32 v142, v142
    v_mfma_f32_16x16x32_bf16 v[156:159], v[224:227], a[112:115], v[156:159]
    s_waitcnt lgkmcnt(4)
    v_cvt_pk_bf16_f32 v172, v140, v141
    v_mfma_f32_16x16x32_bf16 v[144:147], v[228:231], a[20:23], v[144:147]
    ds_read_b64_tr_b16 v[212:213], v245 offset:50720
    v_add_f32 v243, v243, v142
    v_mfma_f32_16x16x32_bf16 v[148:151], v[228:231], a[52:55], v[148:151]
    ds_read_b64_tr_b16 v[214:215], v245 offset:51232
    v_mfma_f32_16x16x32_bf16 v[152:155], v[228:231], a[84:87], v[152:155]
    v_exp_f32 v143, v143
    v_mfma_f32_16x16x32_bf16 v[156:159], v[228:231], a[116:119], v[156:159]
    s_waitcnt lgkmcnt(5)
    v_add_f32 v243, v243, v143
    v_cvt_pk_bf16_f32 v173, v142, v143
    v_mfma_f32_16x16x32_bf16 v[144:147], v[232:235], a[24:27], v[144:147]
    ds_read_b64_tr_b16 v[216:217], v245 offset:50752
    v_mfma_f32_16x16x32_bf16 v[148:151], v[232:235], a[56:59], v[148:151]
    ds_read_b64_tr_b16 v[218:219], v245 offset:51264
    v_mfma_f32_16x16x32_bf16 v[152:155], v[232:235], a[88:91], v[152:155]
    v_mfma_f32_16x16x32_bf16 v[156:159], v[232:235], a[120:123], v[156:159]
    s_waitcnt lgkmcnt(6)
    v_mfma_f32_16x16x32_bf16 v[144:147], v[236:239], a[28:31], v[144:147]
    ds_read_b64_tr_b16 v[220:221], v245 offset:50784
    v_mfma_f32_16x16x32_bf16 v[148:151], v[236:239], a[60:63], v[148:151]
    ds_read_b64_tr_b16 v[222:223], v245 offset:51296
    v_mfma_f32_16x16x32_bf16 v[152:155], v[236:239], a[92:95], v[152:155]
    v_mfma_f32_16x16x32_bf16 v[156:159], v[236:239], a[124:127], v[156:159]
    s_waitcnt lgkmcnt(6)
    v_mfma_f32_16x16x32_bf16 v[32:35], v[208:211], v[176:179], v[32:35]
    s_mov_b32 s32, 0
    ds_read_b64_tr_b16 v[224:225], v245 offset:50816
    v_mfma_f32_16x16x32_bf16 v[96:99], v[208:211], v[180:183], v[96:99]
    s_add_u32 m0, s25, 135168
    ds_read_b64_tr_b16 v[226:227], v245 offset:51328
    v_mfma_f32_16x16x32_bf16 a[160:163], v[208:211], v[184:187], a[160:163]
    buffer_load_dwordx4 v255, s[16:19], s32 offen offset:0  lds
    v_mfma_f32_16x16x32_bf16 a[224:227], v[208:211], v[188:191], a[224:227]
    s_waitcnt lgkmcnt(6)
    v_exp_f32 v144, v144
    v_mfma_f32_16x16x32_bf16 v[36:39], v[212:215], v[176:179], v[36:39]
    ds_read_b64_tr_b16 v[228:229], v245 offset:50848
    v_add_f32 v240, v240, v144
    v_mfma_f32_16x16x32_bf16 v[100:103], v[212:215], v[180:183], v[100:103]
    s_add_u32 m0, s25, 135328
    ds_read_b64_tr_b16 v[230:231], v245 offset:51360
    v_mfma_f32_16x16x32_bf16 a[164:167], v[212:215], v[184:187], a[164:167]
    buffer_load_dwordx4 v255, s[16:19], s32 offen offset:896  lds
    v_mfma_f32_16x16x32_bf16 a[228:231], v[212:215], v[188:191], a[228:231]
    s_waitcnt lgkmcnt(6)
    v_exp_f32 v145, v145
    v_mfma_f32_16x16x32_bf16 v[40:43], v[216:219], v[176:179], v[40:43]
    ds_read_b64_tr_b16 v[232:233], v245 offset:50880
    v_add_f32 v240, v240, v145
    v_mfma_f32_16x16x32_bf16 v[104:107], v[216:219], v[180:183], v[104:107]
    s_add_u32 m0, s25, 135488
    ds_read_b64_tr_b16 v[234:235], v245 offset:51392
    v_cvt_pk_bf16_f32 v162, v144, v145
    v_mfma_f32_16x16x32_bf16 a[168:171], v[216:219], v[184:187], a[168:171]
    buffer_load_dwordx4 v255, s[16:19], s32 offen offset:1792  lds
    v_mfma_f32_16x16x32_bf16 a[232:235], v[216:219], v[188:191], a[232:235]
    s_waitcnt lgkmcnt(6)
    v_mfma_f32_16x16x32_bf16 v[44:47], v[220:223], v[176:179], v[44:47]
    ds_read_b64_tr_b16 v[236:237], v245 offset:50912
    v_mfma_f32_16x16x32_bf16 v[108:111], v[220:223], v[180:183], v[108:111]
    s_add_u32 m0, s25, 135648
    ds_read_b64_tr_b16 v[238:239], v245 offset:51424
    v_mfma_f32_16x16x32_bf16 a[172:175], v[220:223], v[184:187], a[172:175]
    buffer_load_dwordx4 v255, s[16:19], s32 offen offset:2688  lds
    v_mfma_f32_16x16x32_bf16 a[236:239], v[220:223], v[188:191], a[236:239]
    s_waitcnt vmcnt(13) lgkmcnt(6)
    s_barrier
    v_mfma_f32_16x16x32_bf16 v[48:51], v[224:227], v[176:179], v[48:51]
    ds_read_b128 v[208:211], v244 offset:50688
    v_mfma_f32_16x16x32_bf16 v[112:115], v[224:227], v[180:183], v[112:115]
    v_exp_f32 v146, v146
    v_mfma_f32_16x16x32_bf16 a[176:179], v[224:227], v[184:187], a[176:179]
    v_exp_f32 v147, v147
    v_mfma_f32_16x16x32_bf16 a[240:243], v[224:227], v[188:191], a[240:243]
    s_waitcnt lgkmcnt(5)
    v_add_f32 v240, v240, v146
    v_mfma_f32_16x16x32_bf16 v[52:55], v[228:231], v[176:179], v[52:55]
    ds_read_b128 v[212:215], v244 offset:50752
    v_add_f32 v240, v240, v147
    v_mfma_f32_16x16x32_bf16 v[116:119], v[228:231], v[180:183], v[116:119]
    v_exp_f32 v148, v148
    v_mfma_f32_16x16x32_bf16 a[180:183], v[228:231], v[184:187], a[180:183]
    v_cvt_pk_bf16_f32 v163, v146, v147
    v_mfma_f32_16x16x32_bf16 a[244:247], v[228:231], v[188:191], a[244:247]
    s_waitcnt lgkmcnt(4)
    v_exp_f32 v149, v149
    v_mfma_f32_16x16x32_bf16 v[56:59], v[232:235], v[176:179], v[56:59]
    ds_read_b128 v[216:219], v244 offset:50816
    v_add_f32 v241, v241, v148
    v_mfma_f32_16x16x32_bf16 v[120:123], v[232:235], v[180:183], v[120:123]
    v_exp_f32 v150, v150
    v_mfma_f32_16x16x32_bf16 a[184:187], v[232:235], v[184:187], a[184:187]
    v_add_f32 v241, v241, v149
    v_mfma_f32_16x16x32_bf16 a[248:251], v[232:235], v[188:191], a[248:251]
    s_waitcnt lgkmcnt(3)
    v_exp_f32 v151, v151
    v_mfma_f32_16x16x32_bf16 v[60:63], v[236:239], v[176:179], v[60:63]
    ds_read_b128 v[220:223], v244 offset:50880
    v_cvt_pk_bf16_f32 v166, v148, v149
    v_mfma_f32_16x16x32_bf16 v[124:127], v[236:239], v[180:183], v[124:127]
    v_add_f32 v241, v241, v150
    v_mfma_f32_16x16x32_bf16 a[188:191], v[236:239], v[184:187], a[188:191]
    v_exp_f32 v152, v152
    v_mfma_f32_16x16x32_bf16 a[252:255], v[236:239], v[188:191], a[252:255]
    s_waitcnt lgkmcnt(3)
k1_s30:
    v_mfma_f32_16x16x32_bf16 v[128:131], v[208:211], a[0:3], v[192:195]
    ds_read_b128 v[224:227], v244 offset:50944
    v_add_f32 v241, v241, v151
    v_mfma_f32_16x16x32_bf16 v[132:135], v[208:211], a[32:35], v[196:199]
    s_add_u32 m0, s25, 101376
    v_exp_f32 v153, v153
    v_mfma_f32_16x16x32_bf16 v[136:139], v[208:211], a[64:67], v[200:203]
    buffer_load_dwordx4 v247, s[8:11], s28 offen offset:0  lds
    v_mfma_f32_16x16x32_bf16 v[140:143], v[208:211], a[96:99], v[204:207]
    s_waitcnt lgkmcnt(3)
    v_cvt_pk_bf16_f32 v167, v150, v151
    v_mfma_f32_16x16x32_bf16 v[128:131], v[212:215], a[4:7], v[128:131]
    ds_read_b128 v[228:231], v244 offset:51008
    v_add_f32 v242, v242, v152
    v_mfma_f32_16x16x32_bf16 v[132:135], v[212:215], a[36:39], v[132:135]
    s_add_u32 m0, s25, 101920
    v_exp_f32 v154, v154
    v_mfma_f32_16x16x32_bf16 v[136:139], v[212:215], a[68:71], v[136:139]
    buffer_load_dwordx4 v247, s[8:11], s28 offen offset:512  lds
    v_mfma_f32_16x16x32_bf16 v[140:143], v[212:215], a[100:103], v[140:143]
    s_waitcnt lgkmcnt(3)
    v_exp_f32 v155, v155
    v_mfma_f32_16x16x32_bf16 v[128:131], v[216:219], a[8:11], v[128:131]
    ds_read_b128 v[232:235], v244 offset:51072
    v_add_f32 v242, v242, v153
    v_mfma_f32_16x16x32_bf16 v[132:135], v[216:219], a[40:43], v[132:135]
    s_add_u32 m0, s25, 102464
    v_cvt_pk_bf16_f32 v170, v152, v153
    v_mfma_f32_16x16x32_bf16 v[136:139], v[216:219], a[72:75], v[136:139]
    buffer_load_dwordx4 v247, s[8:11], s28 offen offset:1024  lds
    v_mfma_f32_16x16x32_bf16 v[140:143], v[216:219], a[104:107], v[140:143]
    s_waitcnt lgkmcnt(3)
    v_exp_f32 v156, v156
    v_mfma_f32_16x16x32_bf16 v[128:131], v[220:223], a[12:15], v[128:131]
    ds_read_b128 v[236:239], v244 offset:51136
    v_add_f32 v242, v242, v154
    v_mfma_f32_16x16x32_bf16 v[132:135], v[220:223], a[44:47], v[132:135]
    s_add_u32 m0, s25, 103008
    v_add_f32 v242, v242, v155
    v_mfma_f32_16x16x32_bf16 v[136:139], v[220:223], a[76:79], v[136:139]
    buffer_load_dwordx4 v247, s[8:11], s28 offen offset:1536  lds
    v_mfma_f32_16x16x32_bf16 v[140:143], v[220:223], a[108:111], v[140:143]
    s_waitcnt lgkmcnt(3)
    v_exp_f32 v157, v157
    v_mfma_f32_16x16x32_bf16 v[128:131], v[224:227], a[16:19], v[128:131]
    s_add_u32 s28, s28, 256
    ds_read_b64_tr_b16 v[208:209], v245 offset:0
    v_cvt_pk_bf16_f32 v171, v154, v155
    v_mfma_f32_16x16x32_bf16 v[132:135], v[224:227], a[48:51], v[132:135]
    ds_read_b64_tr_b16 v[210:211], v245 offset:512
    v_add_f32 v243, v243, v156
    v_mfma_f32_16x16x32_bf16 v[136:139], v[224:227], a[80:83], v[136:139]
    v_exp_f32 v158, v158
    v_mfma_f32_16x16x32_bf16 v[140:143], v[224:227], a[112:115], v[140:143]
    s_waitcnt lgkmcnt(4)
    v_add_f32 v243, v243, v157
    v_mfma_f32_16x16x32_bf16 v[128:131], v[228:231], a[20:23], v[128:131]
    ds_read_b64_tr_b16 v[212:213], v245 offset:32
    v_cvt_pk_bf16_f32 v174, v156, v157
    v_mfma_f32_16x16x32_bf16 v[132:135], v[228:231], a[52:55], v[132:135]
    ds_read_b64_tr_b16 v[214:215], v245 offset:544
    v_add_f32 v243, v243, v158
    v_mfma_f32_16x16x32_bf16 v[136:139], v[228:231], a[84:87], v[136:139]
    v_exp_f32 v159, v159
    v_mfma_f32_16x16x32_bf16 v[140:143], v[228:231], a[116:119], v[140:143]
    s_waitcnt lgkmcnt(5)
    v_add_f32 v243, v243, v159
    v_cvt_pk_bf16_f32 v175, v158, v159
    v_mfma_f32_16x16x32_bf16 v[128:131], v[232:235], a[24:27], v[128:131]
    ds_read_b64_tr_b16 v[216:217], v245 offset:64
    v_mfma_f32_16x16x32_bf16 v[132:135], v[232:235], a[56:59], v[132:135]
    ds_read_b64_tr_b16 v[218:219], v245 offset:576
    v_mfma_f32_16x16x32_bf16 v[136:139], v[232:235], a[88:91], v[136:139]
    v_mfma_f32_16x16x32_bf16 v[140:143], v[232:235], a[120:123], v[140:143]
    s_waitcnt lgkmcnt(6)
    v_mfma_f32_16x16x32_bf16 v[128:131], v[236:239], a[28:31], v[128:131]
    ds_read_b64_tr_b16 v[220:221], v245 offset:96
    v_mfma_f32_16x16x32_bf16 v[132:135], v[236:239], a[60:63], v[132:135]
    ds_read_b64_tr_b16 v[222:223], v245 offset:608
    v_mfma_f32_16x16x32_bf16 v[136:139], v[236:239], a[92:95], v[136:139]
    v_mfma_f32_16x16x32_bf16 v[140:143], v[236:239], a[124:127], v[140:143]
    s_waitcnt lgkmcnt(6)
    v_mfma_f32_16x16x32_bf16 v[0:3], v[208:211], v[160:163], v[0:3]
    ds_read_b64_tr_b16 v[224:225], v245 offset:128
    v_mfma_f32_16x16x32_bf16 v[64:67], v[208:211], v[164:167], v[64:67]
    ds_read_b64_tr_b16 v[226:227], v245 offset:640
    v_mfma_f32_16x16x32_bf16 a[128:131], v[208:211], v[168:171], a[128:131]
    v_mfma_f32_16x16x32_bf16 a[192:195], v[208:211], v[172:175], a[192:195]
    s_waitcnt lgkmcnt(6)
    v_exp_f32 v128, v128
    v_mfma_f32_16x16x32_bf16 v[4:7], v[212:215], v[160:163], v[4:7]
    s_and_b32 s46, s2, 7
    ds_read_b64_tr_b16 v[228:229], v245 offset:160
    v_add_f32 v240, v240, v128
    v_mfma_f32_16x16x32_bf16 v[68:71], v[212:215], v[164:167], v[68:71]
    ds_read_b64_tr_b16 v[230:231], v245 offset:672
    v_mfma_f32_16x16x32_bf16 a[132:135], v[212:215], v[168:171], a[132:135]
    s_lshr_b32 s47, s2, 3
    v_mfma_f32_16x16x32_bf16 a[196:199], v[212:215], v[172:175], a[196:199]
    s_waitcnt lgkmcnt(6)
    v_exp_f32 v129, v129
    v_mfma_f32_16x16x32_bf16 v[8:11], v[216:219], v[160:163], v[8:11]
    s_mul_i32 s98, s46, 448
    ds_read_b64_tr_b16 v[232:233], v245 offset:192
    v_add_f32 v240, v240, v129
    v_mfma_f32_16x16x32_bf16 v[72:75], v[216:219], v[164:167], v[72:75]
    ds_read_b64_tr_b16 v[234:235], v245 offset:704
    v_cvt_pk_bf16_f32 v176, v128, v129
    v_mfma_f32_16x16x32_bf16 a[136:139], v[216:219], v[168:171], a[136:139]
    s_and_b32 s98, s98, 0xffffff80
    v_mfma_f32_16x16x32_bf16 a[200:203], v[216:219], v[172:175], a[200:203]
    s_waitcnt lgkmcnt(6)
    v_mfma_f32_16x16x32_bf16 v[12:15], v[220:223], v[160:163], v[12:15]
    s_mul_i32 s99, s47, 50176
    ds_read_b64_tr_b16 v[236:237], v245 offset:224
    v_mfma_f32_16x16x32_bf16 v[76:79], v[220:223], v[164:167], v[76:79]
    ds_read_b64_tr_b16 v[238:239], v245 offset:736
    v_mfma_f32_16x16x32_bf16 a[140:143], v[220:223], v[168:171], a[140:143]
    s_add_u32 s98, s98, s99
    s_mov_b32 s99, 3584
    v_mfma_f32_16x16x32_bf16 a[204:207], v[220:223], v[172:175], a[204:207]
    s_waitcnt vmcnt(8) lgkmcnt(6)
    s_barrier
    v_mfma_f32_16x16x32_bf16 v[16:19], v[224:227], v[160:163], v[16:19]
    s_mul_i32 s46, s46, 200704
    ds_read_b128 v[208:211], v244 offset:33792
    v_mfma_f32_16x16x32_bf16 v[80:83], v[224:227], v[164:167], v[80:83]
    v_exp_f32 v130, v130
    v_mfma_f32_16x16x32_bf16 a[144:147], v[224:227], v[168:171], a[144:147]
    s_mul_i32 s47, s47, 6272
    v_add_f32 v240, v240, v130
    v_mfma_f32_16x16x32_bf16 a[208:211], v[224:227], v[172:175], a[208:211]
    s_waitcnt lgkmcnt(5)
    v_exp_f32 v131, v131
    v_mfma_f32_16x16x32_bf16 v[20:23], v[228:231], v[160:163], v[20:23]
    s_add_u32 s46, s46, s47
    ds_read_b128 v[212:215], v244 offset:33856
    v_add_f32 v240, v240, v131
    v_mfma_f32_16x16x32_bf16 v[84:87], v[228:231], v[164:167], v[84:87]
    v_exp_f32 v132, v132
    v_mfma_f32_16x16x32_bf16 a[148:151], v[228:231], v[168:171], a[148:151]
    s_cmp_eq_u32 s24, 3
    s_cselect_b32 s98, s46, s98
    v_cvt_pk_bf16_f32 v177, v130, v131
    v_mfma_f32_16x16x32_bf16 a[212:215], v[228:231], v[172:175], a[212:215]
    s_waitcnt lgkmcnt(4)
    v_exp_f32 v133, v133
    v_mfma_f32_16x16x32_bf16 v[24:27], v[232:235], v[160:163], v[24:27]
    s_cmp_eq_u32 s24, 3
    s_cselect_b32 s99, 512, s99
    ds_read_b128 v[216:219], v244 offset:33920
    v_add_f32 v241, v241, v132
    v_mfma_f32_16x16x32_bf16 v[88:91], v[232:235], v[164:167], v[88:91]
    v_add_f32 v241, v241, v133
    v_mfma_f32_16x16x32_bf16 a[152:155], v[232:235], v[168:171], a[152:155]
    v_exp_f32 v134, v134
    v_mfma_f32_16x16x32_bf16 a[216:219], v[232:235], v[172:175], a[216:219]
    s_waitcnt lgkmcnt(3)
    v_exp_f32 v135, v135
    v_lshrrev_b32 v249, 2, v248
    v_mfma_f32_16x16x32_bf16 v[28:31], v[236:239], v[160:163], v[28:31]
    ds_read_b128 v[220:223], v244 offset:33984
    v_cvt_pk_bf16_f32 v180, v132, v133
    v_mfma_f32_16x16x32_bf16 v[92:95], v[236:239], v[164:167], v[92:95]
    v_add_f32 v241, v241, v134
    v_mfma_f32_16x16x32_bf16 a[156:159], v[236:239], v[168:171], a[156:159]
    v_exp_f32 v136, v136
    v_mfma_f32_16x16x32_bf16 a[220:223], v[236:239], v[172:175], a[220:223]
    s_waitcnt lgkmcnt(3)
    v_add_f32 v241, v241, v135
    v_mul_lo_u32 v249, v249, s99
    v_mfma_f32_16x16x32_bf16 v[144:147], v[208:211], a[0:3], v[192:195]
    ds_read_b128 v[224:227], v244 offset:34048
    v_cvt_pk_bf16_f32 v181, v134, v135
    v_mfma_f32_16x16x32_bf16 v[148:151], v[208:211], a[32:35], v[196:199]
    s_add_u32 m0, s25, 118272
    v_exp_f32 v137, v137
    v_mfma_f32_16x16x32_bf16 v[152:155], v[208:211], a[64:67], v[200:203]
    buffer_load_dwordx4 v247, s[8:11], s28 offen offset:0  lds
    v_mfma_f32_16x16x32_bf16 v[156:159], v[208:211], a[96:99], v[204:207]
    s_waitcnt lgkmcnt(3)
    v_exp_f32 v138, v138
    v_mfma_f32_16x16x32_bf16 v[144:147], v[212:215], a[4:7], v[144:147]
    ds_read_b128 v[228:231], v244 offset:34112
    v_add_f32 v242, v242, v136
    v_mfma_f32_16x16x32_bf16 v[148:151], v[212:215], a[36:39], v[148:151]
    s_add_u32 m0, s25, 118816
    v_add_f32 v242, v242, v137
    v_mfma_f32_16x16x32_bf16 v[152:155], v[212:215], a[68:71], v[152:155]
    buffer_load_dwordx4 v247, s[8:11], s28 offen offset:512  lds
    v_mfma_f32_16x16x32_bf16 v[156:159], v[212:215], a[100:103], v[156:159]
    s_waitcnt lgkmcnt(3)
    v_exp_f32 v139, v139
    v_mfma_f32_16x16x32_bf16 v[144:147], v[216:219], a[8:11], v[144:147]
    ds_read_b128 v[232:235], v244 offset:34176
    v_cvt_pk_bf16_f32 v184, v136, v137
    v_mfma_f32_16x16x32_bf16 v[148:151], v[216:219], a[40:43], v[148:151]
    s_add_u32 m0, s25, 119360
    v_add_f32 v242, v242, v138
    v_mfma_f32_16x16x32_bf16 v[152:155], v[216:219], a[72:75], v[152:155]
    buffer_load_dwordx4 v247, s[8:11], s28 offen offset:1024  lds
    v_mfma_f32_16x16x32_bf16 v[156:159], v[216:219], a[104:107], v[156:159]
    s_waitcnt lgkmcnt(3)
    v_exp_f32 v140, v140
    v_mfma_f32_16x16x32_bf16 v[144:147], v[220:223], a[12:15], v[144:147]
    ds_read_b128 v[236:239], v244 offset:34240
    v_add_f32 v242, v242, v139
    v_mfma_f32_16x16x32_bf16 v[148:151], v[220:223], a[44:47], v[148:151]
    s_add_u32 m0, s25, 119904
    v_exp_f32 v141, v141
    v_mfma_f32_16x16x32_bf16 v[152:155], v[220:223], a[76:79], v[152:155]
    buffer_load_dwordx4 v247, s[8:11], s28 offen offset:1536  lds
    v_mfma_f32_16x16x32_bf16 v[156:159], v[220:223], a[108:111], v[156:159]
    s_waitcnt lgkmcnt(3)
    v_cvt_pk_bf16_f32 v185, v138, v139
    v_mfma_f32_16x16x32_bf16 v[144:147], v[224:227], a[16:19], v[144:147]
    s_add_u32 s28, s28, 32512
    ds_read_b64_tr_b16 v[208:209], v245 offset:16896
    v_add_f32 v243, v243, v140
    v_mfma_f32_16x16x32_bf16 v[148:151], v[224:227], a[48:51], v[148:151]
    ds_read_b64_tr_b16 v[210:211], v245 offset:17408
    v_add_f32 v243, v243, v141
    v_mfma_f32_16x16x32_bf16 v[152:155], v[224:227], a[80:83], v[152:155]
    v_exp_f32 v142, v142
    v_mfma_f32_16x16x32_bf16 v[156:159], v[224:227], a[112:115], v[156:159]
    s_waitcnt lgkmcnt(4)
    v_cvt_pk_bf16_f32 v188, v140, v141
    v_mfma_f32_16x16x32_bf16 v[144:147], v[228:231], a[20:23], v[144:147]
    ds_read_b64_tr_b16 v[212:213], v245 offset:16928
    v_add_f32 v243, v243, v142
    v_mfma_f32_16x16x32_bf16 v[148:151], v[228:231], a[52:55], v[148:151]
    ds_read_b64_tr_b16 v[214:215], v245 offset:17440
    v_mfma_f32_16x16x32_bf16 v[152:155], v[228:231], a[84:87], v[152:155]
    v_exp_f32 v143, v143
    v_mfma_f32_16x16x32_bf16 v[156:159], v[228:231], a[116:119], v[156:159]
    s_waitcnt lgkmcnt(5)
    v_add_f32 v243, v243, v143
    v_cvt_pk_bf16_f32 v189, v142, v143
    v_mfma_f32_16x16x32_bf16 v[144:147], v[232:235], a[24:27], v[144:147]
    ds_read_b64_tr_b16 v[216:217], v245 offset:16960
    v_mfma_f32_16x16x32_bf16 v[148:151], v[232:235], a[56:59], v[148:151]
    ds_read_b64_tr_b16 v[218:219], v245 offset:17472
    v_mfma_f32_16x16x32_bf16 v[152:155], v[232:235], a[88:91], v[152:155]
    v_mfma_f32_16x16x32_bf16 v[156:159], v[232:235], a[120:123], v[156:159]
    s_waitcnt lgkmcnt(6)
    v_and_b32 v250, 3, v248
    v_mfma_f32_16x16x32_bf16 v[144:147], v[236:239], a[28:31], v[144:147]
    ds_read_b64_tr_b16 v[220:221], v245 offset:16992
    v_lshl_add_u32 v249, v250, 7, v249
    v_mfma_f32_16x16x32_bf16 v[148:151], v[236:239], a[60:63], v[148:151]
    ds_read_b64_tr_b16 v[222:223], v245 offset:17504
    v_mfma_f32_16x16x32_bf16 v[152:155], v[236:239], a[92:95], v[152:155]
    v_mfma_f32_16x16x32_bf16 v[156:159], v[236:239], a[124:127], v[156:159]
    s_waitcnt lgkmcnt(6)
    v_mfma_f32_16x16x32_bf16 v[32:35], v[208:211], v[160:163], v[32:35]
    ds_read_b64_tr_b16 v[224:225], v245 offset:17024
    v_mfma_f32_16x16x32_bf16 v[96:99], v[208:211], v[164:167], v[96:99]
    ds_read_b64_tr_b16 v[226:227], v245 offset:17536
    buffer_load_dword v246, v249, s[92:95], s98 offen
    v_mfma_f32_16x16x32_bf16 a[160:163], v[208:211], v[168:171], a[160:163]
    v_mfma_f32_16x16x32_bf16 a[224:227], v[208:211], v[172:175], a[224:227]
    s_waitcnt lgkmcnt(6)
    v_exp_f32 v144, v144
    v_mfma_f32_16x16x32_bf16 v[36:39], v[212:215], v[160:163], v[36:39]
    s_lshl_b32 s99, s24, 11
    ds_read_b64_tr_b16 v[228:229], v245 offset:17056
    v_add_f32 v240, v240, v144
    v_mfma_f32_16x16x32_bf16 v[100:103], v[212:215], v[164:167], v[100:103]
    ds_read_b64_tr_b16 v[230:231], v245 offset:17568
    v_mfma_f32_16x16x32_bf16 a[164:167], v[212:215], v[168:171], a[164:167]
    v_mfma_f32_16x16x32_bf16 a[228:231], v[212:215], v[172:175], a[228:231]
    s_waitcnt lgkmcnt(6)
    v_exp_f32 v145, v145
    v_mfma_f32_16x16x32_bf16 v[40:43], v[216:219], v[160:163], v[40:43]
    s_add_u32 s99, s99, k2g_kernel-k1_pc
    ds_read_b64_tr_b16 v[232:233], v245 offset:17088
    v_add_f32 v240, v240, v145
    v_mfma_f32_16x16x32_bf16 v[104:107], v[216:219], v[164:167], v[104:107]
    ds_read_b64_tr_b16 v[234:235], v245 offset:17600
    v_cvt_pk_bf16_f32 v178, v144, v145
    v_mfma_f32_16x16x32_bf16 a[168:171], v[216:219], v[168:171], a[168:171]
    v_mfma_f32_16x16x32_bf16 a[232:235], v[216:219], v[172:175], a[232:235]
    s_waitcnt lgkmcnt(6)
    v_and_b32 v250, 15, v248
    v_mfma_f32_16x16x32_bf16 v[44:47], v[220:223], v[160:163], v[44:47]
    ds_read_b64_tr_b16 v[236:237], v245 offset:17120
    v_mfma_f32_16x16x32_bf16 v[108:111], v[220:223], v[164:167], v[108:111]
    ds_read_b64_tr_b16 v[238:239], v245 offset:17632
    v_mfma_f32_16x16x32_bf16 a[172:175], v[220:223], v[168:171], a[172:175]
    v_mfma_f32_16x16x32_bf16 a[236:239], v[220:223], v[172:175], a[236:239]
    s_waitcnt vmcnt(5) lgkmcnt(6)
    s_barrier
    v_lshlrev_b32 v250, 7, v250
    v_mfma_f32_16x16x32_bf16 v[48:51], v[224:227], v[160:163], v[48:51]
    ds_read_b64_tr_b16 v[208:209], v245 offset:33792
    v_mfma_f32_16x16x32_bf16 v[112:115], v[224:227], v[164:167], v[112:115]
    ds_read_b64_tr_b16 v[210:211], v245 offset:34304
    v_exp_f32 v146, v146
    v_mfma_f32_16x16x32_bf16 a[176:179], v[224:227], v[168:171], a[176:179]
    v_exp_f32 v147, v147
    v_mfma_f32_16x16x32_bf16 a[240:243], v[224:227], v[172:175], a[240:243]
    s_waitcnt lgkmcnt(6)
    buffer_load_dword v246, v250, s[88:91], s99 offen
    v_add_f32 v240, v240, v146
    v_mfma_f32_16x16x32_bf16 v[52:55], v[228:231], v[160:163], v[52:55]
    ds_read_b64_tr_b16 v[212:213], v245 offset:33824
    v_add_f32 v240, v240, v147
    v_mfma_f32_16x16x32_bf16 v[116:119], v[228:231], v[164:167], v[116:119]
    ds_read_b64_tr_b16 v[214:215], v245 offset:34336
    v_exp_f32 v148, v148
    v_mfma_f32_16x16x32_bf16 a[180:183], v[228:231], v[168:171], a[180:183]
    v_cvt_pk_bf16_f32 v179, v146, v147
    v_mfma_f32_16x16x32_bf16 a[244:247], v[228:231], v[172:175], a[244:247]
    s_waitcnt lgkmcnt(6)
    v_exp_f32 v149, v149
    v_mfma_f32_16x16x32_bf16 v[56:59], v[232:235], v[160:163], v[56:59]
    ds_read_b64_tr_b16 v[216:217], v245 offset:33856
    v_add_f32 v241, v241, v148
    v_mfma_f32_16x16x32_bf16 v[120:123], v[232:235], v[164:167], v[120:123]
    ds_read_b64_tr_b16 v[218:219], v245 offset:34368
    v_exp_f32 v150, v150
    v_mfma_f32_16x16x32_bf16 a[184:187], v[232:235], v[168:171], a[184:187]
    v_add_f32 v241, v241, v149
    v_mfma_f32_16x16x32_bf16 a[248:251], v[232:235], v[172:175], a[248:251]
    s_waitcnt lgkmcnt(6)
    v_exp_f32 v151, v151
    v_mfma_f32_16x16x32_bf16 v[60:63], v[236:239], v[160:163], v[60:63]
    ds_read_b64_tr_b16 v[220:221], v245 offset:33888
    v_cvt_pk_bf16_f32 v182, v148, v149
    v_mfma_f32_16x16x32_bf16 v[124:127], v[236:239], v[164:167], v[124:127]
    ds_read_b64_tr_b16 v[222:223], v245 offset:34400
    v_add_f32 v241, v241, v150
    v_mfma_f32_16x16x32_bf16 a[188:191], v[236:239], v[168:171], a[188:191]
    v_exp_f32 v152, v152
    v_mfma_f32_16x16x32_bf16 a[252:255], v[236:239], v[172:175], a[252:255]
    s_nop 0
    v_add_f32 v241, v241, v151
    v_exp_f32 v153, v153
    s_nop 0
    v_cvt_pk_bf16_f32 v183, v150, v151
    s_nop 0
    v_add_f32 v242, v242, v152
    v_exp_f32 v154, v154
    v_exp_f32 v155, v155
    s_nop 0
    v_add_f32 v242, v242, v153
    s_nop 0
    v_cvt_pk_bf16_f32 v186, v152, v153
    v_exp_f32 v156, v156
    s_nop 0
    v_add_f32 v242, v242, v154
    s_nop 0
    v_add_f32 v242, v242, v155
    v_exp_f32 v157, v157
    s_nop 0
    v_cvt_pk_bf16_f32 v187, v154, v155
    s_nop 0
    v_add_f32 v243, v243, v156
    v_exp_f32 v158, v158
    s_nop 0
    v_add_f32 v243, v243, v157
    s_nop 0
    v_cvt_pk_bf16_f32 v190, v156, v157
    s_nop 0
    v_add_f32 v243, v243, v158
    v_exp_f32 v159, v159
    s_nop 0
    v_add_f32 v243, v243, v159
    s_nop 0
    v_cvt_pk_bf16_f32 v191, v158, v159
    s_lshl_b32 s46, s2, 2
    s_add_u32 s46, s46, s24
    s_cmp_lg_u32 s46, 1
    s_cbranch_scc1 k1_nobump
    v_mov_b32 v251, s51
    s_mov_b32 s46, 4096
    s_mov_b64 exec, 1
    buffer_store_dword v251, off, s[20:23], s46 sc1
    s_mov_b64 exec, -1
k1_nobump:
    s_lshl_b32 s46, s24, 14
    s_xor_b32 s47, s46, 16384
    v_lshlrev_b32 v251, 4, v248
    v_add_u32 v249, s46, v251
    v_add_u32 v250, s47, v251
    s_mov_b32 s35, 0
    s_waitcnt lgkmcnt(6)
    v_mfma_f32_16x16x32_bf16 v[0:3], v[208:211], v[176:179], v[0:3]
    ds_read_b64_tr_b16 v[224:225], v245 offset:33920
    v_mfma_f32_16x16x32_bf16 v[64:67], v[208:211], v[180:183], v[64:67]
    ds_read_b64_tr_b16 v[226:227], v245 offset:34432
    v_mfma_f32_16x16x32_bf16 a[128:131], v[208:211], v[184:187], a[128:131]
    ds_write_b64 v253, v[242:243]
    v_mfma_f32_16x16x32_bf16 a[192:195], v[208:211], v[188:191], a[192:195]
    s_waitcnt lgkmcnt(7)
    v_mfma_f32_16x16x32_bf16 v[4:7], v[212:215], v[176:179], v[4:7]
    ds_read_b64_tr_b16 v[228:229], v245 offset:33952
    v_mfma_f32_16x16x32_bf16 v[68:71], v[212:215], v[180:183], v[68:71]
    ds_read_b64_tr_b16 v[230:231], v245 offset:34464
    v_mfma_f32_16x16x32_bf16 a[132:135], v[212:215], v[184:187], a[132:135]
    v_mfma_f32_16x16x32_bf16 a[196:199], v[212:215], v[188:191], a[196:199]
    s_waitcnt lgkmcnt(7)
    v_mfma_f32_16x16x32_bf16 v[8:11], v[216:219], v[176:179], v[8:11]
    ds_read_b64_tr_b16 v[232:233], v245 offset:33984
    v_mfma_f32_16x16x32_bf16 v[72:75], v[216:219], v[180:183], v[72:75]
    ds_read_b64_tr_b16 v[234:235], v245 offset:34496
    v_mfma_f32_16x16x32_bf16 a[136:139], v[216:219], v[184:187], a[136:139]
    v_mfma_f32_16x16x32_bf16 a[200:203], v[216:219], v[188:191], a[200:203]
    s_waitcnt lgkmcnt(7)
    v_mfma_f32_16x16x32_bf16 v[12:15], v[220:223], v[176:179], v[12:15]
    ds_read_b64_tr_b16 v[236:237], v245 offset:34016
    v_mfma_f32_16x16x32_bf16 v[76:79], v[220:223], v[180:183], v[76:79]
    ds_read_b64_tr_b16 v[238:239], v245 offset:34528
    v_mfma_f32_16x16x32_bf16 a[140:143], v[220:223], v[184:187], a[140:143]
    v_mfma_f32_16x16x32_bf16 a[204:207], v[220:223], v[188:191], a[204:207]
    s_waitcnt vmcnt(3) lgkmcnt(7)
    s_barrier
    v_mfma_f32_16x16x32_bf16 v[16:19], v[224:227], v[176:179], v[16:19]
    ds_read_b64_tr_b16 v[208:209], v245 offset:50688
    v_mfma_f32_16x16x32_bf16 v[80:83], v[224:227], v[180:183], v[80:83]
    s_mov_b32 s32, 114688
    s_add_u32 m0, s25, 67584
    ds_read_b64_tr_b16 v[210:211], v245 offset:51200
    v_mfma_f32_16x16x32_bf16 a[144:147], v[224:227], v[184:187], a[144:147]
    buffer_load_dwordx4 v255, s[16:19], s32 offen offset:0  lds
    v_mfma_f32_16x16x32_bf16 a[208:211], v[224:227], v[188:191], a[208:211]
    s_waitcnt lgkmcnt(6)
    v_mfma_f32_16x16x32_bf16 v[20:23], v[228:231], v[176:179], v[20:23]
    ds_read_b64_tr_b16 v[212:213], v245 offset:50720
    v_mfma_f32_16x16x32_bf16 v[84:87], v[228:231], v[180:183], v[84:87]
    s_add_u32 m0, s25, 67744
    ds_read_b64_tr_b16 v[214:215], v245 offset:51232
    v_mfma_f32_16x16x32_bf16 a[148:151], v[228:231], v[184:187], a[148:151]
    buffer_load_dwordx4 v255, s[16:19], s32 offen offset:896  lds
    v_mfma_f32_16x16x32_bf16 a[212:215], v[228:231], v[188:191], a[212:215]
    s_waitcnt lgkmcnt(6)
    v_mfma_f32_16x16x32_bf16 v[24:27], v[232:235], v[176:179], v[24:27]
    ds_read_b64_tr_b16 v[216:217], v245 offset:50752
    v_mfma_f32_16x16x32_bf16 v[88:91], v[232:235], v[180:183], v[88:91]
    s_add_u32 m0, s25, 67904
    ds_read_b64_tr_b16 v[218:219], v245 offset:51264
    v_mfma_f32_16x16x32_bf16 a[152:155], v[232:235], v[184:187], a[152:155]
    buffer_load_dwordx4 v255, s[16:19], s32 offen offset:1792  lds
    v_mfma_f32_16x16x32_bf16 a[216:219], v[232:235], v[188:191], a[216:219]
    s_waitcnt lgkmcnt(6)
    v_mfma_f32_16x16x32_bf16 v[28:31], v[236:239], v[176:179], v[28:31]
    ds_read_b64_tr_b16 v[220:221], v245 offset:50784
    v_mfma_f32_16x16x32_bf16 v[92:95], v[236:239], v[180:183], v[92:95]
    s_add_u32 m0, s25, 68064
    ds_read_b64_tr_b16 v[222:223], v245 offset:51296
    v_mfma_f32_16x16x32_bf16 a[156:159], v[236:239], v[184:187], a[156:159]
    buffer_load_dwordx4 v255, s[16:19], s32 offen offset:2688  lds
    v_mfma_f32_16x16x32_bf16 a[220:223], v[236:239], v[188:191], a[220:223]
    s_waitcnt lgkmcnt(6)
    v_mfma_f32_16x16x32_bf16 v[32:35], v[208:211], v[176:179], v[32:35]
    ds_read_b64_tr_b16 v[224:225], v245 offset:50816
    v_mfma_f32_16x16x32_bf16 v[96:99], v[208:211], v[180:183], v[96:99]
    ds_read_b64_tr_b16 v[226:227], v245 offset:51328
    v_mfma_f32_16x16x32_bf16 a[160:163], v[208:211], v[184:187], a[160:163]
    ds_write_b128 v249, a[128:131] offset:0
    v_mfma_f32_16x16x32_bf16 a[224:227], v[208:211], v[188:191], a[224:227]
    s_waitcnt lgkmcnt(7)
    ds_write_b128 v249, a[132:135] offset:1024
    v_mfma_f32_16x16x32_bf16 v[36:39], v[212:215], v[176:179], v[36:39]
    ds_read_b64_tr_b16 v[228:229], v245 offset:50848
    v_mfma_f32_16x16x32_bf16 v[100:103], v[212:215], v[180:183], v[100:103]
    ds_read_b64_tr_b16 v[230:231], v245 offset:51360
    v_mfma_f32_16x16x32_bf16 a[164:167], v[212:215], v[184:187], a[164:167]
    ds_write_b128 v249, a[136:139] offset:2048
    v_mfma_f32_16x16x32_bf16 a[228:231], v[212:215], v[188:191], a[228:231]
    s_waitcnt lgkmcnt(9)
    ds_write_b128 v249, a[140:143] offset:3072
    v_mfma_f32_16x16x32_bf16 v[40:43], v[216:219], v[176:179], v[40:43]
    ds_read_b64_tr_b16 v[232:233], v245 offset:50880
    v_mfma_f32_16x16x32_bf16 v[104:107], v[216:219], v[180:183], v[104:107]
    ds_read_b64_tr_b16 v[234:235], v245 offset:51392
    v_mfma_f32_16x16x32_bf16 a[168:171], v[216:219], v[184:187], a[168:171]
    ds_write_b128 v249, a[144:147] offset:4096
    v_mfma_f32_16x16x32_bf16 a[232:235], v[216:219], v[188:191], a[232:235]
    s_waitcnt lgkmcnt(11)
    ds_write_b128 v249, a[148:151] offset:5120
    v_mfma_f32_16x16x32_bf16 v[44:47], v[220:223], v[176:179], v[44:47]
    ds_read_b64_tr_b16 v[236:237], v245 offset:50912
    v_mfma_f32_16x16x32_bf16 v[108:111], v[220:223], v[180:183], v[108:111]
    ds_read_b64_tr_b16 v[238:239], v245 offset:51424
    v_mfma_f32_16x16x32_bf16 a[172:175], v[220:223], v[184:187], a[172:175]
    ds_write_b128 v249, a[152:155] offset:6144
    v_mfma_f32_16x16x32_bf16 a[236:239], v[220:223], v[188:191], a[236:239]
    s_waitcnt lgkmcnt(13)
    s_mov_b32 s32, 128
    s_add_u32 m0, s25, 84480
    ds_write_b128 v249, a[156:159] offset:7168
    v_mfma_f32_16x16x32_bf16 v[48:51], v[224:227], v[176:179], v[48:51]
    buffer_load_dwordx4 v255, s[16:19], s32 offen offset:0  lds
    v_mfma_f32_16x16x32_bf16 v[112:115], v[224:227], v[180:183], v[112:115]
    v_mfma_f32_16x16x32_bf16 a[176:179], v[224:227], v[184:187], a[176:179]
    ds_write_b128 v249, a[192:195] offset:8192
    v_mfma_f32_16x16x32_bf16 a[240:243], v[224:227], v[188:191], a[240:243]
    s_waitcnt lgkmcnt(11)
    s_add_u32 m0, s25, 84640
    ds_write_b128 v249, a[196:199] offset:9216
    v_mfma_f32_16x16x32_bf16 v[52:55], v[228:231], v[176:179], v[52:55]
    buffer_load_dwordx4 v255, s[16:19], s32 offen offset:896  lds
    v_mfma_f32_16x16x32_bf16 v[116:119], v[228:231], v[180:183], v[116:119]
    v_mfma_f32_16x16x32_bf16 a[180:183], v[228:231], v[184:187], a[180:183]
    ds_write_b128 v249, a[200:203] offset:10240
    v_mfma_f32_16x16x32_bf16 a[244:247], v[228:231], v[188:191], a[244:247]
    s_waitcnt lgkmcnt(9)
    s_add_u32 m0, s25, 84800
    ds_write_b128 v249, a[204:207] offset:11264
    v_mfma_f32_16x16x32_bf16 v[56:59], v[232:235], v[176:179], v[56:59]
    buffer_load_dwordx4 v255, s[16:19], s32 offen offset:1792  lds
    v_mfma_f32_16x16x32_bf16 v[120:123], v[232:235], v[180:183], v[120:123]
    v_mfma_f32_16x16x32_bf16 a[184:187], v[232:235], v[184:187], a[184:187]
    ds_write_b128 v249, a[208:211] offset:12288
    v_mfma_f32_16x16x32_bf16 a[248:251], v[232:235], v[188:191], a[248:251]
    s_waitcnt lgkmcnt(7)
    s_add_u32 m0, s25, 84960
    ds_write_b128 v249, a[212:215] offset:13312
    v_mfma_f32_16x16x32_bf16 v[60:63], v[236:239], v[176:179], v[60:63]
    buffer_load_dwordx4 v255, s[16:19], s32 offen offset:2688  lds
    v_mfma_f32_16x16x32_bf16 v[124:127], v[236:239], v[180:183], v[124:127]
    v_mfma_f32_16x16x32_bf16 a[188:191], v[236:239], v[184:187], a[188:191]
    ds_write_b128 v249, a[216:219] offset:14336
    v_mfma_f32_16x16x32_bf16 a[252:255], v[236:239], v[188:191], a[252:255]
    ds_write_b128 v249, a[220:223] offset:15360
k1_comb:
    s_setreg_imm32_b32 hwreg(HW_REG_MODE, 4, 2), 3
    s_waitcnt lgkmcnt(0)
    s_barrier
    ds_read_b64 v[242:243], v254
    ds_read_b128 v[128:131], v250 offset:0
    ds_read_b128 v[132:135], v250 offset:1024
    ds_read_b128 v[160:163], v250 offset:8192
    ds_read_b128 v[164:167], v250 offset:9216
    ds_read_b128 v[136:139], v250 offset:2048
    ds_read_b128 v[140:143], v250 offset:3072
    ds_read_b128 v[168:171], v250 offset:10240
    ds_read_b128 v[172:175], v250 offset:11264
    ds_read_b128 v[144:147], v250 offset:4096
    ds_read_b128 v[148:151], v250 offset:5120
    ds_read_b128 v[176:179], v250 offset:12288
    ds_read_b128 v[180:183], v250 offset:13312
    ds_read_b128 v[152:155], v250 offset:6144
    ds_read_b128 v[156:159], v250 offset:7168
    ds_read_b128 v[184:187], v250 offset:14336
    ds_read_b128 v[188:191], v250 offset:15360
    s_mov_b32 s32, 114816
    s_add_u32 m0, s25, 101376
    s_nop 0
    buffer_load_dwordx4 v255, s[16:19], s32 offen offset:0  lds
    s_add_u32 m0, s25, 101536
    s_nop 0
    buffer_load_dwordx4 v255, s[16:19], s32 offen offset:896  lds
    s_add_u32 m0, s25, 101696
    s_nop 0
    buffer_load_dwordx4 v255, s[16:19], s32 offen offset:1792  lds
    s_add_u32 m0, s25, 101856
    s_nop 0
    buffer_load_dwordx4 v255, s[16:19], s32 offen offset:2688  lds
    s_mov_b32 s32, 256
    s_add_u32 m0, s25, 118272
    s_nop 0
    buffer_load_dwordx4 v255, s[16:19], s32 offen offset:0  lds
    s_add_u32 m0, s25, 118432
    s_nop 0
    buffer_load_dwordx4 v255, s[16:19], s32 offen offset:896  lds
    s_add_u32 m0, s25, 118592
    s_nop 0
    buffer_load_dwordx4 v255, s[16:19], s32 offen offset:1792  lds
    s_add_u32 m0, s25, 118752
    s_nop 0
    buffer_load_dwordx4 v255, s[16:19], s32 offen offset:2688  lds
    s_waitcnt lgkmcnt(15)
    v_add_f32 v240, v240, v242
    v_add_f32 v241, v241, v243
    v_mov_b32 v242, v240
    v_mov_b32 v243, v241
    s_nop 1
    v_permlane32_swap_b32 v240, v242
    v_permlane32_swap_b32 v241, v243
    v_add_f32 v240, v240, v242
    v_add_f32 v241, v241, v243
    v_mov_b32 v242, v240
    v_mov_b32 v243, v241
    s_nop 1
    v_permlane16_swap_b32 v240, v242
    v_permlane16_swap_b32 v241, v243
    v_add_f32 v240, v240, v242
    v_add_f32 v241, v241, v243
    v_rcp_f32 v240, v240
    v_rcp_f32 v241, v241
    s_waitcnt lgkmcnt(0)
    s_barrier
    ds_write_b128 v249, a[160:163] offset:0
    v_pk_add_f32 v[0:1], v[0:1], v[128:129]
    v_pk_add_f32 v[2:3], v[2:3], v[130:131]
    v_pk_mul_f32 v[0:1], v[0:1], v[240:241] op_sel:[0,0] op_sel_hi:[1,0]
    v_pk_mul_f32 v[2:3], v[2:3], v[240:241] op_sel:[0,0] op_sel_hi:[1,0]
    v_pk_add_f32 v[4:5], v[4:5], v[132:133]
    v_pk_add_f32 v[6:7], v[6:7], v[134:135]
    ds_write_b128 v249, a[164:167] offset:1024
    v_pk_mul_f32 v[4:5], v[4:5], v[240:241] op_sel:[0,0] op_sel_hi:[1,0]
    v_pk_mul_f32 v[6:7], v[6:7], v[240:241] op_sel:[0,0] op_sel_hi:[1,0]
    v_cvt_pk_bf16_f32 v0, v0, v1
    v_cvt_pk_bf16_f32 v1, v2, v3
    v_cvt_pk_bf16_f32 v2, v4, v5
    v_cvt_pk_bf16_f32 v3, v6, v7
    ds_write_b128 v249, a[168:171] offset:2048
    v_pk_add_f32 v[64:65], v[64:65], v[160:161]
    v_pk_add_f32 v[66:67], v[66:67], v[162:163]
    v_pk_mul_f32 v[64:65], v[64:65], v[240:241] op_sel:[0,1] op_sel_hi:[1,1]
    v_pk_mul_f32 v[66:67], v[66:67], v[240:241] op_sel:[0,1] op_sel_hi:[1,1]
    v_pk_add_f32 v[68:69], v[68:69], v[164:165]
    v_pk_add_f32 v[70:71], v[70:71], v[166:167]
    ds_write_b128 v249, a[172:175] offset:3072
    v_pk_mul_f32 v[68:69], v[68:69], v[240:241] op_sel:[0,1] op_sel_hi:[1,1]
    v_pk_mul_f32 v[70:71], v[70:71], v[240:241] op_sel:[0,1] op_sel_hi:[1,1]
    v_cvt_pk_bf16_f32 v64, v64, v65
    v_cvt_pk_bf16_f32 v65, v66, v67
    v_cvt_pk_bf16_f32 v66, v68, v69
    v_cvt_pk_bf16_f32 v67, v70, v71
    ds_write_b128 v249, a[176:179] offset:4096
    v_pk_add_f32 v[8:9], v[8:9], v[136:137]
    v_pk_add_f32 v[10:11], v[10:11], v[138:139]
    v_pk_mul_f32 v[8:9], v[8:9], v[240:241] op_sel:[0,0] op_sel_hi:[1,0]
    v_pk_mul_f32 v[10:11], v[10:11], v[240:241] op_sel:[0,0] op_sel_hi:[1,0]
    v_pk_add_f32 v[12:13], v[12:13], v[140:141]
    v_pk_add_f32 v[14:15], v[14:15], v[142:143]
    ds_write_b128 v249, a[180:183] offset:5120
    v_pk_mul_f32 v[12:13], v[12:13], v[240:241] op_sel:[0,0] op_sel_hi:[1,0]
    v_pk_mul_f32 v[14:15], v[14:15], v[240:241] op_sel:[0,0] op_sel_hi:[1,0]
    v_cvt_pk_bf16_f32 v8, v8, v9
    v_cvt_pk_bf16_f32 v9, v10, v11
    v_cvt_pk_bf16_f32 v10, v12, v13
    v_cvt_pk_bf16_f32 v11, v14, v15
    ds_write_b128 v249, a[184:187] offset:6144
    v_pk_add_f32 v[72:73], v[72:73], v[168:169]
    v_pk_add_f32 v[74:75], v[74:75], v[170:171]
    v_pk_mul_f32 v[72:73], v[72:73], v[240:241] op_sel:[0,1] op_sel_hi:[1,1]
    v_pk_mul_f32 v[74:75], v[74:75], v[240:241] op_sel:[0,1] op_sel_hi:[1,1]
    v_pk_add_f32 v[76:77], v[76:77], v[172:173]
    v_pk_add_f32 v[78:79], v[78:79], v[174:175]
    ds_write_b128 v249, a[188:191] offset:7168
    v_pk_mul_f32 v[76:77], v[76:77], v[240:241] op_sel:[0,1] op_sel_hi:[1,1]
    v_pk_mul_f32 v[78:79], v[78:79], v[240:241] op_sel:[0,1] op_sel_hi:[1,1]
    v_cvt_pk_bf16_f32 v72, v72, v73
    v_cvt_pk_bf16_f32 v73, v74, v75
    v_cvt_pk_bf16_f32 v74, v76, v77
    v_cvt_pk_bf16_f32 v75, v78, v79
    ds_write_b128 v249, a[224:227] offset:8192
    v_pk_add_f32 v[16:17], v[16:17], v[144:145]
    v_pk_add_f32 v[18:19], v[18:19], v[146:147]
    v_pk_mul_f32 v[16:17], v[16:17], v[240:241] op_sel:[0,0] op_sel_hi:[1,0]
    v_pk_mul_f32 v[18:19], v[18:19], v[240:241] op_sel:[0,0] op_sel_hi:[1,0]
    v_pk_add_f32 v[20:21], v[20:21], v[148:149]
    v_pk_add_f32 v[22:23], v[22:23], v[150:151]
    ds_write_b128 v249, a[228:231] offset:9216
    v_pk_mul_f32 v[20:21], v[20:21], v[240:241] op_sel:[0,0] op_sel_hi:[1,0]
    v_pk_mul_f32 v[22:23], v[22:23], v[240:241] op_sel:[0,0] op_sel_hi:[1,0]
    v_cvt_pk_bf16_f32 v16, v16, v17
    v_cvt_pk_bf16_f32 v17, v18, v19
    v_cvt_pk_bf16_f32 v18, v20, v21
    v_cvt_pk_bf16_f32 v19, v22, v23
    ds_write_b128 v249, a[232:235] offset:10240
    v_pk_add_f32 v[80:81], v[80:81], v[176:177]
    v_pk_add_f32 v[82:83], v[82:83], v[178:179]
    v_pk_mul_f32 v[80:81], v[80:81], v[240:241] op_sel:[0,1] op_sel_hi:[1,1]
    v_pk_mul_f32 v[82:83], v[82:83], v[240:241] op_sel:[0,1] op_sel_hi:[1,1]
    v_pk_add_f32 v[84:85], v[84:85], v[180:181]
    v_pk_add_f32 v[86:87], v[86:87], v[182:183]
    ds_write_b128 v249, a[236:239] offset:11264
    v_pk_mul_f32 v[84:85], v[84:85], v[240:241] op_sel:[0,1] op_sel_hi:[1,1]
    v_pk_mul_f32 v[86:87], v[86:87], v[240:241] op_sel:[0,1] op_sel_hi:[1,1]
    v_cvt_pk_bf16_f32 v80, v80, v81
    v_cvt_pk_bf16_f32 v81, v82, v83
    v_cvt_pk_bf16_f32 v82, v84, v85
    v_cvt_pk_bf16_f32 v83, v86, v87
    ds_write_b128 v249, a[240:243] offset:12288
    v_pk_add_f32 v[24:25], v[24:25], v[152:153]
    v_pk_add_f32 v[26:27], v[26:27], v[154:155]
    v_pk_mul_f32 v[24:25], v[24:25], v[240:241] op_sel:[0,0] op_sel_hi:[1,0]
    v_pk_mul_f32 v[26:27], v[26:27], v[240:241] op_sel:[0,0] op_sel_hi:[1,0]
    v_pk_add_f32 v[28:29], v[28:29], v[156:157]
    v_pk_add_f32 v[30:31], v[30:31], v[158:159]
    ds_write_b128 v249, a[244:247] offset:13312
    v_pk_mul_f32 v[28:29], v[28:29], v[240:241] op_sel:[0,0] op_sel_hi:[1,0]
    v_pk_mul_f32 v[30:31], v[30:31], v[240:241] op_sel:[0,0] op_sel_hi:[1,0]
    v_cvt_pk_bf16_f32 v24, v24, v25
    v_cvt_pk_bf16_f32 v25, v26, v27
    v_cvt_pk_bf16_f32 v26, v28, v29
    v_cvt_pk_bf16_f32 v27, v30, v31
    ds_write_b128 v249, a[248:251] offset:14336
    v_pk_add_f32 v[88:89], v[88:89], v[184:185]
    v_pk_add_f32 v[90:91], v[90:91], v[186:187]
    v_pk_mul_f32 v[88:89], v[88:89], v[240:241] op_sel:[0,1] op_sel_hi:[1,1]
    v_pk_mul_f32 v[90:91], v[90:91], v[240:241] op_sel:[0,1] op_sel_hi:[1,1]
    v_pk_add_f32 v[92:93], v[92:93], v[188:189]
    v_pk_add_f32 v[94:95], v[94:95], v[190:191]
    ds_write_b128 v249, a[252:255] offset:15360
    v_pk_mul_f32 v[92:93], v[92:93], v[240:241] op_sel:[0,1] op_sel_hi:[1,1]
    v_pk_mul_f32 v[94:95], v[94:95], v[240:241] op_sel:[0,1] op_sel_hi:[1,1]
    v_cvt_pk_bf16_f32 v88, v88, v89
    v_cvt_pk_bf16_f32 v89, v90, v91
    v_cvt_pk_bf16_f32 v90, v92, v93
    v_cvt_pk_bf16_f32 v91, v94, v95
    v_add_u32 v245, 67584, v252
    v_add_u32 v244, 135168, v252
    s_waitcnt vmcnt(12) lgkmcnt(0)
    s_barrier
    ds_read_b128 v[128:131], v250 offset:0
    ds_read_b128 v[132:135], v250 offset:1024
    ds_read_b128 v[160:163], v250 offset:8192
    ds_read_b128 v[164:167], v250 offset:9216
    ds_read_b128 v[136:139], v250 offset:2048
    ds_read_b128 v[140:143], v250 offset:3072
    ds_read_b128 v[168:171], v250 offset:10240
    ds_read_b128 v[172:175], v250 offset:11264
    ds_read_b128 v[144:147], v250 offset:4096
    ds_read_b128 v[148:151], v250 offset:5120
    ds_read_b128 v[176:179], v250 offset:12288
    ds_read_b128 v[180:183], v250 offset:13312
    ds_read_b128 v[152:155], v250 offset:6144
    ds_read_b128 v[156:159], v250 offset:7168
    ds_read_b128 v[184:187], v250 offset:14336
    ds_read_b128 v[188:191], v250 offset:15360
    s_waitcnt lgkmcnt(15)
    v_pk_add_f32 v[32:33], v[32:33], v[128:129]
    v_pk_add_f32 v[34:35], v[34:35], v[130:131]
    v_pk_mul_f32 v[32:33], v[32:33], v[240:241] op_sel:[0,0] op_sel_hi:[1,0]
    v_pk_mul_f32 v[34:35], v[34:35], v[240:241] op_sel:[0,0] op_sel_hi:[1,0]
    s_waitcnt lgkmcnt(14)
    v_pk_add_f32 v[36:37], v[36:37], v[132:133]
    v_pk_add_f32 v[38:39], v[38:39], v[134:135]
    v_pk_mul_f32 v[36:37], v[36:37], v[240:241] op_sel:[0,0] op_sel_hi:[1,0]
    v_pk_mul_f32 v[38:39], v[38:39], v[240:241] op_sel:[0,0] op_sel_hi:[1,0]
    v_cvt_pk_bf16_f32 v32, v32, v33
    v_cvt_pk_bf16_f32 v33, v34, v35
    v_cvt_pk_bf16_f32 v34, v36, v37
    v_cvt_pk_bf16_f32 v35, v38, v39
    s_waitcnt lgkmcnt(13)
    v_pk_add_f32 v[96:97], v[96:97], v[160:161]
    v_pk_add_f32 v[98:99], v[98:99], v[162:163]
    v_pk_mul_f32 v[96:97], v[96:97], v[240:241] op_sel:[0,1] op_sel_hi:[1,1]
    v_pk_mul_f32 v[98:99], v[98:99], v[240:241] op_sel:[0,1] op_sel_hi:[1,1]
    ds_read_b64_tr_b16 a[128:129], v244 offset:0
    ds_read_b64_tr_b16 a[130:131], v244 offset:256
    s_waitcnt lgkmcnt(14)
    v_pk_add_f32 v[100:101], v[100:101], v[164:165]
    v_pk_add_f32 v[102:103], v[102:103], v[166:167]
    v_pk_mul_f32 v[100:101], v[100:101], v[240:241] op_sel:[0,1] op_sel_hi:[1,1]
    v_pk_mul_f32 v[102:103], v[102:103], v[240:241] op_sel:[0,1] op_sel_hi:[1,1]
    v_cvt_pk_bf16_f32 v96, v96, v97
    v_cvt_pk_bf16_f32 v97, v98, v99
    v_cvt_pk_bf16_f32 v98, v100, v101
    v_cvt_pk_bf16_f32 v99, v102, v103
    s_waitcnt lgkmcnt(13)
    v_pk_add_f32 v[40:41], v[40:41], v[136:137]
    v_pk_add_f32 v[42:43], v[42:43], v[138:139]
    v_pk_mul_f32 v[40:41], v[40:41], v[240:241] op_sel:[0,0] op_sel_hi:[1,0]
    v_pk_mul_f32 v[42:43], v[42:43], v[240:241] op_sel:[0,0] op_sel_hi:[1,0]
    s_waitcnt lgkmcnt(12)
    v_pk_add_f32 v[44:45], v[44:45], v[140:141]
    v_pk_add_f32 v[46:47], v[46:47], v[142:143]
    v_pk_mul_f32 v[44:45], v[44:45], v[240:241] op_sel:[0,0] op_sel_hi:[1,0]
    v_pk_mul_f32 v[46:47], v[46:47], v[240:241] op_sel:[0,0] op_sel_hi:[1,0]
    ds_read_b64_tr_b16 a[132:133], v244 offset:32
    ds_read_b64_tr_b16 a[134:135], v244 offset:288
    v_cvt_pk_bf16_f32 v40, v40, v41
    v_cvt_pk_bf16_f32 v41, v42, v43
    v_cvt_pk_bf16_f32 v42, v44, v45
    v_cvt_pk_bf16_f32 v43, v46, v47
    s_waitcnt lgkmcnt(13)
    v_pk_add_f32 v[104:105], v[104:105], v[168:169]
    v_pk_add_f32 v[106:107], v[106:107], v[170:171]
    v_pk_mul_f32 v[104:105], v[104:105], v[240:241] op_sel:[0,1] op_sel_hi:[1,1]
    v_pk_mul_f32 v[106:107], v[106:107], v[240:241] op_sel:[0,1] op_sel_hi:[1,1]
    s_waitcnt lgkmcnt(12)
    v_pk_add_f32 v[108:109], v[108:109], v[172:173]
    v_pk_add_f32 v[110:111], v[110:111], v[174:175]
    v_pk_mul_f32 v[108:109], v[108:109], v[240:241] op_sel:[0,1] op_sel_hi:[1,1]
    v_pk_mul_f32 v[110:111], v[110:111], v[240:241] op_sel:[0,1] op_sel_hi:[1,1]
    v_cvt_pk_bf16_f32 v104, v104, v105
    v_cvt_pk_bf16_f32 v105, v106, v107
    v_cvt_pk_bf16_f32 v106, v108, v109
    v_cvt_pk_bf16_f32 v107, v110, v111
    ds_read_b64_tr_b16 a[136:137], v244 offset:64
    ds_read_b64_tr_b16 a[138:139], v244 offset:320
    s_waitcnt lgkmcnt(13)
    v_pk_add_f32 v[48:49], v[48:49], v[144:145]
    v_pk_add_f32 v[50:51], v[50:51], v[146:147]
    v_pk_mul_f32 v[48:49], v[48:49], v[240:241] op_sel:[0,0] op_sel_hi:[1,0]
    v_pk_mul_f32 v[50:51], v[50:51], v[240:241] op_sel:[0,0] op_sel_hi:[1,0]
    s_waitcnt lgkmcnt(12)
    v_pk_add_f32 v[52:53], v[52:53], v[148:149]
    v_pk_add_f32 v[54:55], v[54:55], v[150:151]
    v_pk_mul_f32 v[52:53], v[52:53], v[240:241] op_sel:[0,0] op_sel_hi:[1,0]
    v_pk_mul_f32 v[54:55], v[54:55], v[240:241] op_sel:[0,0] op_sel_hi:[1,0]
    v_cvt_pk_bf16_f32 v48, v48, v49
    v_cvt_pk_bf16_f32 v49, v50, v51
    v_cvt_pk_bf16_f32 v50, v52, v53
    v_cvt_pk_bf16_f32 v51, v54, v55
    s_waitcnt lgkmcnt(11)
    v_pk_add_f32 v[112:113], v[112:113], v[176:177]
    v_pk_add_f32 v[114:115], v[114:115], v[178:179]
    v_pk_mul_f32 v[112:113], v[112:113], v[240:241] op_sel:[0,1] op_sel_hi:[1,1]
    v_pk_mul_f32 v[114:115], v[114:115], v[240:241] op_sel:[0,1] op_sel_hi:[1,1]
    ds_read_b64_tr_b16 a[140:141], v244 offset:96
    ds_read_b64_tr_b16 a[142:143], v244 offset:352
    s_waitcnt lgkmcnt(12)
    v_pk_add_f32 v[116:117], v[116:117], v[180:181]
    v_pk_add_f32 v[118:119], v[118:119], v[182:183]
    v_pk_mul_f32 v[116:117], v[116:117], v[240:241] op_sel:[0,1] op_sel_hi:[1,1]
    v_pk_mul_f32 v[118:119], v[118:119], v[240:241] op_sel:[0,1] op_sel_hi:[1,1]
    v_cvt_pk_bf16_f32 v112, v112, v113
    v_cvt_pk_bf16_f32 v113, v114, v115
    v_cvt_pk_bf16_f32 v114, v116, v117
    v_cvt_pk_bf16_f32 v115, v118, v119
    s_waitcnt lgkmcnt(11)
    v_pk_add_f32 v[56:57], v[56:57], v[152:153]
    v_pk_add_f32 v[58:59], v[58:59], v[154:155]
    v_pk_mul_f32 v[56:57], v[56:57], v[240:241] op_sel:[0,0] op_sel_hi:[1,0]
    v_pk_mul_f32 v[58:59], v[58:59], v[240:241] op_sel:[0,0] op_sel_hi:[1,0]
    s_waitcnt lgkmcnt(10)
    v_pk_add_f32 v[60:61], v[60:61], v[156:157]
    v_pk_add_f32 v[62:63], v[62:63], v[158:159]
    v_pk_mul_f32 v[60:61], v[60:61], v[240:241] op_sel:[0,0] op_sel_hi:[1,0]
    v_pk_mul_f32 v[62:63], v[62:63], v[240:241] op_sel:[0,0] op_sel_hi:[1,0]
    ds_read_b64_tr_b16 a[144:145], v244 offset:512
    ds_read_b64_tr_b16 a[146:147], v244 offset:768
    v_cvt_pk_bf16_f32 v56, v56, v57
    v_cvt_pk_bf16_f32 v57, v58, v59
    v_cvt_pk_bf16_f32 v58, v60, v61
    v_cvt_pk_bf16_f32 v59, v62, v63
    s_waitcnt lgkmcnt(11)
    v_pk_add_f32 v[120:121], v[120:121], v[184:185]
    v_pk_add_f32 v[122:123], v[122:123], v[186:187]
    v_pk_mul_f32 v[120:121], v[120:121], v[240:241] op_sel:[0,1] op_sel_hi:[1,1]
    v_pk_mul_f32 v[122:123], v[122:123], v[240:241] op_sel:[0,1] op_sel_hi:[1,1]
    s_waitcnt lgkmcnt(10)
    v_pk_add_f32 v[124:125], v[124:125], v[188:189]
    v_pk_add_f32 v[126:127], v[126:127], v[190:191]
    v_pk_mul_f32 v[124:125], v[124:125], v[240:241] op_sel:[0,1] op_sel_hi:[1,1]
    v_pk_mul_f32 v[126:127], v[126:127], v[240:241] op_sel:[0,1] op_sel_hi:[1,1]
    v_cvt_pk_bf16_f32 v120, v120, v121
    v_cvt_pk_bf16_f32 v121, v122, v123
    v_cvt_pk_bf16_f32 v122, v124, v125
    v_cvt_pk_bf16_f32 v123, v126, v127
    ds_read_b64_tr_b16 a[148:149], v244 offset:544
    ds_read_b64_tr_b16 a[150:151], v244 offset:800
    s_barrier
    s_waitcnt lgkmcnt(10)
    v_mfma_f32_16x16x32_bf16 v[192:195], a[128:131], v[0:3], 0
    s_mov_b32 s32, 114944
    ds_read_b64_tr_b16 a[152:153], v244 offset:576
    v_mfma_f32_16x16x32_bf16 v[208:211], a[128:131], v[64:67], 0
    s_waitcnt lgkmcnt(9)
    s_add_u32 m0, s25, 0
    ds_read_b64_tr_b16 a[154:155], v244 offset:832
    v_mfma_f32_16x16x32_bf16 v[196:199], a[132:135], v[0:3], 0
    ds_read_b64_tr_b16 a[156:157], v244 offset:608
    buffer_load_dwordx4 v255, s[16:19], s32 offen offset:0  lds
    v_mfma_f32_16x16x32_bf16 v[212:215], a[132:135], v[64:67], 0
    s_waitcnt lgkmcnt(9)
    ds_read_b64_tr_b16 a[158:159], v244 offset:864
    v_mfma_f32_16x16x32_bf16 v[200:203], a[136:139], v[0:3], 0
    s_add_u32 m0, s25, 160
    ds_read_b64_tr_b16 a[128:129], v244 offset:8448
    v_mfma_f32_16x16x32_bf16 v[216:219], a[136:139], v[64:67], 0
    s_waitcnt lgkmcnt(9)
    ds_read_b64_tr_b16 a[130:131], v244 offset:8704
    buffer_load_dwordx4 v255, s[16:19], s32 offen offset:896  lds
    v_mfma_f32_16x16x32_bf16 v[204:207], a[140:143], v[0:3], 0
    ds_read_b64_tr_b16 a[132:133], v244 offset:8480
    v_mfma_f32_16x16x32_bf16 v[220:223], a[140:143], v[64:67], 0
    s_waitcnt lgkmcnt(9)
    s_add_u32 m0, s25, 320
    ds_read_b64_tr_b16 a[134:135], v244 offset:8736
    v_mfma_f32_16x16x32_bf16 v[192:195], a[144:147], v[8:11], v[192:195]
    ds_read_b64_tr_b16 a[136:137], v244 offset:8512
    buffer_load_dwordx4 v255, s[16:19], s32 offen offset:1792  lds
    v_mfma_f32_16x16x32_bf16 v[208:211], a[144:147], v[72:75], v[208:211]
    s_waitcnt lgkmcnt(9)
    ds_read_b64_tr_b16 a[138:139], v244 offset:8768
    v_mfma_f32_16x16x32_bf16 v[196:199], a[148:151], v[8:11], v[196:199]
    s_add_u32 m0, s25, 480
    ds_read_b64_tr_b16 a[140:141], v244 offset:8544
    v_max_u32 v224, v0, v1
    v_mfma_f32_16x16x32_bf16 v[212:215], a[148:151], v[72:75], v[212:215]
    s_waitcnt lgkmcnt(9)
    ds_read_b64_tr_b16 a[142:143], v244 offset:8800
    buffer_load_dwordx4 v255, s[16:19], s32 offen offset:2688  lds
    v_max_u32 v225, v64, v65
    v_mfma_f32_16x16x32_bf16 v[200:203], a[152:155], v[8:11], v[200:203]
    s_mov_b32 s32, 384
    ds_read_b64_tr_b16 a[144:145], v244 offset:8960
    v_max3_u32 v224, v224, v2, v3
    v_mfma_f32_16x16x32_bf16 v[216:219], a[152:155], v[72:75], v[216:219]
    s_waitcnt lgkmcnt(9)
    s_add_u32 m0, s25, 16896
    ds_read_b64_tr_b16 a[146:147], v244 offset:9216
    v_max3_u32 v225, v225, v66, v67
    v_mfma_f32_16x16x32_bf16 v[204:207], a[156:159], v[8:11], v[204:207]
    ds_read_b64_tr_b16 a[148:149], v244 offset:8992
    buffer_load_dwordx4 v255, s[16:19], s32 offen offset:0  lds
    v_max3_u32 v224, v224, v8, v9
    v_mfma_f32_16x16x32_bf16 v[220:223], a[156:159], v[72:75], v[220:223]
    s_waitcnt lgkmcnt(9)
    ds_read_b64_tr_b16 a[150:151], v244 offset:9248
    v_max3_u32 v225, v225, v72, v73
    v_mfma_f32_16x16x32_bf16 v[192:195], a[128:131], v[16:19], v[192:195]
    s_add_u32 m0, s25, 17056
    ds_read_b64_tr_b16 a[152:153], v244 offset:9024
    v_max3_u32 v224, v224, v10, v11
    v_mfma_f32_16x16x32_bf16 v[208:211], a[128:131], v[80:83], v[208:211]
    s_waitcnt lgkmcnt(9)
    ds_read_b64_tr_b16 a[154:155], v244 offset:9280
    buffer_load_dwordx4 v255, s[16:19], s32 offen offset:896  lds
    v_max3_u32 v225, v225, v74, v75
    v_mfma_f32_16x16x32_bf16 v[196:199], a[132:135], v[16:19], v[196:199]
    ds_read_b64_tr_b16 a[156:157], v244 offset:9056
    v_max3_u32 v224, v224, v16, v17
    v_mfma_f32_16x16x32_bf16 v[212:215], a[132:135], v[80:83], v[212:215]
    s_waitcnt lgkmcnt(9)
    s_add_u32 m0, s25, 17216
    ds_read_b64_tr_b16 a[158:159], v244 offset:9312
    v_max3_u32 v225, v225, v80, v81
    v_mfma_f32_16x16x32_bf16 v[200:203], a[136:139], v[16:19], v[200:203]
    ds_read_b64_tr_b16 a[128:129], v245 offset:0
    buffer_load_dwordx4 v255, s[16:19], s32 offen offset:1792  lds
    v_max3_u32 v224, v224, v18, v19
    v_mfma_f32_16x16x32_bf16 v[216:219], a[136:139], v[80:83], v[216:219]
    s_waitcnt lgkmcnt(9)
    ds_read_b64_tr_b16 a[130:131], v245 offset:256
    v_max3_u32 v225, v225, v82, v83
    v_mfma_f32_16x16x32_bf16 v[204:207], a[140:143], v[16:19], v[204:207]
    s_add_u32 m0, s25, 17376
    ds_read_b64_tr_b16 a[132:133], v245 offset:32
    v_max3_u32 v224, v224, v24, v25
    v_mfma_f32_16x16x32_bf16 v[220:223], a[140:143], v[80:83], v[220:223]
    s_waitcnt lgkmcnt(9)
    ds_read_b64_tr_b16 a[134:135], v245 offset:288
    buffer_load_dwordx4 v255, s[16:19], s32 offen offset:2688  lds
    v_max3_u32 v225, v225, v88, v89
    v_mfma_f32_16x16x32_bf16 v[192:195], a[144:147], v[24:27], v[192:195]
    s_mov_b32 s32, 115072
    ds_read_b64_tr_b16 a[136:137], v245 offset:64
    v_max3_u32 v224, v224, v26, v27
    v_mfma_f32_16x16x32_bf16 v[208:211], a[144:147], v[88:91], v[208:211]
    s_waitcnt lgkmcnt(9)
    s_add_u32 m0, s25, 50688
    ds_read_b64_tr_b16 a[138:139], v245 offset:320
    v_max3_u32 v225, v225, v90, v91
    v_mfma_f32_16x16x32_bf16 v[196:199], a[148:151], v[24:27], v[196:199]
    ds_read_b64_tr_b16 a[140:141], v245 offset:96
    buffer_load_dwordx4 v255, s[16:19], s32 offen offset:0  lds
    v_max3_u32 v224, v224, v32, v33
    v_mfma_f32_16x16x32_bf16 v[212:215], a[148:151], v[88:91], v[212:215]
    s_waitcnt lgkmcnt(9)
    ds_read_b64_tr_b16 a[142:143], v245 offset:352
    v_max3_u32 v225, v225, v96, v97
    v_mfma_f32_16x16x32_bf16 v[200:203], a[152:155], v[24:27], v[200:203]
    s_add_u32 m0, s25, 50848
    ds_read_b64_tr_b16 a[144:145], v245 offset:512
    v_max3_u32 v224, v224, v34, v35
    v_mfma_f32_16x16x32_bf16 v[216:219], a[152:155], v[88:91], v[216:219]
    s_waitcnt lgkmcnt(9)
    ds_read_b64_tr_b16 a[146:147], v245 offset:768
    buffer_load_dwordx4 v255, s[16:19], s32 offen offset:896  lds
    v_max3_u32 v225, v225, v98, v99
    v_mfma_f32_16x16x32_bf16 v[204:207], a[156:159], v[24:27], v[204:207]
    ds_read_b64_tr_b16 a[148:149], v245 offset:544
    v_max3_u32 v224, v224, v40, v41
    v_mfma_f32_16x16x32_bf16 v[220:223], a[156:159], v[88:91], v[220:223]
    s_waitcnt lgkmcnt(9)
    s_add_u32 m0, s25, 51008
    ds_read_b64_tr_b16 a[150:151], v245 offset:800
    v_max3_u32 v225, v225, v104, v105
    v_mfma_f32_16x16x32_bf16 v[192:195], a[128:131], v[32:35], v[192:195]
    ds_read_b64_tr_b16 a[152:153], v245 offset:576
    buffer_load_dwordx4 v255, s[16:19], s32 offen offset:1792  lds
    v_max3_u32 v224, v224, v42, v43
    v_mfma_f32_16x16x32_bf16 v[208:211], a[128:131], v[96:99], v[208:211]
    s_waitcnt lgkmcnt(9)
    ds_read_b64_tr_b16 a[154:155], v245 offset:832
    v_max3_u32 v225, v225, v106, v107
    v_mfma_f32_16x16x32_bf16 v[196:199], a[132:135], v[32:35], v[196:199]
    s_add_u32 m0, s25, 51168
    ds_read_b64_tr_b16 a[156:157], v245 offset:608
    v_max3_u32 v224, v224, v48, v49
    v_mfma_f32_16x16x32_bf16 v[212:215], a[132:135], v[96:99], v[212:215]
    s_waitcnt lgkmcnt(9)
    ds_read_b64_tr_b16 a[158:159], v245 offset:864
    buffer_load_dwordx4 v255, s[16:19], s32 offen offset:2688  lds
    v_max3_u32 v225, v225, v112, v113
    v_mfma_f32_16x16x32_bf16 v[200:203], a[136:139], v[32:35], v[200:203]
    s_mov_b32 s32, 512
    ds_read_b64_tr_b16 a[128:129], v245 offset:8448
    v_max3_u32 v224, v224, v50, v51
    v_mfma_f32_16x16x32_bf16 v[216:219], a[136:139], v[96:99], v[216:219]
    s_waitcnt lgkmcnt(9)
    s_add_u32 m0, s25, 33792
    ds_read_b64_tr_b16 a[130:131], v245 offset:8704
    v_max3_u32 v225, v225, v114, v115
    v_mfma_f32_16x16x32_bf16 v[204:207], a[140:143], v[32:35], v[204:207]
    ds_read_b64_tr_b16 a[132:133], v245 offset:8480
    buffer_load_dwordx4 v255, s[16:19], s32 offen offset:0  lds
    v_max3_u32 v224, v224, v56, v57
    v_mfma_f32_16x16x32_bf16 v[220:223], a[140:143], v[96:99], v[220:223]
    s_waitcnt lgkmcnt(9)
    ds_read_b64_tr_b16 a[134:135], v245 offset:8736
    v_max3_u32 v225, v225, v120, v121
    v_mfma_f32_16x16x32_bf16 v[192:195], a[144:147], v[40:43], v[192:195]
    s_add_u32 m0, s25, 33952
    ds_read_b64_tr_b16 a[136:137], v245 offset:8512
    v_max3_u32 v224, v224, v58, v59
    v_mfma_f32_16x16x32_bf16 v[208:211], a[144:147], v[104:107], v[208:211]
    s_waitcnt lgkmcnt(9)
    ds_read_b64_tr_b16 a[138:139], v245 offset:8768
    buffer_load_dwordx4 v255, s[16:19], s32 offen offset:896  lds
    v_max3_u32 v225, v225, v122, v123
    v_mfma_f32_16x16x32_bf16 v[196:199], a[148:151], v[40:43], v[196:199]
    ds_read_b64_tr_b16 a[140:141], v245 offset:8544
    v_and_b32 v224, 0x7fff0000, v224
    v_mfma_f32_16x16x32_bf16 v[212:215], a[148:151], v[104:107], v[212:215]
    s_waitcnt lgkmcnt(9)
    s_add_u32 m0, s25, 34112
    ds_read_b64_tr_b16 a[142:143], v245 offset:8800
    v_mul_f32 v226, 503316480, v240
    v_mfma_f32_16x16x32_bf16 v[200:203], a[152:155], v[40:43], v[200:203]
    ds_read_b64_tr_b16 a[144:145], v245 offset:8960
    buffer_load_dwordx4 v255, s[16:19], s32 offen offset:1792  lds
    v_mul_f32 v226, 503316480, v226
    v_mfma_f32_16x16x32_bf16 v[216:219], a[152:155], v[104:107], v[216:219]
    s_waitcnt lgkmcnt(9)
    ds_read_b64_tr_b16 a[146:147], v245 offset:9216
    v_and_b32 v225, 0x7fff0000, v225
    v_mfma_f32_16x16x32_bf16 v[204:207], a[156:159], v[40:43], v[204:207]
    s_add_u32 m0, s25, 34272
    ds_read_b64_tr_b16 a[148:149], v245 offset:8992
    v_mul_f32 v227, 503316480, v241
    v_mfma_f32_16x16x32_bf16 v[220:223], a[156:159], v[104:107], v[220:223]
    s_waitcnt lgkmcnt(9)
    ds_read_b64_tr_b16 a[150:151], v245 offset:9248
    buffer_load_dwordx4 v255, s[16:19], s32 offen offset:2688  lds
    v_mul_f32 v227, 503316480, v227
    v_mfma_f32_16x16x32_bf16 v[192:195], a[128:131], v[48:51], v[192:195]
    ds_read_b64_tr_b16 a[152:153], v245 offset:9024
    v_cmp_nge_f32 s[36:37], v224, v226
    v_mfma_f32_16x16x32_bf16 v[208:211], a[128:131], v[112:115], v[208:211]
    s_waitcnt lgkmcnt(9)
    ds_read_b64_tr_b16 a[154:155], v245 offset:9280
    v_cmp_nge_f32 s[38:39], v225, v227
    v_mfma_f32_16x16x32_bf16 v[196:199], a[132:135], v[48:51], v[196:199]
    ds_read_b64_tr_b16 a[156:157], v245 offset:9056
    v_mov_b32 v228, 562036736
    v_mfma_f32_16x16x32_bf16 v[212:215], a[132:135], v[112:115], v[212:215]
    s_waitcnt vmcnt(20) lgkmcnt(9)
    s_barrier
    ds_read_b64_tr_b16 a[158:159], v245 offset:9312
    v_cmp_nge_f32 s[40:41], v240, v228
    v_mfma_f32_16x16x32_bf16 v[200:203], a[136:139], v[48:51], v[200:203]
    ds_read_b64_tr_b16 a[128:129], v245 offset:16896
    v_cmp_nge_f32 s[42:43], v241, v228
    v_mfma_f32_16x16x32_bf16 v[216:219], a[136:139], v[112:115], v[216:219]
    s_waitcnt lgkmcnt(9)
    ds_read_b64_tr_b16 a[130:131], v245 offset:17152
    v_mfma_f32_16x16x32_bf16 v[204:207], a[140:143], v[48:51], v[204:207]
    ds_read_b64_tr_b16 a[132:133], v245 offset:16928
    v_mfma_f32_16x16x32_bf16 v[220:223], a[140:143], v[112:115], v[220:223]
    s_waitcnt lgkmcnt(9)
    ds_read_b64_tr_b16 a[134:135], v245 offset:17184
    v_mfma_f32_16x16x32_bf16 v[192:195], a[144:147], v[56:59], v[192:195]
    ds_read_b64_tr_b16 a[136:137], v245 offset:16960
    v_mfma_f32_16x16x32_bf16 v[208:211], a[144:147], v[120:123], v[208:211]
    s_waitcnt lgkmcnt(9)
    ds_read_b64_tr_b16 a[138:139], v245 offset:17216
    v_mfma_f32_16x16x32_bf16 v[196:199], a[148:151], v[56:59], v[196:199]
    ds_read_b64_tr_b16 a[140:141], v245 offset:16992
    v_mfma_f32_16x16x32_bf16 v[212:215], a[148:151], v[120:123], v[212:215]
    s_waitcnt lgkmcnt(9)
    ds_read_b64_tr_b16 a[142:143], v245 offset:17248
    v_mfma_f32_16x16x32_bf16 v[200:203], a[152:155], v[56:59], v[200:203]
    ds_read_b64_tr_b16 a[144:145], v245 offset:17408
    v_mfma_f32_16x16x32_bf16 v[216:219], a[152:155], v[120:123], v[216:219]
    s_waitcnt lgkmcnt(9)
    ds_read_b64_tr_b16 a[146:147], v245 offset:17664
    v_mfma_f32_16x16x32_bf16 v[204:207], a[156:159], v[56:59], v[204:207]
    ds_read_b64_tr_b16 a[148:149], v245 offset:17440
    v_mfma_f32_16x16x32_bf16 v[220:223], a[156:159], v[120:123], v[220:223]
    s_waitcnt lgkmcnt(9)
    ds_read_b64_tr_b16 a[150:151], v245 offset:17696
    v_mfma_f32_16x16x32_bf16 v[128:131], a[128:131], v[0:3], 0
    ds_read_b64_tr_b16 a[152:153], v245 offset:17472
    v_mfma_f32_16x16x32_bf16 v[144:147], a[128:131], v[64:67], 0
    s_waitcnt lgkmcnt(9)
    ds_read_b64_tr_b16 a[154:155], v245 offset:17728
    v_mfma_f32_16x16x32_bf16 v[132:135], a[132:135], v[0:3], 0
    ds_read_b64_tr_b16 a[156:157], v245 offset:17504
    v_mfma_f32_16x16x32_bf16 v[148:151], a[132:135], v[64:67], 0
    s_waitcnt lgkmcnt(9)
    ds_read_b64_tr_b16 a[158:159], v245 offset:17760
    v_cvt_pk_bf16_f32 v192, v192, v193
    v_mfma_f32_16x16x32_bf16 v[136:139], a[136:139], v[0:3], 0
    ds_read_b64_tr_b16 a[128:129], v245 offset:25344
    v_cvt_pk_bf16_f32 v193, v194, v195
    v_mfma_f32_16x16x32_bf16 v[152:155], a[136:139], v[64:67], 0
    s_waitcnt lgkmcnt(9)
    ds_read_b64_tr_b16 a[130:131], v245 offset:25600
    v_cvt_pk_bf16_f32 v194, v196, v197
    v_mfma_f32_16x16x32_bf16 v[140:143], a[140:143], v[0:3], 0
    s_add_u32 s33, s31, 0
    ds_read_b64_tr_b16 a[132:133], v245 offset:25376
    v_cvt_pk_bf16_f32 v195, v198, v199
    v_mfma_f32_16x16x32_bf16 v[156:159], a[140:143], v[64:67], 0
    s_waitcnt lgkmcnt(9)
    ds_read_b64_tr_b16 a[134:135], v245 offset:25632
    buffer_store_dwordx4 v[192:195], v251, s[20:23], s33 offen sc1
    v_mfma_f32_16x16x32_bf16 v[128:131], a[144:147], v[8:11], v[128:131]
    ds_read_b64_tr_b16 a[136:137], v245 offset:25408
    v_cvt_pk_bf16_f32 v200, v200, v201
    v_mfma_f32_16x16x32_bf16 v[144:147], a[144:147], v[72:75], v[144:147]
    s_waitcnt lgkmcnt(9)
    ds_read_b64_tr_b16 a[138:139], v245 offset:25664
    v_cvt_pk_bf16_f32 v201, v202, v203
    v_mfma_f32_16x16x32_bf16 v[132:135], a[148:151], v[8:11], v[132:135]
    ds_read_b64_tr_b16 a[140:141], v245 offset:25440
    v_cvt_pk_bf16_f32 v202, v204, v205
    v_mfma_f32_16x16x32_bf16 v[148:151], a[148:151], v[72:75], v[148:151]
    s_waitcnt lgkmcnt(9)
    s_add_u32 s33, s31, 2048
    ds_read_b64_tr_b16 a[142:143], v245 offset:25696
    v_cvt_pk_bf16_f32 v203, v206, v207
    v_mfma_f32_16x16x32_bf16 v[136:139], a[152:155], v[8:11], v[136:139]
    ds_read_b64_tr_b16 a[144:145], v245 offset:25856
    buffer_store_dwordx4 v[200:203], v251, s[20:23], s33 offen sc1
    v_mfma_f32_16x16x32_bf16 v[152:155], a[152:155], v[72:75], v[152:155]
    s_waitcnt lgkmcnt(9)
    ds_read_b64_tr_b16 a[146:147], v245 offset:26112
    v_cvt_pk_bf16_f32 v208, v208, v209
    v_mfma_f32_16x16x32_bf16 v[140:143], a[156:159], v[8:11], v[140:143]
    ds_read_b64_tr_b16 a[148:149], v245 offset:25888
    v_cvt_pk_bf16_f32 v209, v210, v211
    v_mfma_f32_16x16x32_bf16 v[156:159], a[156:159], v[72:75], v[156:159]
    s_waitcnt lgkmcnt(9)
    ds_read_b64_tr_b16 a[150:151], v245 offset:26144
    v_cvt_pk_bf16_f32 v210, v212, v213
    v_mfma_f32_16x16x32_bf16 v[128:131], a[128:131], v[16:19], v[128:131]
    s_add_u32 s33, s31, 1024
    ds_read_b64_tr_b16 a[152:153], v245 offset:25920
    v_cvt_pk_bf16_f32 v211, v214, v215
    v_mfma_f32_16x16x32_bf16 v[144:147], a[128:131], v[80:83], v[144:147]
    s_waitcnt lgkmcnt(9)
    ds_read_b64_tr_b16 a[154:155], v245 offset:26176
    buffer_store_dwordx4 v[208:211], v251, s[20:23], s33 offen sc1
    v_mfma_f32_16x16x32_bf16 v[132:135], a[132:135], v[16:19], v[132:135]
    ds_read_b64_tr_b16 a[156:157], v245 offset:25952
    v_cvt_pk_bf16_f32 v216, v216, v217
    v_mfma_f32_16x16x32_bf16 v[148:151], a[132:135], v[80:83], v[148:151]
    s_waitcnt lgkmcnt(9)
    ds_read_b64_tr_b16 a[158:159], v245 offset:26208
    v_cvt_pk_bf16_f32 v217, v218, v219
    v_mfma_f32_16x16x32_bf16 v[136:139], a[136:139], v[16:19], v[136:139]
    ds_read_b64_tr_b16 a[128:129], v245 offset:33792
    v_cvt_pk_bf16_f32 v218, v220, v221
    v_mfma_f32_16x16x32_bf16 v[152:155], a[136:139], v[80:83], v[152:155]
    s_waitcnt lgkmcnt(9)
    s_add_u32 s33, s31, 3072
    ds_read_b64_tr_b16 a[130:131], v245 offset:34048
    v_cvt_pk_bf16_f32 v219, v222, v223
    v_mfma_f32_16x16x32_bf16 v[140:143], a[140:143], v[16:19], v[140:143]
    ds_read_b64_tr_b16 a[132:133], v245 offset:33824
    buffer_store_dwordx4 v[216:219], v251, s[20:23], s33 offen sc1
    v_mfma_f32_16x16x32_bf16 v[156:159], a[140:143], v[80:83], v[156:159]
    s_waitcnt lgkmcnt(9)
    ds_read_b64_tr_b16 a[134:135], v245 offset:34080
    v_mfma_f32_16x16x32_bf16 v[128:131], a[144:147], v[24:27], v[128:131]
    ds_read_b64_tr_b16 a[136:137], v245 offset:33856
    v_mfma_f32_16x16x32_bf16 v[144:147], a[144:147], v[88:91], v[144:147]
    s_waitcnt lgkmcnt(9)
    ds_read_b64_tr_b16 a[138:139], v245 offset:34112
    v_mfma_f32_16x16x32_bf16 v[132:135], a[148:151], v[24:27], v[132:135]
    ds_read_b64_tr_b16 a[140:141], v245 offset:33888
    v_mfma_f32_16x16x32_bf16 v[148:151], a[148:151], v[88:91], v[148:151]
    s_waitcnt lgkmcnt(9)
    ds_read_b64_tr_b16 a[142:143], v245 offset:34144
    v_mfma_f32_16x16x32_bf16 v[136:139], a[152:155], v[24:27], v[136:139]
    ds_read_b64_tr_b16 a[144:145], v245 offset:34304
    v_mfma_f32_16x16x32_bf16 v[152:155], a[152:155], v[88:91], v[152:155]
    s_waitcnt lgkmcnt(9)
    ds_read_b64_tr_b16 a[146:147], v245 offset:34560
    v_mfma_f32_16x16x32_bf16 v[140:143], a[156:159], v[24:27], v[140:143]
    ds_read_b64_tr_b16 a[148:149], v245 offset:34336
    v_mfma_f32_16x16x32_bf16 v[156:159], a[156:159], v[88:91], v[156:159]
    s_waitcnt lgkmcnt(9)
    ds_read_b64_tr_b16 a[150:151], v245 offset:34592
    v_mfma_f32_16x16x32_bf16 v[128:131], a[128:131], v[32:35], v[128:131]
    ds_read_b64_tr_b16 a[152:153], v245 offset:34368
    v_mfma_f32_16x16x32_bf16 v[144:147], a[128:131], v[96:99], v[144:147]
    s_waitcnt lgkmcnt(9)
    ds_read_b64_tr_b16 a[154:155], v245 offset:34624
    v_mfma_f32_16x16x32_bf16 v[132:135], a[132:135], v[32:35], v[132:135]
    ds_read_b64_tr_b16 a[156:157], v245 offset:34400
    v_mfma_f32_16x16x32_bf16 v[148:151], a[132:135], v[96:99], v[148:151]
    s_waitcnt lgkmcnt(9)
    ds_read_b64_tr_b16 a[158:159], v245 offset:34656
    v_mfma_f32_16x16x32_bf16 v[136:139], a[136:139], v[32:35], v[136:139]
    ds_read_b64_tr_b16 a[128:129], v245 offset:42240
    v_mfma_f32_16x16x32_bf16 v[152:155], a[136:139], v[96:99], v[152:155]
    s_waitcnt lgkmcnt(9)
    ds_read_b64_tr_b16 a[130:131], v245 offset:42496
    v_mfma_f32_16x16x32_bf16 v[140:143], a[140:143], v[32:35], v[140:143]
    ds_read_b64_tr_b16 a[132:133], v245 offset:42272
    v_mfma_f32_16x16x32_bf16 v[156:159], a[140:143], v[96:99], v[156:159]
    s_waitcnt lgkmcnt(9)
    ds_read_b64_tr_b16 a[134:135], v245 offset:42528
    v_mfma_f32_16x16x32_bf16 v[128:131], a[144:147], v[40:43], v[128:131]
    ds_read_b64_tr_b16 a[136:137], v245 offset:42304
    v_mfma_f32_16x16x32_bf16 v[144:147], a[144:147], v[104:107], v[144:147]
    s_waitcnt lgkmcnt(9)
    ds_read_b64_tr_b16 a[138:139], v245 offset:42560
    v_mfma_f32_16x16x32_bf16 v[132:135], a[148:151], v[40:43], v[132:135]
    ds_read_b64_tr_b16 a[140:141], v245 offset:42336
    v_mfma_f32_16x16x32_bf16 v[148:151], a[148:151], v[104:107], v[148:151]
    s_waitcnt lgkmcnt(9)
    ds_read_b64_tr_b16 a[142:143], v245 offset:42592
    v_mfma_f32_16x16x32_bf16 v[136:139], a[152:155], v[40:43], v[136:139]
    ds_read_b64_tr_b16 a[144:145], v245 offset:42752
    v_mfma_f32_16x16x32_bf16 v[152:155], a[152:155], v[104:107], v[152:155]
    s_waitcnt lgkmcnt(9)
    ds_read_b64_tr_b16 a[146:147], v245 offset:43008
    v_mfma_f32_16x16x32_bf16 v[140:143], a[156:159], v[40:43], v[140:143]
    ds_read_b64_tr_b16 a[148:149], v245 offset:42784
    v_mfma_f32_16x16x32_bf16 v[156:159], a[156:159], v[104:107], v[156:159]
    s_waitcnt lgkmcnt(9)
    s_or_b64 s[36:37], s[36:37], s[38:39]
    s_or_b64 s[40:41], s[40:41], s[42:43]
    ds_read_b64_tr_b16 a[150:151], v245 offset:43040
    v_mfma_f32_16x16x32_bf16 v[128:131], a[128:131], v[48:51], v[128:131]
    s_or_b64 s[36:37], s[36:37], s[40:41]
    s_cselect_b32 s36, 1, 0
    ds_read_b64_tr_b16 a[152:153], v245 offset:42816
    v_mov_b32 v224, s36
    v_mov_b32 v225, s24
    v_mfma_f32_16x16x32_bf16 v[144:147], a[128:131], v[112:115], v[144:147]
    s_waitcnt lgkmcnt(9)
    ds_read_b64_tr_b16 a[154:155], v245 offset:43072
    v_lshlrev_b32 v225, 2, v225
    v_add_u32 v225, 159744, v225
    v_mfma_f32_16x16x32_bf16 v[132:135], a[132:135], v[48:51], v[132:135]
    ds_read_b64_tr_b16 a[156:157], v245 offset:42848
    ds_write_b32 v225, v224
    v_mov_b32 v226, 159744
    v_mfma_f32_16x16x32_bf16 v[148:151], a[132:135], v[112:115], v[148:151]
    s_waitcnt vmcnt(16) lgkmcnt(0)
    s_barrier
    ds_read_b64_tr_b16 a[158:159], v245 offset:43104
    v_mfma_f32_16x16x32_bf16 v[136:139], a[136:139], v[48:51], v[136:139]
    ds_read_b64_tr_b16 a[128:129], v245 offset:50688
    v_mfma_f32_16x16x32_bf16 v[152:155], a[136:139], v[112:115], v[152:155]
    ds_read_b64_tr_b16 a[130:131], v245 offset:50944
    v_mfma_f32_16x16x32_bf16 v[140:143], a[140:143], v[48:51], v[140:143]
    ds_read_b64_tr_b16 a[132:133], v245 offset:50720
    ds_read_b128 v[228:231], v226
    v_mfma_f32_16x16x32_bf16 v[156:159], a[140:143], v[112:115], v[156:159]
    ds_read_b64_tr_b16 a[134:135], v245 offset:50976
    v_mfma_f32_16x16x32_bf16 v[128:131], a[144:147], v[56:59], v[128:131]
    ds_read_b64_tr_b16 a[136:137], v245 offset:50752
    v_mfma_f32_16x16x32_bf16 v[144:147], a[144:147], v[120:123], v[144:147]
    ds_read_b64_tr_b16 a[138:139], v245 offset:51008
    v_mfma_f32_16x16x32_bf16 v[132:135], a[148:151], v[56:59], v[132:135]
    ds_read_b64_tr_b16 a[140:141], v245 offset:50784
    v_mfma_f32_16x16x32_bf16 v[148:151], a[148:151], v[120:123], v[148:151]
    ds_read_b64_tr_b16 a[142:143], v245 offset:51040
    v_mfma_f32_16x16x32_bf16 v[136:139], a[152:155], v[56:59], v[136:139]
    s_waitcnt lgkmcnt(5)
    ds_read_b64_tr_b16 a[144:145], v245 offset:51200
    v_or3_b32 v228, v228, v229, v230
    v_or_b32 v228, v228, v231
    v_mfma_f32_16x16x32_bf16 v[152:155], a[152:155], v[120:123], v[152:155]
    ds_read_b64_tr_b16 a[146:147], v245 offset:51456
    v_readfirstlane_b32 s36, v228
    v_mfma_f32_16x16x32_bf16 v[140:143], a[156:159], v[56:59], v[140:143]
    ds_read_b64_tr_b16 a[148:149], v245 offset:51232
    v_mfma_f32_16x16x32_bf16 v[156:159], a[156:159], v[120:123], v[156:159]
    ds_read_b64_tr_b16 a[150:151], v245 offset:51488
    s_andn2_b32 s36, s36, s35
    s_cbranch_scc1 k1_safe
    v_mfma_f32_16x16x32_bf16 v[192:195], a[128:131], v[0:3], 0
    s_mov_b32 s32, 115200
    ds_read_b64_tr_b16 a[152:153], v245 offset:51264
    v_mfma_f32_16x16x32_bf16 v[208:211], a[128:131], v[64:67], 0
    s_waitcnt lgkmcnt(9)
    s_add_u32 m0, s25, 135168
    ds_read_b64_tr_b16 a[154:155], v245 offset:51520
    v_mfma_f32_16x16x32_bf16 v[196:199], a[132:135], v[0:3], 0
    ds_read_b64_tr_b16 a[156:157], v245 offset:51296
    buffer_load_dwordx4 v255, s[16:19], s32 offen offset:0  lds
    v_mfma_f32_16x16x32_bf16 v[212:215], a[132:135], v[64:67], 0
    s_waitcnt lgkmcnt(9)
    ds_read_b64_tr_b16 a[158:159], v245 offset:51552
    v_mfma_f32_16x16x32_bf16 v[200:203], a[136:139], v[0:3], 0
    s_add_u32 m0, s25, 135328
    ds_read_b64_tr_b16 a[128:129], v245 offset:59136
    v_mfma_f32_16x16x32_bf16 v[216:219], a[136:139], v[64:67], 0
    s_waitcnt lgkmcnt(9)
    ds_read_b64_tr_b16 a[130:131], v245 offset:59392
    buffer_load_dwordx4 v255, s[16:19], s32 offen offset:896  lds
    v_mfma_f32_16x16x32_bf16 v[204:207], a[140:143], v[0:3], 0
    ds_read_b64_tr_b16 a[132:133], v245 offset:59168
    v_mfma_f32_16x16x32_bf16 v[220:223], a[140:143], v[64:67], 0
    s_waitcnt lgkmcnt(9)
    s_add_u32 m0, s25, 135488
    ds_read_b64_tr_b16 a[134:135], v245 offset:59424
    v_mfma_f32_16x16x32_bf16 v[192:195], a[144:147], v[8:11], v[192:195]
    ds_read_b64_tr_b16 a[136:137], v245 offset:59200
    buffer_load_dwordx4 v255, s[16:19], s32 offen offset:1792  lds
    v_cvt_pk_bf16_f32 v128, v128, v129
    v_mfma_f32_16x16x32_bf16 v[208:211], a[144:147], v[72:75], v[208:211]
    s_waitcnt lgkmcnt(9)
    ds_read_b64_tr_b16 a[138:139], v245 offset:59456
    v_cvt_pk_bf16_f32 v129, v130, v131
    v_mfma_f32_16x16x32_bf16 v[196:199], a[148:151], v[8:11], v[196:199]
    s_add_u32 m0, s25, 135648
    ds_read_b64_tr_b16 a[140:141], v245 offset:59232
    v_cvt_pk_bf16_f32 v130, v132, v133
    v_mfma_f32_16x16x32_bf16 v[212:215], a[148:151], v[72:75], v[212:215]
    s_waitcnt lgkmcnt(9)
    s_add_u32 s33, s31, 4096
    ds_read_b64_tr_b16 a[142:143], v245 offset:59488
    buffer_load_dwordx4 v255, s[16:19], s32 offen offset:2688  lds
    v_cvt_pk_bf16_f32 v131, v134, v135
    v_mfma_f32_16x16x32_bf16 v[200:203], a[152:155], v[8:11], v[200:203]
    s_mov_b32 s32, 640
    ds_read_b64_tr_b16 a[144:145], v245 offset:59648
    buffer_store_dwordx4 v[128:131], v251, s[20:23], s33 offen sc1
    v_mfma_f32_16x16x32_bf16 v[216:219], a[152:155], v[72:75], v[216:219]
    s_waitcnt lgkmcnt(9)
    s_add_u32 m0, s25, 67584
    ds_read_b64_tr_b16 a[146:147], v245 offset:59904
    v_mfma_f32_16x16x32_bf16 v[204:207], a[156:159], v[8:11], v[204:207]
    ds_read_b64_tr_b16 a[148:149], v245 offset:59680
    buffer_load_dwordx4 v255, s[16:19], s32 offen offset:0  lds
    v_mfma_f32_16x16x32_bf16 v[220:223], a[156:159], v[72:75], v[220:223]
    s_waitcnt lgkmcnt(9)
    ds_read_b64_tr_b16 a[150:151], v245 offset:59936
    v_mfma_f32_16x16x32_bf16 v[192:195], a[128:131], v[16:19], v[192:195]
    s_add_u32 m0, s25, 67744
    ds_read_b64_tr_b16 a[152:153], v245 offset:59712
    v_mfma_f32_16x16x32_bf16 v[208:211], a[128:131], v[80:83], v[208:211]
    s_waitcnt lgkmcnt(9)
    ds_read_b64_tr_b16 a[154:155], v245 offset:59968
    buffer_load_dwordx4 v255, s[16:19], s32 offen offset:896  lds
    v_mfma_f32_16x16x32_bf16 v[196:199], a[132:135], v[16:19], v[196:199]
    ds_read_b64_tr_b16 a[156:157], v245 offset:59744
    v_cvt_pk_bf16_f32 v136, v136, v137
    v_mfma_f32_16x16x32_bf16 v[212:215], a[132:135], v[80:83], v[212:215]
    s_waitcnt lgkmcnt(9)
    s_add_u32 m0, s25, 67904
    ds_read_b64_tr_b16 a[158:159], v245 offset:60000
    v_cvt_pk_bf16_f32 v137, v138, v139
    v_mfma_f32_16x16x32_bf16 v[200:203], a[136:139], v[16:19], v[200:203]
    ds_read_b64_tr_b16 a[128:129], v252 offset:0
    buffer_load_dwordx4 v255, s[16:19], s32 offen offset:1792  lds
    v_cvt_pk_bf16_f32 v138, v140, v141
    v_mfma_f32_16x16x32_bf16 v[216:219], a[136:139], v[80:83], v[216:219]
    s_waitcnt lgkmcnt(9)
    s_add_u32 s33, s31, 6144
    ds_read_b64_tr_b16 a[130:131], v252 offset:256
    v_cvt_pk_bf16_f32 v139, v142, v143
    v_mfma_f32_16x16x32_bf16 v[204:207], a[140:143], v[16:19], v[204:207]
    s_add_u32 m0, s25, 68064
    ds_read_b64_tr_b16 a[132:133], v252 offset:32
    buffer_store_dwordx4 v[136:139], v251, s[20:23], s33 offen sc1
    v_mfma_f32_16x16x32_bf16 v[220:223], a[140:143], v[80:83], v[220:223]
    s_waitcnt lgkmcnt(9)
    ds_read_b64_tr_b16 a[134:135], v252 offset:288
    buffer_load_dwordx4 v255, s[16:19], s32 offen offset:2688  lds
    v_mfma_f32_16x16x32_bf16 v[192:195], a[144:147], v[24:27], v[192:195]
    s_mov_b32 s32, 115328
    ds_read_b64_tr_b16 a[136:137], v252 offset:64
    v_mfma_f32_16x16x32_bf16 v[208:211], a[144:147], v[88:91], v[208:211]
    s_waitcnt lgkmcnt(9)
    s_add_u32 m0, s25, 84480
    ds_read_b64_tr_b16 a[138:139], v252 offset:320
    v_mfma_f32_16x16x32_bf16 v[196:199], a[148:151], v[24:27], v[196:199]
    ds_read_b64_tr_b16 a[140:141], v252 offset:96
    buffer_load_dwordx4 v255, s[16:19], s32 offen offset:0  lds
    v_mfma_f32_16x16x32_bf16 v[212:215], a[148:151], v[88:91], v[212:215]
    s_waitcnt lgkmcnt(9)
    ds_read_b64_tr_b16 a[142:143], v252 offset:352
    v_mfma_f32_16x16x32_bf16 v[200:203], a[152:155], v[24:27], v[200:203]
    s_add_u32 m0, s25, 84640
    ds_read_b64_tr_b16 a[144:145], v252 offset:512
    v_cvt_pk_bf16_f32 v144, v144, v145
    v_mfma_f32_16x16x32_bf16 v[216:219], a[152:155], v[88:91], v[216:219]
    s_waitcnt lgkmcnt(9)
    ds_read_b64_tr_b16 a[146:147], v252 offset:768
    buffer_load_dwordx4 v255, s[16:19], s32 offen offset:896  lds
    v_cvt_pk_bf16_f32 v145, v146, v147
    v_mfma_f32_16x16x32_bf16 v[204:207], a[156:159], v[24:27], v[204:207]
    ds_read_b64_tr_b16 a[148:149], v252 offset:544
    v_cvt_pk_bf16_f32 v146, v148, v149
    v_mfma_f32_16x16x32_bf16 v[220:223], a[156:159], v[88:91], v[220:223]
    s_waitcnt lgkmcnt(9)
    s_add_u32 m0, s25, 84800
    s_add_u32 s33, s31, 5120
    ds_read_b64_tr_b16 a[150:151], v252 offset:800
    v_cvt_pk_bf16_f32 v147, v150, v151
    v_mfma_f32_16x16x32_bf16 v[192:195], a[128:131], v[32:35], v[192:195]
    ds_read_b64_tr_b16 a[152:153], v252 offset:576
    buffer_load_dwordx4 v255, s[16:19], s32 offen offset:1792  lds
    buffer_store_dwordx4 v[144:147], v251, s[20:23], s33 offen sc1
    v_mfma_f32_16x16x32_bf16 v[208:211], a[128:131], v[96:99], v[208:211]
    s_waitcnt lgkmcnt(9)
    ds_read_b64_tr_b16 a[154:155], v252 offset:832
    v_mfma_f32_16x16x32_bf16 v[196:199], a[132:135], v[32:35], v[196:199]
    s_add_u32 m0, s25, 84960
    ds_read_b64_tr_b16 a[156:157], v252 offset:608
    v_mfma_f32_16x16x32_bf16 v[212:215], a[132:135], v[96:99], v[212:215]
    s_waitcnt lgkmcnt(9)
    ds_read_b64_tr_b16 a[158:159], v252 offset:864
    buffer_load_dwordx4 v255, s[16:19], s32 offen offset:2688  lds
    v_mfma_f32_16x16x32_bf16 v[200:203], a[136:139], v[32:35], v[200:203]
    ds_read_b64_tr_b16 a[128:129], v252 offset:8448
    v_mfma_f32_16x16x32_bf16 v[216:219], a[136:139], v[96:99], v[216:219]
    s_waitcnt lgkmcnt(9)
    ds_read_b64_tr_b16 a[130:131], v252 offset:8704
    v_mfma_f32_16x16x32_bf16 v[204:207], a[140:143], v[32:35], v[204:207]
    ds_read_b64_tr_b16 a[132:133], v252 offset:8480
    v_cvt_pk_bf16_f32 v152, v152, v153
    v_mfma_f32_16x16x32_bf16 v[220:223], a[140:143], v[96:99], v[220:223]
    s_waitcnt lgkmcnt(9)
    ds_read_b64_tr_b16 a[134:135], v252 offset:8736
    v_cvt_pk_bf16_f32 v153, v154, v155
    v_mfma_f32_16x16x32_bf16 v[192:195], a[144:147], v[40:43], v[192:195]
    ds_read_b64_tr_b16 a[136:137], v252 offset:8512
    v_cvt_pk_bf16_f32 v154, v156, v157
    v_mfma_f32_16x16x32_bf16 v[208:211], a[144:147], v[104:107], v[208:211]
    s_waitcnt lgkmcnt(9)
    s_add_u32 s33, s31, 7168
    ds_read_b64_tr_b16 a[138:139], v252 offset:8768
    v_cvt_pk_bf16_f32 v155, v158, v159
    v_mfma_f32_16x16x32_bf16 v[196:199], a[148:151], v[40:43], v[196:199]
    ds_read_b64_tr_b16 a[140:141], v252 offset:8544
    buffer_store_dwordx4 v[152:155], v251, s[20:23], s33 offen sc1
    v_mfma_f32_16x16x32_bf16 v[212:215], a[148:151], v[104:107], v[212:215]
    s_waitcnt lgkmcnt(9)
    ds_read_b64_tr_b16 a[142:143], v252 offset:8800
    v_mfma_f32_16x16x32_bf16 v[200:203], a[152:155], v[40:43], v[200:203]
    ds_read_b64_tr_b16 a[144:145], v252 offset:8960
    v_mfma_f32_16x16x32_bf16 v[216:219], a[152:155], v[104:107], v[216:219]
    s_waitcnt lgkmcnt(9)
    ds_read_b64_tr_b16 a[146:147], v252 offset:9216
    v_mfma_f32_16x16x32_bf16 v[204:207], a[156:159], v[40:43], v[204:207]
    ds_read_b64_tr_b16 a[148:149], v252 offset:8992
    v_mfma_f32_16x16x32_bf16 v[220:223], a[156:159], v[104:107], v[220:223]
    s_waitcnt lgkmcnt(9)
    ds_read_b64_tr_b16 a[150:151], v252 offset:9248
    v_mfma_f32_16x16x32_bf16 v[192:195], a[128:131], v[48:51], v[192:195]
    ds_read_b64_tr_b16 a[152:153], v252 offset:9024
    v_mfma_f32_16x16x32_bf16 v[208:211], a[128:131], v[112:115], v[208:211]
    s_waitcnt lgkmcnt(9)
    ds_read_b64_tr_b16 a[154:155], v252 offset:9280
    v_mfma_f32_16x16x32_bf16 v[196:199], a[132:135], v[48:51], v[196:199]
    ds_read_b64_tr_b16 a[156:157], v252 offset:9056
    v_mfma_f32_16x16x32_bf16 v[212:215], a[132:135], v[112:115], v[212:215]
    s_waitcnt vmcnt(24) lgkmcnt(9)
    s_barrier
    ds_read_b64_tr_b16 a[158:159], v252 offset:9312
    v_mfma_f32_16x16x32_bf16 v[200:203], a[136:139], v[48:51], v[200:203]
    ds_read_b64_tr_b16 a[128:129], v252 offset:16896
    v_mfma_f32_16x16x32_bf16 v[216:219], a[136:139], v[112:115], v[216:219]
    s_waitcnt lgkmcnt(9)
    ds_read_b64_tr_b16 a[130:131], v252 offset:17152
    v_mfma_f32_16x16x32_bf16 v[204:207], a[140:143], v[48:51], v[204:207]
    ds_read_b64_tr_b16 a[132:133], v252 offset:16928
    v_mfma_f32_16x16x32_bf16 v[220:223], a[140:143], v[112:115], v[220:223]
    s_waitcnt lgkmcnt(9)
    ds_read_b64_tr_b16 a[134:135], v252 offset:17184
    v_mfma_f32_16x16x32_bf16 v[192:195], a[144:147], v[56:59], v[192:195]
    ds_read_b64_tr_b16 a[136:137], v252 offset:16960
    v_mfma_f32_16x16x32_bf16 v[208:211], a[144:147], v[120:123], v[208:211]
    s_waitcnt lgkmcnt(9)
    ds_read_b64_tr_b16 a[138:139], v252 offset:17216
    v_mfma_f32_16x16x32_bf16 v[196:199], a[148:151], v[56:59], v[196:199]
    ds_read_b64_tr_b16 a[140:141], v252 offset:16992
    v_mfma_f32_16x16x32_bf16 v[212:215], a[148:151], v[120:123], v[212:215]
    s_waitcnt lgkmcnt(9)
    ds_read_b64_tr_b16 a[142:143], v252 offset:17248
    v_mfma_f32_16x16x32_bf16 v[200:203], a[152:155], v[56:59], v[200:203]
    ds_read_b64_tr_b16 a[144:145], v252 offset:17408
    v_mfma_f32_16x16x32_bf16 v[216:219], a[152:155], v[120:123], v[216:219]
    s_waitcnt lgkmcnt(9)
    ds_read_b64_tr_b16 a[146:147], v252 offset:17664
    v_mfma_f32_16x16x32_bf16 v[204:207], a[156:159], v[56:59], v[204:207]
    ds_read_b64_tr_b16 a[148:149], v252 offset:17440
    v_mfma_f32_16x16x32_bf16 v[220:223], a[156:159], v[120:123], v[220:223]
    s_waitcnt lgkmcnt(9)
    ds_read_b64_tr_b16 a[150:151], v252 offset:17696
    v_mfma_f32_16x16x32_bf16 v[128:131], a[128:131], v[0:3], 0
    s_mov_b32 s32, 768
    ds_read_b64_tr_b16 a[152:153], v252 offset:17472
    v_mfma_f32_16x16x32_bf16 v[144:147], a[128:131], v[64:67], 0
    s_waitcnt lgkmcnt(9)
    s_add_u32 m0, s25, 101376
    ds_read_b64_tr_b16 a[154:155], v252 offset:17728
    v_mfma_f32_16x16x32_bf16 v[132:135], a[132:135], v[0:3], 0
    ds_read_b64_tr_b16 a[156:157], v252 offset:17504
    buffer_load_dwordx4 v255, s[16:19], s32 offen offset:0  lds
    v_mfma_f32_16x16x32_bf16 v[148:151], a[132:135], v[64:67], 0
    s_waitcnt lgkmcnt(9)
    ds_read_b64_tr_b16 a[158:159], v252 offset:17760
    v_mfma_f32_16x16x32_bf16 v[136:139], a[136:139], v[0:3], 0
    s_add_u32 m0, s25, 101536
    ds_read_b64_tr_b16 a[128:129], v252 offset:25344
    v_mfma_f32_16x16x32_bf16 v[152:155], a[136:139], v[64:67], 0
    s_waitcnt lgkmcnt(9)
    ds_read_b64_tr_b16 a[130:131], v252 offset:25600
    buffer_load_dwordx4 v255, s[16:19], s32 offen offset:896  lds
    v_mfma_f32_16x16x32_bf16 v[140:143], a[140:143], v[0:3], 0
    ds_read_b64_tr_b16 a[132:133], v252 offset:25376
    v_mfma_f32_16x16x32_bf16 v[156:159], a[140:143], v[64:67], 0
    s_waitcnt lgkmcnt(9)
    s_add_u32 m0, s25, 101696
    ds_read_b64_tr_b16 a[134:135], v252 offset:25632
    v_mfma_f32_16x16x32_bf16 v[128:131], a[144:147], v[8:11], v[128:131]
    ds_read_b64_tr_b16 a[136:137], v252 offset:25408
    buffer_load_dwordx4 v255, s[16:19], s32 offen offset:1792  lds
    v_cvt_pk_bf16_f32 v192, v192, v193
    v_mfma_f32_16x16x32_bf16 v[144:147], a[144:147], v[72:75], v[144:147]
    s_waitcnt lgkmcnt(9)
    ds_read_b64_tr_b16 a[138:139], v252 offset:25664
    v_cvt_pk_bf16_f32 v193, v194, v195
    v_mfma_f32_16x16x32_bf16 v[132:135], a[148:151], v[8:11], v[132:135]
    s_add_u32 m0, s25, 101856
    ds_read_b64_tr_b16 a[140:141], v252 offset:25440
    v_cvt_pk_bf16_f32 v194, v196, v197
    v_mfma_f32_16x16x32_bf16 v[148:151], a[148:151], v[72:75], v[148:151]
    s_waitcnt lgkmcnt(9)
    s_add_u32 s33, s31, 8192
    ds_read_b64_tr_b16 a[142:143], v252 offset:25696
    buffer_load_dwordx4 v255, s[16:19], s32 offen offset:2688  lds
    v_cvt_pk_bf16_f32 v195, v198, v199
    v_mfma_f32_16x16x32_bf16 v[136:139], a[152:155], v[8:11], v[136:139]
    s_mov_b32 s32, 115456
    ds_read_b64_tr_b16 a[144:145], v252 offset:25856
    buffer_store_dwordx4 v[192:195], v251, s[20:23], s33 offen sc1
    v_mfma_f32_16x16x32_bf16 v[152:155], a[152:155], v[72:75], v[152:155]
    s_waitcnt lgkmcnt(9)
    s_add_u32 m0, s25, 118272
    ds_read_b64_tr_b16 a[146:147], v252 offset:26112
    v_mfma_f32_16x16x32_bf16 v[140:143], a[156:159], v[8:11], v[140:143]
    ds_read_b64_tr_b16 a[148:149], v252 offset:25888
    buffer_load_dwordx4 v255, s[16:19], s32 offen offset:0  lds
    v_mfma_f32_16x16x32_bf16 v[156:159], a[156:159], v[72:75], v[156:159]
    s_waitcnt lgkmcnt(9)
    ds_read_b64_tr_b16 a[150:151], v252 offset:26144
    v_mfma_f32_16x16x32_bf16 v[128:131], a[128:131], v[16:19], v[128:131]
    s_add_u32 m0, s25, 118432
    ds_read_b64_tr_b16 a[152:153], v252 offset:25920
    v_mfma_f32_16x16x32_bf16 v[144:147], a[128:131], v[80:83], v[144:147]
    s_waitcnt lgkmcnt(9)
    ds_read_b64_tr_b16 a[154:155], v252 offset:26176
    buffer_load_dwordx4 v255, s[16:19], s32 offen offset:896  lds
    v_mfma_f32_16x16x32_bf16 v[132:135], a[132:135], v[16:19], v[132:135]
    ds_read_b64_tr_b16 a[156:157], v252 offset:25952
    v_cvt_pk_bf16_f32 v200, v200, v201
    v_mfma_f32_16x16x32_bf16 v[148:151], a[132:135], v[80:83], v[148:151]
    s_waitcnt lgkmcnt(9)
    s_add_u32 m0, s25, 118592
    ds_read_b64_tr_b16 a[158:159], v252 offset:26208
    v_cvt_pk_bf16_f32 v201, v202, v203
    v_mfma_f32_16x16x32_bf16 v[136:139], a[136:139], v[16:19], v[136:139]
    ds_read_b64_tr_b16 a[128:129], v252 offset:50688
    buffer_load_dwordx4 v255, s[16:19], s32 offen offset:1792  lds
    v_cvt_pk_bf16_f32 v202, v204, v205
    v_mfma_f32_16x16x32_bf16 v[152:155], a[136:139], v[80:83], v[152:155]
    s_waitcnt lgkmcnt(9)
    s_add_u32 s33, s31, 10240
    ds_read_b64_tr_b16 a[130:131], v252 offset:50944
    v_cvt_pk_bf16_f32 v203, v206, v207
    v_mfma_f32_16x16x32_bf16 v[140:143], a[140:143], v[16:19], v[140:143]
    s_add_u32 m0, s25, 118752
    ds_read_b64_tr_b16 a[132:133], v252 offset:50720
    buffer_store_dwordx4 v[200:203], v251, s[20:23], s33 offen sc1
    v_mfma_f32_16x16x32_bf16 v[156:159], a[140:143], v[80:83], v[156:159]
    s_waitcnt lgkmcnt(9)
    ds_read_b64_tr_b16 a[134:135], v252 offset:50976
    buffer_load_dwordx4 v255, s[16:19], s32 offen offset:2688  lds
    v_mfma_f32_16x16x32_bf16 v[128:131], a[144:147], v[24:27], v[128:131]
    ds_read_b64_tr_b16 a[136:137], v252 offset:50752
    v_mfma_f32_16x16x32_bf16 v[144:147], a[144:147], v[88:91], v[144:147]
    s_waitcnt lgkmcnt(9)
    ds_read_b64_tr_b16 a[138:139], v252 offset:51008
    v_mfma_f32_16x16x32_bf16 v[132:135], a[148:151], v[24:27], v[132:135]
    ds_read_b64_tr_b16 a[140:141], v252 offset:50784
    v_mfma_f32_16x16x32_bf16 v[148:151], a[148:151], v[88:91], v[148:151]
    s_waitcnt lgkmcnt(9)
    ds_read_b64_tr_b16 a[142:143], v252 offset:51040
    v_mfma_f32_16x16x32_bf16 v[136:139], a[152:155], v[24:27], v[136:139]
    ds_read_b64_tr_b16 a[144:145], v252 offset:51200
    v_cvt_pk_bf16_f32 v208, v208, v209
    v_mfma_f32_16x16x32_bf16 v[152:155], a[152:155], v[88:91], v[152:155]
    s_waitcnt lgkmcnt(9)
    ds_read_b64_tr_b16 a[146:147], v252 offset:51456
    v_cvt_pk_bf16_f32 v209, v210, v211
    v_mfma_f32_16x16x32_bf16 v[140:143], a[156:159], v[24:27], v[140:143]
    ds_read_b64_tr_b16 a[148:149], v252 offset:51232
    v_cvt_pk_bf16_f32 v210, v212, v213
    v_mfma_f32_16x16x32_bf16 v[156:159], a[156:159], v[88:91], v[156:159]
    s_waitcnt lgkmcnt(9)
    s_add_u32 s33, s31, 9216
    ds_read_b64_tr_b16 a[150:151], v252 offset:51488
    v_cvt_pk_bf16_f32 v211, v214, v215
    v_mfma_f32_16x16x32_bf16 v[128:131], a[128:131], v[32:35], v[128:131]
    ds_read_b64_tr_b16 a[152:153], v252 offset:51264
    buffer_store_dwordx4 v[208:211], v251, s[20:23], s33 offen sc1
    v_mfma_f32_16x16x32_bf16 v[144:147], a[128:131], v[96:99], v[144:147]
    s_waitcnt lgkmcnt(9)
    ds_read_b64_tr_b16 a[154:155], v252 offset:51520
    v_mfma_f32_16x16x32_bf16 v[132:135], a[132:135], v[32:35], v[132:135]
    ds_read_b64_tr_b16 a[156:157], v252 offset:51296
    v_mfma_f32_16x16x32_bf16 v[148:151], a[132:135], v[96:99], v[148:151]
    s_waitcnt lgkmcnt(9)
    ds_read_b64_tr_b16 a[158:159], v252 offset:51552
    v_mfma_f32_16x16x32_bf16 v[136:139], a[136:139], v[32:35], v[136:139]
    ds_read_b64_tr_b16 a[128:129], v252 offset:59136
    v_mfma_f32_16x16x32_bf16 v[152:155], a[136:139], v[96:99], v[152:155]
    s_waitcnt lgkmcnt(9)
    ds_read_b64_tr_b16 a[130:131], v252 offset:59392
    v_mfma_f32_16x16x32_bf16 v[140:143], a[140:143], v[32:35], v[140:143]
    ds_read_b64_tr_b16 a[132:133], v252 offset:59168
    v_cvt_pk_bf16_f32 v216, v216, v217
    v_mfma_f32_16x16x32_bf16 v[156:159], a[140:143], v[96:99], v[156:159]
    s_waitcnt lgkmcnt(9)
    ds_read_b64_tr_b16 a[134:135], v252 offset:59424
    v_cvt_pk_bf16_f32 v217, v218, v219
    v_mfma_f32_16x16x32_bf16 v[128:131], a[144:147], v[40:43], v[128:131]
    ds_read_b64_tr_b16 a[136:137], v252 offset:59200
    v_cvt_pk_bf16_f32 v218, v220, v221
    v_mfma_f32_16x16x32_bf16 v[144:147], a[144:147], v[104:107], v[144:147]
    s_waitcnt lgkmcnt(9)
    s_add_u32 s33, s31, 11264
    ds_read_b64_tr_b16 a[138:139], v252 offset:59456
    v_cvt_pk_bf16_f32 v219, v222, v223
    v_mfma_f32_16x16x32_bf16 v[132:135], a[148:151], v[40:43], v[132:135]
    ds_read_b64_tr_b16 a[140:141], v252 offset:59232
    buffer_store_dwordx4 v[216:219], v251, s[20:23], s33 offen sc1
    v_mfma_f32_16x16x32_bf16 v[148:151], a[148:151], v[104:107], v[148:151]
    s_waitcnt lgkmcnt(9)
    ds_read_b64_tr_b16 a[142:143], v252 offset:59488
    v_mfma_f32_16x16x32_bf16 v[136:139], a[152:155], v[40:43], v[136:139]
    ds_read_b64_tr_b16 a[144:145], v252 offset:59648
    v_mfma_f32_16x16x32_bf16 v[152:155], a[152:155], v[104:107], v[152:155]
    s_waitcnt lgkmcnt(9)
    ds_read_b64_tr_b16 a[146:147], v252 offset:59904
    v_mfma_f32_16x16x32_bf16 v[140:143], a[156:159], v[40:43], v[140:143]
    ds_read_b64_tr_b16 a[148:149], v252 offset:59680
    v_mfma_f32_16x16x32_bf16 v[156:159], a[156:159], v[104:107], v[156:159]
    s_waitcnt lgkmcnt(9)
    ds_read_b64_tr_b16 a[150:151], v252 offset:59936
    v_mfma_f32_16x16x32_bf16 v[128:131], a[128:131], v[48:51], v[128:131]
    ds_read_b64_tr_b16 a[152:153], v252 offset:59712
    v_mfma_f32_16x16x32_bf16 v[144:147], a[128:131], v[112:115], v[144:147]
    s_waitcnt lgkmcnt(9)
    ds_read_b64_tr_b16 a[154:155], v252 offset:59968
    v_mfma_f32_16x16x32_bf16 v[132:135], a[132:135], v[48:51], v[132:135]
    ds_read_b64_tr_b16 a[156:157], v252 offset:59744
    v_mfma_f32_16x16x32_bf16 v[148:151], a[132:135], v[112:115], v[148:151]
    s_waitcnt vmcnt(24) lgkmcnt(9)
    s_barrier
    ds_read_b64_tr_b16 a[158:159], v252 offset:60000
    v_mfma_f32_16x16x32_bf16 v[136:139], a[136:139], v[48:51], v[136:139]
    ds_read_b64_tr_b16 a[128:129], v252 offset:33792
    v_mfma_f32_16x16x32_bf16 v[152:155], a[136:139], v[112:115], v[152:155]
    s_waitcnt lgkmcnt(9)
    ds_read_b64_tr_b16 a[130:131], v252 offset:34048
    v_mfma_f32_16x16x32_bf16 v[140:143], a[140:143], v[48:51], v[140:143]
    ds_read_b64_tr_b16 a[132:133], v252 offset:33824
    v_mfma_f32_16x16x32_bf16 v[156:159], a[140:143], v[112:115], v[156:159]
    s_waitcnt lgkmcnt(9)
    ds_read_b64_tr_b16 a[134:135], v252 offset:34080
    v_mfma_f32_16x16x32_bf16 v[128:131], a[144:147], v[56:59], v[128:131]
    ds_read_b64_tr_b16 a[136:137], v252 offset:33856
    v_mfma_f32_16x16x32_bf16 v[144:147], a[144:147], v[120:123], v[144:147]
    s_waitcnt lgkmcnt(9)
    ds_read_b64_tr_b16 a[138:139], v252 offset:34112
    v_mfma_f32_16x16x32_bf16 v[132:135], a[148:151], v[56:59], v[132:135]
    ds_read_b64_tr_b16 a[140:141], v252 offset:33888
    v_mfma_f32_16x16x32_bf16 v[148:151], a[148:151], v[120:123], v[148:151]
    s_waitcnt lgkmcnt(9)
    ds_read_b64_tr_b16 a[142:143], v252 offset:34144
    v_mfma_f32_16x16x32_bf16 v[136:139], a[152:155], v[56:59], v[136:139]
    ds_read_b64_tr_b16 a[144:145], v252 offset:34304
    v_mfma_f32_16x16x32_bf16 v[152:155], a[152:155], v[120:123], v[152:155]
    s_waitcnt lgkmcnt(9)
    ds_read_b64_tr_b16 a[146:147], v252 offset:34560
    v_mfma_f32_16x16x32_bf16 v[140:143], a[156:159], v[56:59], v[140:143]
    ds_read_b64_tr_b16 a[148:149], v252 offset:34336
    v_mfma_f32_16x16x32_bf16 v[156:159], a[156:159], v[120:123], v[156:159]
    s_waitcnt lgkmcnt(9)
    ds_read_b64_tr_b16 a[150:151], v252 offset:34592
    v_mfma_f32_16x16x32_bf16 v[192:195], a[128:131], v[0:3], 0
    ds_read_b64_tr_b16 a[152:153], v252 offset:34368
    v_mfma_f32_16x16x32_bf16 v[208:211], a[128:131], v[64:67], 0
    s_waitcnt lgkmcnt(9)
    ds_read_b64_tr_b16 a[154:155], v252 offset:34624
    v_mfma_f32_16x16x32_bf16 v[196:199], a[132:135], v[0:3], 0
    ds_read_b64_tr_b16 a[156:157], v252 offset:34400
    v_mfma_f32_16x16x32_bf16 v[212:215], a[132:135], v[64:67], 0
    s_waitcnt lgkmcnt(9)
    ds_read_b64_tr_b16 a[158:159], v252 offset:34656
    v_mfma_f32_16x16x32_bf16 v[200:203], a[136:139], v[0:3], 0
    ds_read_b64_tr_b16 a[128:129], v252 offset:42240
    v_mfma_f32_16x16x32_bf16 v[216:219], a[136:139], v[64:67], 0
    s_waitcnt lgkmcnt(9)
    ds_read_b64_tr_b16 a[130:131], v252 offset:42496
    v_mfma_f32_16x16x32_bf16 v[204:207], a[140:143], v[0:3], 0
    ds_read_b64_tr_b16 a[132:133], v252 offset:42272
    v_mfma_f32_16x16x32_bf16 v[220:223], a[140:143], v[64:67], 0
    s_waitcnt lgkmcnt(9)
    ds_read_b64_tr_b16 a[134:135], v252 offset:42528
    v_mfma_f32_16x16x32_bf16 v[192:195], a[144:147], v[8:11], v[192:195]
    ds_read_b64_tr_b16 a[136:137], v252 offset:42304
    v_cvt_pk_bf16_f32 v128, v128, v129
    v_mfma_f32_16x16x32_bf16 v[208:211], a[144:147], v[72:75], v[208:211]
    s_waitcnt lgkmcnt(9)
    ds_read_b64_tr_b16 a[138:139], v252 offset:42560
    v_cvt_pk_bf16_f32 v129, v130, v131
    v_mfma_f32_16x16x32_bf16 v[196:199], a[148:151], v[8:11], v[196:199]
    ds_read_b64_tr_b16 a[140:141], v252 offset:42336
    v_cvt_pk_bf16_f32 v130, v132, v133
    v_mfma_f32_16x16x32_bf16 v[212:215], a[148:151], v[72:75], v[212:215]
    s_waitcnt lgkmcnt(9)
    s_add_u32 s33, s31, 12288
    ds_read_b64_tr_b16 a[142:143], v252 offset:42592
    v_cvt_pk_bf16_f32 v131, v134, v135
    v_mfma_f32_16x16x32_bf16 v[200:203], a[152:155], v[8:11], v[200:203]
    ds_read_b64_tr_b16 a[144:145], v252 offset:42752
    buffer_store_dwordx4 v[128:131], v251, s[20:23], s33 offen sc1
    v_mfma_f32_16x16x32_bf16 v[216:219], a[152:155], v[72:75], v[216:219]
    s_waitcnt lgkmcnt(9)
    ds_read_b64_tr_b16 a[146:147], v252 offset:43008
    v_mfma_f32_16x16x32_bf16 v[204:207], a[156:159], v[8:11], v[204:207]
    ds_read_b64_tr_b16 a[148:149], v252 offset:42784
    v_mfma_f32_16x16x32_bf16 v[220:223], a[156:159], v[72:75], v[220:223]
    s_waitcnt lgkmcnt(9)
    ds_read_b64_tr_b16 a[150:151], v252 offset:43040
    v_mfma_f32_16x16x32_bf16 v[192:195], a[128:131], v[16:19], v[192:195]
    ds_read_b64_tr_b16 a[152:153], v252 offset:42816
    v_mfma_f32_16x16x32_bf16 v[208:211], a[128:131], v[80:83], v[208:211]
    s_waitcnt lgkmcnt(9)
    ds_read_b64_tr_b16 a[154:155], v252 offset:43072
    v_mfma_f32_16x16x32_bf16 v[196:199], a[132:135], v[16:19], v[196:199]
    ds_read_b64_tr_b16 a[156:157], v252 offset:42848
    v_cvt_pk_bf16_f32 v136, v136, v137
    v_mfma_f32_16x16x32_bf16 v[212:215], a[132:135], v[80:83], v[212:215]
    s_waitcnt lgkmcnt(9)
    ds_read_b64_tr_b16 a[158:159], v252 offset:43104
    v_cvt_pk_bf16_f32 v137, v138, v139
    v_mfma_f32_16x16x32_bf16 v[200:203], a[136:139], v[16:19], v[200:203]
    ds_read_b64_tr_b16 a[128:129], v244 offset:0
    v_cvt_pk_bf16_f32 v138, v140, v141
    v_mfma_f32_16x16x32_bf16 v[216:219], a[136:139], v[80:83], v[216:219]
    s_waitcnt lgkmcnt(9)
    s_add_u32 s33, s31, 14336
    ds_read_b64_tr_b16 a[130:131], v244 offset:256
    v_cvt_pk_bf16_f32 v139, v142, v143
    v_mfma_f32_16x16x32_bf16 v[204:207], a[140:143], v[16:19], v[204:207]
    ds_read_b64_tr_b16 a[132:133], v244 offset:32
    buffer_store_dwordx4 v[136:139], v251, s[20:23], s33 offen sc1
    v_mfma_f32_16x16x32_bf16 v[220:223], a[140:143], v[80:83], v[220:223]
    s_waitcnt lgkmcnt(9)
    ds_read_b64_tr_b16 a[134:135], v244 offset:288
    v_mfma_f32_16x16x32_bf16 v[192:195], a[144:147], v[24:27], v[192:195]
    ds_read_b64_tr_b16 a[136:137], v244 offset:64
    v_mfma_f32_16x16x32_bf16 v[208:211], a[144:147], v[88:91], v[208:211]
    s_waitcnt lgkmcnt(9)
    ds_read_b64_tr_b16 a[138:139], v244 offset:320
    v_mfma_f32_16x16x32_bf16 v[196:199], a[148:151], v[24:27], v[196:199]
    ds_read_b64_tr_b16 a[140:141], v244 offset:96
    v_mfma_f32_16x16x32_bf16 v[212:215], a[148:151], v[88:91], v[212:215]
    s_waitcnt lgkmcnt(9)
    ds_read_b64_tr_b16 a[142:143], v244 offset:352
    v_mfma_f32_16x16x32_bf16 v[200:203], a[152:155], v[24:27], v[200:203]
    ds_read_b64_tr_b16 a[144:145], v244 offset:512
    v_cvt_pk_bf16_f32 v144, v144, v145
    v_mfma_f32_16x16x32_bf16 v[216:219], a[152:155], v[88:91], v[216:219]
    s_waitcnt lgkmcnt(9)
    ds_read_b64_tr_b16 a[146:147], v244 offset:768
    v_cvt_pk_bf16_f32 v145, v146, v147
    v_mfma_f32_16x16x32_bf16 v[204:207], a[156:159], v[24:27], v[204:207]
    ds_read_b64_tr_b16 a[148:149], v244 offset:544
    v_cvt_pk_bf16_f32 v146, v148, v149
    v_mfma_f32_16x16x32_bf16 v[220:223], a[156:159], v[88:91], v[220:223]
    s_waitcnt lgkmcnt(9)
    s_add_u32 s33, s31, 13312
    ds_read_b64_tr_b16 a[150:151], v244 offset:800
    v_cvt_pk_bf16_f32 v147, v150, v151
    v_mfma_f32_16x16x32_bf16 v[192:195], a[128:131], v[32:35], v[192:195]
    ds_read_b64_tr_b16 a[152:153], v244 offset:576
    buffer_store_dwordx4 v[144:147], v251, s[20:23], s33 offen sc1
    v_mfma_f32_16x16x32_bf16 v[208:211], a[128:131], v[96:99], v[208:211]
    s_waitcnt lgkmcnt(9)
    ds_read_b64_tr_b16 a[154:155], v244 offset:832
    v_mfma_f32_16x16x32_bf16 v[196:199], a[132:135], v[32:35], v[196:199]
    ds_read_b64_tr_b16 a[156:157], v244 offset:608
    v_mfma_f32_16x16x32_bf16 v[212:215], a[132:135], v[96:99], v[212:215]
    s_waitcnt lgkmcnt(9)
    ds_read_b64_tr_b16 a[158:159], v244 offset:864
    v_mfma_f32_16x16x32_bf16 v[200:203], a[136:139], v[32:35], v[200:203]
    ds_read_b64_tr_b16 a[128:129], v244 offset:8448
    v_mfma_f32_16x16x32_bf16 v[216:219], a[136:139], v[96:99], v[216:219]
    s_waitcnt lgkmcnt(9)
    ds_read_b64_tr_b16 a[130:131], v244 offset:8704
    v_mfma_f32_16x16x32_bf16 v[204:207], a[140:143], v[32:35], v[204:207]
    ds_read_b64_tr_b16 a[132:133], v244 offset:8480
    v_cvt_pk_bf16_f32 v152, v152, v153
    v_mfma_f32_16x16x32_bf16 v[220:223], a[140:143], v[96:99], v[220:223]
    s_waitcnt lgkmcnt(9)
    ds_read_b64_tr_b16 a[134:135], v244 offset:8736
    v_cvt_pk_bf16_f32 v153, v154, v155
    v_mfma_f32_16x16x32_bf16 v[192:195], a[144:147], v[40:43], v[192:195]
    ds_read_b64_tr_b16 a[136:137], v244 offset:8512
    v_cvt_pk_bf16_f32 v154, v156, v157
    v_mfma_f32_16x16x32_bf16 v[208:211], a[144:147], v[104:107], v[208:211]
    s_waitcnt lgkmcnt(9)
    s_add_u32 s33, s31, 15360
    ds_read_b64_tr_b16 a[138:139], v244 offset:8768
    v_cvt_pk_bf16_f32 v155, v158, v159
    v_mfma_f32_16x16x32_bf16 v[196:199], a[148:151], v[40:43], v[196:199]
    ds_read_b64_tr_b16 a[140:141], v244 offset:8544
    buffer_store_dwordx4 v[152:155], v251, s[20:23], s33 offen sc1
    v_mfma_f32_16x16x32_bf16 v[212:215], a[148:151], v[104:107], v[212:215]
    s_waitcnt lgkmcnt(9)
    ds_read_b64_tr_b16 a[142:143], v244 offset:8800
    v_mfma_f32_16x16x32_bf16 v[200:203], a[152:155], v[40:43], v[200:203]
    ds_read_b64_tr_b16 a[144:145], v244 offset:8960
    v_mfma_f32_16x16x32_bf16 v[216:219], a[152:155], v[104:107], v[216:219]
    s_waitcnt lgkmcnt(9)
    ds_read_b64_tr_b16 a[146:147], v244 offset:9216
    v_mfma_f32_16x16x32_bf16 v[204:207], a[156:159], v[40:43], v[204:207]
    ds_read_b64_tr_b16 a[148:149], v244 offset:8992
    v_mfma_f32_16x16x32_bf16 v[220:223], a[156:159], v[104:107], v[220:223]
    s_waitcnt lgkmcnt(9)
    ds_read_b64_tr_b16 a[150:151], v244 offset:9248
    v_mfma_f32_16x16x32_bf16 v[192:195], a[128:131], v[48:51], v[192:195]
    ds_read_b64_tr_b16 a[152:153], v244 offset:9024
    v_mfma_f32_16x16x32_bf16 v[208:211], a[128:131], v[112:115], v[208:211]
    s_waitcnt lgkmcnt(9)
    ds_read_b64_tr_b16 a[154:155], v244 offset:9280
    v_mfma_f32_16x16x32_bf16 v[196:199], a[132:135], v[48:51], v[196:199]
    ds_read_b64_tr_b16 a[156:157], v244 offset:9056
    v_mfma_f32_16x16x32_bf16 v[212:215], a[132:135], v[112:115], v[212:215]
    s_waitcnt vmcnt(17) lgkmcnt(9)
    s_barrier
    ds_read_b64_tr_b16 a[158:159], v244 offset:9312
    v_mfma_f32_16x16x32_bf16 v[200:203], a[136:139], v[48:51], v[200:203]
    ds_read_b64_tr_b16 a[128:129], v245 offset:0
    v_mfma_f32_16x16x32_bf16 v[216:219], a[136:139], v[112:115], v[216:219]
    s_waitcnt lgkmcnt(9)
    ds_read_b64_tr_b16 a[130:131], v245 offset:256
    v_mfma_f32_16x16x32_bf16 v[204:207], a[140:143], v[48:51], v[204:207]
    ds_read_b64_tr_b16 a[132:133], v245 offset:32
    v_mfma_f32_16x16x32_bf16 v[220:223], a[140:143], v[112:115], v[220:223]
    s_waitcnt lgkmcnt(9)
    ds_read_b64_tr_b16 a[134:135], v245 offset:288
    v_mfma_f32_16x16x32_bf16 v[192:195], a[144:147], v[56:59], v[192:195]
    ds_read_b64_tr_b16 a[136:137], v245 offset:64
    v_mfma_f32_16x16x32_bf16 v[208:211], a[144:147], v[120:123], v[208:211]
    s_waitcnt lgkmcnt(9)
    ds_read_b64_tr_b16 a[138:139], v245 offset:320
    v_mfma_f32_16x16x32_bf16 v[196:199], a[148:151], v[56:59], v[196:199]
    ds_read_b64_tr_b16 a[140:141], v245 offset:96
    v_mfma_f32_16x16x32_bf16 v[212:215], a[148:151], v[120:123], v[212:215]
    s_waitcnt lgkmcnt(9)
    ds_read_b64_tr_b16 a[142:143], v245 offset:352
    v_mfma_f32_16x16x32_bf16 v[200:203], a[152:155], v[56:59], v[200:203]
    ds_read_b64_tr_b16 a[144:145], v245 offset:512
    v_mfma_f32_16x16x32_bf16 v[216:219], a[152:155], v[120:123], v[216:219]
    s_waitcnt lgkmcnt(9)
    ds_read_b64_tr_b16 a[146:147], v245 offset:768
    v_mfma_f32_16x16x32_bf16 v[204:207], a[156:159], v[56:59], v[204:207]
    ds_read_b64_tr_b16 a[148:149], v245 offset:544
    v_mfma_f32_16x16x32_bf16 v[220:223], a[156:159], v[120:123], v[220:223]
    s_waitcnt lgkmcnt(9)
    ds_read_b64_tr_b16 a[150:151], v245 offset:800
    v_mfma_f32_16x16x32_bf16 v[128:131], a[128:131], v[0:3], 0
    ds_read_b64_tr_b16 a[152:153], v245 offset:576
    v_mfma_f32_16x16x32_bf16 v[144:147], a[128:131], v[64:67], 0
    s_waitcnt lgkmcnt(9)
    ds_read_b64_tr_b16 a[154:155], v245 offset:832
    v_mfma_f32_16x16x32_bf16 v[132:135], a[132:135], v[0:3], 0
    ds_read_b64_tr_b16 a[156:157], v245 offset:608
    v_mfma_f32_16x16x32_bf16 v[148:151], a[132:135], v[64:67], 0
    s_waitcnt lgkmcnt(9)
    ds_read_b64_tr_b16 a[158:159], v245 offset:864
    v_mfma_f32_16x16x32_bf16 v[136:139], a[136:139], v[0:3], 0
    ds_read_b64_tr_b16 a[128:129], v245 offset:8448
    v_mfma_f32_16x16x32_bf16 v[152:155], a[136:139], v[64:67], 0
    s_waitcnt lgkmcnt(9)
    ds_read_b64_tr_b16 a[130:131], v245 offset:8704
    v_mfma_f32_16x16x32_bf16 v[140:143], a[140:143], v[0:3], 0
    ds_read_b64_tr_b16 a[132:133], v245 offset:8480
    v_mfma_f32_16x16x32_bf16 v[156:159], a[140:143], v[64:67], 0
    s_waitcnt lgkmcnt(9)
    ds_read_b64_tr_b16 a[134:135], v245 offset:8736
    v_mfma_f32_16x16x32_bf16 v[128:131], a[144:147], v[8:11], v[128:131]
    ds_read_b64_tr_b16 a[136:137], v245 offset:8512
    v_cvt_pk_bf16_f32 v192, v192, v193
    v_mfma_f32_16x16x32_bf16 v[144:147], a[144:147], v[72:75], v[144:147]
    s_waitcnt lgkmcnt(9)
    ds_read_b64_tr_b16 a[138:139], v245 offset:8768
    v_cvt_pk_bf16_f32 v193, v194, v195
    v_mfma_f32_16x16x32_bf16 v[132:135], a[148:151], v[8:11], v[132:135]
    ds_read_b64_tr_b16 a[140:141], v245 offset:8544
    v_cvt_pk_bf16_f32 v194, v196, v197
    v_mfma_f32_16x16x32_bf16 v[148:151], a[148:151], v[72:75], v[148:151]
    s_waitcnt lgkmcnt(9)
    s_add_u32 s33, s31, 16384
    ds_read_b64_tr_b16 a[142:143], v245 offset:8800
    v_cvt_pk_bf16_f32 v195, v198, v199
    v_mfma_f32_16x16x32_bf16 v[136:139], a[152:155], v[8:11], v[136:139]
    ds_read_b64_tr_b16 a[144:145], v245 offset:8960
    buffer_store_dwordx4 v[192:195], v251, s[20:23], s33 offen sc1
    v_mfma_f32_16x16x32_bf16 v[152:155], a[152:155], v[72:75], v[152:155]
    s_waitcnt lgkmcnt(9)
    ds_read_b64_tr_b16 a[146:147], v245 offset:9216
    v_mfma_f32_16x16x32_bf16 v[140:143], a[156:159], v[8:11], v[140:143]
    ds_read_b64_tr_b16 a[148:149], v245 offset:8992
    v_mfma_f32_16x16x32_bf16 v[156:159], a[156:159], v[72:75], v[156:159]
    s_waitcnt lgkmcnt(9)
    ds_read_b64_tr_b16 a[150:151], v245 offset:9248
    v_mfma_f32_16x16x32_bf16 v[128:131], a[128:131], v[16:19], v[128:131]
    ds_read_b64_tr_b16 a[152:153], v245 offset:9024
    v_mfma_f32_16x16x32_bf16 v[144:147], a[128:131], v[80:83], v[144:147]
    s_waitcnt lgkmcnt(9)
    ds_read_b64_tr_b16 a[154:155], v245 offset:9280
    v_mfma_f32_16x16x32_bf16 v[132:135], a[132:135], v[16:19], v[132:135]
    ds_read_b64_tr_b16 a[156:157], v245 offset:9056
    v_cvt_pk_bf16_f32 v200, v200, v201
    v_mfma_f32_16x16x32_bf16 v[148:151], a[132:135], v[80:83], v[148:151]
    s_waitcnt lgkmcnt(9)
    ds_read_b64_tr_b16 a[158:159], v245 offset:9312
    v_cvt_pk_bf16_f32 v201, v202, v203
    v_mfma_f32_16x16x32_bf16 v[136:139], a[136:139], v[16:19], v[136:139]
    ds_read_b64_tr_b16 a[128:129], v245 offset:16896
    v_cvt_pk_bf16_f32 v202, v204, v205
    v_mfma_f32_16x16x32_bf16 v[152:155], a[136:139], v[80:83], v[152:155]
    s_waitcnt lgkmcnt(9)
    s_add_u32 s33, s31, 18432
    ds_read_b64_tr_b16 a[130:131], v245 offset:17152
    v_cvt_pk_bf16_f32 v203, v206, v207
    v_mfma_f32_16x16x32_bf16 v[140:143], a[140:143], v[16:19], v[140:143]
    ds_read_b64_tr_b16 a[132:133], v245 offset:16928
    buffer_store_dwordx4 v[200:203], v251, s[20:23], s33 offen sc1
    v_mfma_f32_16x16x32_bf16 v[156:159], a[140:143], v[80:83], v[156:159]
    s_waitcnt lgkmcnt(9)
    ds_read_b64_tr_b16 a[134:135], v245 offset:17184
    v_mfma_f32_16x16x32_bf16 v[128:131], a[144:147], v[24:27], v[128:131]
    ds_read_b64_tr_b16 a[136:137], v245 offset:16960
    v_mfma_f32_16x16x32_bf16 v[144:147], a[144:147], v[88:91], v[144:147]
    s_waitcnt lgkmcnt(9)
    ds_read_b64_tr_b16 a[138:139], v245 offset:17216
    v_mfma_f32_16x16x32_bf16 v[132:135], a[148:151], v[24:27], v[132:135]
    ds_read_b64_tr_b16 a[140:141], v245 offset:16992
    v_mfma_f32_16x16x32_bf16 v[148:151], a[148:151], v[88:91], v[148:151]
    s_waitcnt lgkmcnt(9)
    ds_read_b64_tr_b16 a[142:143], v245 offset:17248
    v_mfma_f32_16x16x32_bf16 v[136:139], a[152:155], v[24:27], v[136:139]
    ds_read_b64_tr_b16 a[144:145], v245 offset:17408
    v_cvt_pk_bf16_f32 v208, v208, v209
    v_mfma_f32_16x16x32_bf16 v[152:155], a[152:155], v[88:91], v[152:155]
    s_waitcnt lgkmcnt(9)
    ds_read_b64_tr_b16 a[146:147], v245 offset:17664
    v_cvt_pk_bf16_f32 v209, v210, v211
    v_mfma_f32_16x16x32_bf16 v[140:143], a[156:159], v[24:27], v[140:143]
    ds_read_b64_tr_b16 a[148:149], v245 offset:17440
    v_cvt_pk_bf16_f32 v210, v212, v213
    v_mfma_f32_16x16x32_bf16 v[156:159], a[156:159], v[88:91], v[156:159]
    s_waitcnt lgkmcnt(9)
    s_add_u32 s33, s31, 17408
    ds_read_b64_tr_b16 a[150:151], v245 offset:17696
    v_cvt_pk_bf16_f32 v211, v214, v215
    v_mfma_f32_16x16x32_bf16 v[128:131], a[128:131], v[32:35], v[128:131]
    ds_read_b64_tr_b16 a[152:153], v245 offset:17472
    buffer_store_dwordx4 v[208:211], v251, s[20:23], s33 offen sc1
    v_mfma_f32_16x16x32_bf16 v[144:147], a[128:131], v[96:99], v[144:147]
    s_waitcnt lgkmcnt(9)
    ds_read_b64_tr_b16 a[154:155], v245 offset:17728
    v_mfma_f32_16x16x32_bf16 v[132:135], a[132:135], v[32:35], v[132:135]
    ds_read_b64_tr_b16 a[156:157], v245 offset:17504
    v_mfma_f32_16x16x32_bf16 v[148:151], a[132:135], v[96:99], v[148:151]
    s_waitcnt lgkmcnt(9)
    ds_read_b64_tr_b16 a[158:159], v245 offset:17760
    v_mfma_f32_16x16x32_bf16 v[136:139], a[136:139], v[32:35], v[136:139]
    ds_read_b64_tr_b16 a[128:129], v245 offset:25344
    v_mfma_f32_16x16x32_bf16 v[152:155], a[136:139], v[96:99], v[152:155]
    s_waitcnt lgkmcnt(9)
    ds_read_b64_tr_b16 a[130:131], v245 offset:25600
    v_mfma_f32_16x16x32_bf16 v[140:143], a[140:143], v[32:35], v[140:143]
    ds_read_b64_tr_b16 a[132:133], v245 offset:25376
    v_cvt_pk_bf16_f32 v216, v216, v217
    v_mfma_f32_16x16x32_bf16 v[156:159], a[140:143], v[96:99], v[156:159]
    s_waitcnt lgkmcnt(9)
    ds_read_b64_tr_b16 a[134:135], v245 offset:25632
    v_cvt_pk_bf16_f32 v217, v218, v219
    v_mfma_f32_16x16x32_bf16 v[128:131], a[144:147], v[40:43], v[128:131]
    ds_read_b64_tr_b16 a[136:137], v245 offset:25408
    v_cvt_pk_bf16_f32 v218, v220, v221
    v_mfma_f32_16x16x32_bf16 v[144:147], a[144:147], v[104:107], v[144:147]
    s_waitcnt lgkmcnt(9)
    s_add_u32 s33, s31, 19456
    ds_read_b64_tr_b16 a[138:139], v245 offset:25664
    v_cvt_pk_bf16_f32 v219, v222, v223
    v_mfma_f32_16x16x32_bf16 v[132:135], a[148:151], v[40:43], v[132:135]
    ds_read_b64_tr_b16 a[140:141], v245 offset:25440
    buffer_store_dwordx4 v[216:219], v251, s[20:23], s33 offen sc1
    v_mfma_f32_16x16x32_bf16 v[148:151], a[148:151], v[104:107], v[148:151]
    s_waitcnt lgkmcnt(9)
    ds_read_b64_tr_b16 a[142:143], v245 offset:25696
    v_mfma_f32_16x16x32_bf16 v[136:139], a[152:155], v[40:43], v[136:139]
    ds_read_b64_tr_b16 a[144:145], v245 offset:25856
    v_mfma_f32_16x16x32_bf16 v[152:155], a[152:155], v[104:107], v[152:155]
    s_waitcnt lgkmcnt(9)
    ds_read_b64_tr_b16 a[146:147], v245 offset:26112
    v_mfma_f32_16x16x32_bf16 v[140:143], a[156:159], v[40:43], v[140:143]
    ds_read_b64_tr_b16 a[148:149], v245 offset:25888
    v_mfma_f32_16x16x32_bf16 v[156:159], a[156:159], v[104:107], v[156:159]
    s_waitcnt lgkmcnt(9)
    ds_read_b64_tr_b16 a[150:151], v245 offset:26144
    v_mfma_f32_16x16x32_bf16 v[128:131], a[128:131], v[48:51], v[128:131]
    ds_read_b64_tr_b16 a[152:153], v245 offset:25920
    v_mfma_f32_16x16x32_bf16 v[144:147], a[128:131], v[112:115], v[144:147]
    s_waitcnt lgkmcnt(9)
    ds_read_b64_tr_b16 a[154:155], v245 offset:26176
    v_mfma_f32_16x16x32_bf16 v[132:135], a[132:135], v[48:51], v[132:135]
    ds_read_b64_tr_b16 a[156:157], v245 offset:25952
    v_mfma_f32_16x16x32_bf16 v[148:151], a[132:135], v[112:115], v[148:151]
    s_waitcnt vmcnt(10) lgkmcnt(9)
    s_barrier
    ds_read_b64_tr_b16 a[158:159], v245 offset:26208
    v_mfma_f32_16x16x32_bf16 v[136:139], a[136:139], v[48:51], v[136:139]
    ds_read_b64_tr_b16 a[128:129], v245 offset:33792
    v_mfma_f32_16x16x32_bf16 v[152:155], a[136:139], v[112:115], v[152:155]
    s_waitcnt lgkmcnt(9)
    ds_read_b64_tr_b16 a[130:131], v245 offset:34048
    v_mfma_f32_16x16x32_bf16 v[140:143], a[140:143], v[48:51], v[140:143]
    ds_read_b64_tr_b16 a[132:133], v245 offset:33824
    v_mfma_f32_16x16x32_bf16 v[156:159], a[140:143], v[112:115], v[156:159]
    s_waitcnt lgkmcnt(9)
    ds_read_b64_tr_b16 a[134:135], v245 offset:34080
    v_mfma_f32_16x16x32_bf16 v[128:131], a[144:147], v[56:59], v[128:131]
    ds_read_b64_tr_b16 a[136:137], v245 offset:33856
    v_mfma_f32_16x16x32_bf16 v[144:147], a[144:147], v[120:123], v[144:147]
    s_waitcnt lgkmcnt(9)
    ds_read_b64_tr_b16 a[138:139], v245 offset:34112
    v_mfma_f32_16x16x32_bf16 v[132:135], a[148:151], v[56:59], v[132:135]
    ds_read_b64_tr_b16 a[140:141], v245 offset:33888
    v_mfma_f32_16x16x32_bf16 v[148:151], a[148:151], v[120:123], v[148:151]
    s_waitcnt lgkmcnt(9)
    ds_read_b64_tr_b16 a[142:143], v245 offset:34144
    v_mfma_f32_16x16x32_bf16 v[136:139], a[152:155], v[56:59], v[136:139]
    ds_read_b64_tr_b16 a[144:145], v245 offset:34304
    v_mfma_f32_16x16x32_bf16 v[152:155], a[152:155], v[120:123], v[152:155]
    s_waitcnt lgkmcnt(9)
    ds_read_b64_tr_b16 a[146:147], v245 offset:34560
    v_mfma_f32_16x16x32_bf16 v[140:143], a[156:159], v[56:59], v[140:143]
    ds_read_b64_tr_b16 a[148:149], v245 offset:34336
    v_mfma_f32_16x16x32_bf16 v[156:159], a[156:159], v[120:123], v[156:159]
    s_waitcnt lgkmcnt(9)
    ds_read_b64_tr_b16 a[150:151], v245 offset:34592
    v_mfma_f32_16x16x32_bf16 v[192:195], a[128:131], v[0:3], 0
    ds_read_b64_tr_b16 a[152:153], v245 offset:34368
    v_mfma_f32_16x16x32_bf16 v[208:211], a[128:131], v[64:67], 0
    s_waitcnt lgkmcnt(9)
    ds_read_b64_tr_b16 a[154:155], v245 offset:34624
    v_mfma_f32_16x16x32_bf16 v[196:199], a[132:135], v[0:3], 0
    ds_read_b64_tr_b16 a[156:157], v245 offset:34400
    v_mfma_f32_16x16x32_bf16 v[212:215], a[132:135], v[64:67], 0
    s_waitcnt lgkmcnt(9)
    ds_read_b64_tr_b16 a[158:159], v245 offset:34656
    v_mfma_f32_16x16x32_bf16 v[200:203], a[136:139], v[0:3], 0
    ds_read_b64_tr_b16 a[128:129], v245 offset:42240
    v_mfma_f32_16x16x32_bf16 v[216:219], a[136:139], v[64:67], 0
    s_waitcnt lgkmcnt(9)
    ds_read_b64_tr_b16 a[130:131], v245 offset:42496
    v_mfma_f32_16x16x32_bf16 v[204:207], a[140:143], v[0:3], 0
    ds_read_b64_tr_b16 a[132:133], v245 offset:42272
    v_mfma_f32_16x16x32_bf16 v[220:223], a[140:143], v[64:67], 0
    s_waitcnt lgkmcnt(9)
    ds_read_b64_tr_b16 a[134:135], v245 offset:42528
    v_mfma_f32_16x16x32_bf16 v[192:195], a[144:147], v[8:11], v[192:195]
    ds_read_b64_tr_b16 a[136:137], v245 offset:42304
    v_cvt_pk_bf16_f32 v128, v128, v129
    v_mfma_f32_16x16x32_bf16 v[208:211], a[144:147], v[72:75], v[208:211]
    s_waitcnt lgkmcnt(9)
    ds_read_b64_tr_b16 a[138:139], v245 offset:42560
    v_cvt_pk_bf16_f32 v129, v130, v131
    v_mfma_f32_16x16x32_bf16 v[196:199], a[148:151], v[8:11], v[196:199]
    ds_read_b64_tr_b16 a[140:141], v245 offset:42336
    v_cvt_pk_bf16_f32 v130, v132, v133
    v_mfma_f32_16x16x32_bf16 v[212:215], a[148:151], v[72:75], v[212:215]
    s_waitcnt lgkmcnt(9)
    s_add_u32 s33, s31, 20480
    ds_read_b64_tr_b16 a[142:143], v245 offset:42592
    v_cvt_pk_bf16_f32 v131, v134, v135
    v_mfma_f32_16x16x32_bf16 v[200:203], a[152:155], v[8:11], v[200:203]
    ds_read_b64_tr_b16 a[144:145], v245 offset:42752
    buffer_store_dwordx4 v[128:131], v251, s[20:23], s33 offen sc1
    v_mfma_f32_16x16x32_bf16 v[216:219], a[152:155], v[72:75], v[216:219]
    s_waitcnt lgkmcnt(9)
    ds_read_b64_tr_b16 a[146:147], v245 offset:43008
    v_mfma_f32_16x16x32_bf16 v[204:207], a[156:159], v[8:11], v[204:207]
    ds_read_b64_tr_b16 a[148:149], v245 offset:42784
    v_mfma_f32_16x16x32_bf16 v[220:223], a[156:159], v[72:75], v[220:223]
    s_waitcnt lgkmcnt(9)
    ds_read_b64_tr_b16 a[150:151], v245 offset:43040
    v_mfma_f32_16x16x32_bf16 v[192:195], a[128:131], v[16:19], v[192:195]
    ds_read_b64_tr_b16 a[152:153], v245 offset:42816
    v_mfma_f32_16x16x32_bf16 v[208:211], a[128:131], v[80:83], v[208:211]
    s_waitcnt lgkmcnt(9)
    ds_read_b64_tr_b16 a[154:155], v245 offset:43072
    v_mfma_f32_16x16x32_bf16 v[196:199], a[132:135], v[16:19], v[196:199]
    ds_read_b64_tr_b16 a[156:157], v245 offset:42848
    v_cvt_pk_bf16_f32 v136, v136, v137
    v_mfma_f32_16x16x32_bf16 v[212:215], a[132:135], v[80:83], v[212:215]
    s_waitcnt lgkmcnt(9)
    ds_read_b64_tr_b16 a[158:159], v245 offset:43104
    v_cvt_pk_bf16_f32 v137, v138, v139
    v_mfma_f32_16x16x32_bf16 v[200:203], a[136:139], v[16:19], v[200:203]
    ds_read_b64_tr_b16 a[128:129], v245 offset:50688
    v_cvt_pk_bf16_f32 v138, v140, v141
    v_mfma_f32_16x16x32_bf16 v[216:219], a[136:139], v[80:83], v[216:219]
    s_waitcnt lgkmcnt(9)
    s_add_u32 s33, s31, 22528
    ds_read_b64_tr_b16 a[130:131], v245 offset:50944
    v_cvt_pk_bf16_f32 v139, v142, v143
    v_mfma_f32_16x16x32_bf16 v[204:207], a[140:143], v[16:19], v[204:207]
    ds_read_b64_tr_b16 a[132:133], v245 offset:50720
    buffer_store_dwordx4 v[136:139], v251, s[20:23], s33 offen sc1
    v_mfma_f32_16x16x32_bf16 v[220:223], a[140:143], v[80:83], v[220:223]
    s_waitcnt lgkmcnt(9)
    ds_read_b64_tr_b16 a[134:135], v245 offset:50976
    v_mfma_f32_16x16x32_bf16 v[192:195], a[144:147], v[24:27], v[192:195]
    ds_read_b64_tr_b16 a[136:137], v245 offset:50752
    v_mfma_f32_16x16x32_bf16 v[208:211], a[144:147], v[88:91], v[208:211]
    s_waitcnt lgkmcnt(9)
    ds_read_b64_tr_b16 a[138:139], v245 offset:51008
    v_mfma_f32_16x16x32_bf16 v[196:199], a[148:151], v[24:27], v[196:199]
    ds_read_b64_tr_b16 a[140:141], v245 offset:50784
    v_mfma_f32_16x16x32_bf16 v[212:215], a[148:151], v[88:91], v[212:215]
    s_waitcnt lgkmcnt(9)
    ds_read_b64_tr_b16 a[142:143], v245 offset:51040
    v_mfma_f32_16x16x32_bf16 v[200:203], a[152:155], v[24:27], v[200:203]
    ds_read_b64_tr_b16 a[144:145], v245 offset:51200
    v_cvt_pk_bf16_f32 v144, v144, v145
    v_mfma_f32_16x16x32_bf16 v[216:219], a[152:155], v[88:91], v[216:219]
    s_waitcnt lgkmcnt(9)
    ds_read_b64_tr_b16 a[146:147], v245 offset:51456
    v_cvt_pk_bf16_f32 v145, v146, v147
    v_mfma_f32_16x16x32_bf16 v[204:207], a[156:159], v[24:27], v[204:207]
    ds_read_b64_tr_b16 a[148:149], v245 offset:51232
    v_cvt_pk_bf16_f32 v146, v148, v149
    v_mfma_f32_16x16x32_bf16 v[220:223], a[156:159], v[88:91], v[220:223]
    s_waitcnt lgkmcnt(9)
    s_add_u32 s33, s31, 21504
    ds_read_b64_tr_b16 a[150:151], v245 offset:51488
    v_cvt_pk_bf16_f32 v147, v150, v151
    v_mfma_f32_16x16x32_bf16 v[192:195], a[128:131], v[32:35], v[192:195]
    ds_read_b64_tr_b16 a[152:153], v245 offset:51264
    buffer_store_dwordx4 v[144:147], v251, s[20:23], s33 offen sc1
    v_mfma_f32_16x16x32_bf16 v[208:211], a[128:131], v[96:99], v[208:211]
    s_waitcnt lgkmcnt(9)
    ds_read_b64_tr_b16 a[154:155], v245 offset:51520
    v_mfma_f32_16x16x32_bf16 v[196:199], a[132:135], v[32:35], v[196:199]
    ds_read_b64_tr_b16 a[156:157], v245 offset:51296
    v_mfma_f32_16x16x32_bf16 v[212:215], a[132:135], v[96:99], v[212:215]
    s_waitcnt lgkmcnt(9)
    ds_read_b64_tr_b16 a[158:159], v245 offset:51552
    v_mfma_f32_16x16x32_bf16 v[200:203], a[136:139], v[32:35], v[200:203]
    ds_read_b64_tr_b16 a[128:129], v245 offset:59136
    v_mfma_f32_16x16x32_bf16 v[216:219], a[136:139], v[96:99], v[216:219]
    s_waitcnt lgkmcnt(9)
    ds_read_b64_tr_b16 a[130:131], v245 offset:59392
    v_mfma_f32_16x16x32_bf16 v[204:207], a[140:143], v[32:35], v[204:207]
    ds_read_b64_tr_b16 a[132:133], v245 offset:59168
    v_cvt_pk_bf16_f32 v152, v152, v153
    v_mfma_f32_16x16x32_bf16 v[220:223], a[140:143], v[96:99], v[220:223]
    s_waitcnt lgkmcnt(9)
    ds_read_b64_tr_b16 a[134:135], v245 offset:59424
    v_cvt_pk_bf16_f32 v153, v154, v155
    v_mfma_f32_16x16x32_bf16 v[192:195], a[144:147], v[40:43], v[192:195]
    ds_read_b64_tr_b16 a[136:137], v245 offset:59200
    v_cvt_pk_bf16_f32 v154, v156, v157
    v_mfma_f32_16x16x32_bf16 v[208:211], a[144:147], v[104:107], v[208:211]
    s_waitcnt lgkmcnt(9)
    s_add_u32 s33, s31, 23552
    ds_read_b64_tr_b16 a[138:139], v245 offset:59456
    v_cvt_pk_bf16_f32 v155, v158, v159
    v_mfma_f32_16x16x32_bf16 v[196:199], a[148:151], v[40:43], v[196:199]
    ds_read_b64_tr_b16 a[140:141], v245 offset:59232
    buffer_store_dwordx4 v[152:155], v251, s[20:23], s33 offen sc1
    v_mfma_f32_16x16x32_bf16 v[212:215], a[148:151], v[104:107], v[212:215]
    s_waitcnt lgkmcnt(9)
    ds_read_b64_tr_b16 a[142:143], v245 offset:59488
    v_mfma_f32_16x16x32_bf16 v[200:203], a[152:155], v[40:43], v[200:203]
    ds_read_b64_tr_b16 a[144:145], v245 offset:59648
    v_mfma_f32_16x16x32_bf16 v[216:219], a[152:155], v[104:107], v[216:219]
    s_waitcnt lgkmcnt(9)
    ds_read_b64_tr_b16 a[146:147], v245 offset:59904
    v_mfma_f32_16x16x32_bf16 v[204:207], a[156:159], v[40:43], v[204:207]
    ds_read_b64_tr_b16 a[148:149], v245 offset:59680
    v_mfma_f32_16x16x32_bf16 v[220:223], a[156:159], v[104:107], v[220:223]
    s_waitcnt lgkmcnt(9)
    ds_read_b64_tr_b16 a[150:151], v245 offset:59936
    v_mfma_f32_16x16x32_bf16 v[192:195], a[128:131], v[48:51], v[192:195]
    ds_read_b64_tr_b16 a[152:153], v245 offset:59712
    v_mfma_f32_16x16x32_bf16 v[208:211], a[128:131], v[112:115], v[208:211]
    s_waitcnt lgkmcnt(9)
    ds_read_b64_tr_b16 a[154:155], v245 offset:59968
    v_mfma_f32_16x16x32_bf16 v[196:199], a[132:135], v[48:51], v[196:199]
    ds_read_b64_tr_b16 a[156:157], v245 offset:59744
    v_mfma_f32_16x16x32_bf16 v[212:215], a[132:135], v[112:115], v[212:215]
    s_waitcnt lgkmcnt(9)
    ds_read_b64_tr_b16 a[158:159], v245 offset:60000
    v_mfma_f32_16x16x32_bf16 v[200:203], a[136:139], v[48:51], v[200:203]
    v_mfma_f32_16x16x32_bf16 v[216:219], a[136:139], v[112:115], v[216:219]
    s_waitcnt lgkmcnt(8)
    v_mfma_f32_16x16x32_bf16 v[204:207], a[140:143], v[48:51], v[204:207]
    v_mfma_f32_16x16x32_bf16 v[220:223], a[140:143], v[112:115], v[220:223]
    s_waitcnt lgkmcnt(6)
    v_mfma_f32_16x16x32_bf16 v[192:195], a[144:147], v[56:59], v[192:195]
    v_mfma_f32_16x16x32_bf16 v[208:211], a[144:147], v[120:123], v[208:211]
    s_waitcnt lgkmcnt(4)
    v_mfma_f32_16x16x32_bf16 v[196:199], a[148:151], v[56:59], v[196:199]
    v_mfma_f32_16x16x32_bf16 v[212:215], a[148:151], v[120:123], v[212:215]
    s_waitcnt lgkmcnt(2)
    v_mfma_f32_16x16x32_bf16 v[200:203], a[152:155], v[56:59], v[200:203]
    v_mfma_f32_16x16x32_bf16 v[216:219], a[152:155], v[120:123], v[216:219]
    s_waitcnt lgkmcnt(0)
    v_mfma_f32_16x16x32_bf16 v[204:207], a[156:159], v[56:59], v[204:207]
    v_mfma_f32_16x16x32_bf16 v[220:223], a[156:159], v[120:123], v[220:223]
    s_nop 7
    v_cvt_pk_bf16_f32 v192, v192, v193
    v_cvt_pk_bf16_f32 v193, v194, v195
    v_cvt_pk_bf16_f32 v194, v196, v197
    v_cvt_pk_bf16_f32 v195, v198, v199
    s_add_u32 s33, s31, 24576
    buffer_store_dwordx4 v[192:195], v251, s[20:23], s33 offen sc1
    v_cvt_pk_bf16_f32 v200, v200, v201
    v_cvt_pk_bf16_f32 v201, v202, v203
    v_cvt_pk_bf16_f32 v202, v204, v205
    v_cvt_pk_bf16_f32 v203, v206, v207
    s_add_u32 s33, s31, 26624
    buffer_store_dwordx4 v[200:203], v251, s[20:23], s33 offen sc1
    v_cvt_pk_bf16_f32 v208, v208, v209
    v_cvt_pk_bf16_f32 v209, v210, v211
    v_cvt_pk_bf16_f32 v210, v212, v213
    v_cvt_pk_bf16_f32 v211, v214, v215
    s_add_u32 s33, s31, 25600
    buffer_store_dwordx4 v[208:211], v251, s[20:23], s33 offen sc1
    v_cvt_pk_bf16_f32 v216, v216, v217
    v_cvt_pk_bf16_f32 v217, v218, v219
    v_cvt_pk_bf16_f32 v218, v220, v221
    v_cvt_pk_bf16_f32 v219, v222, v223
    s_add_u32 s33, s31, 27648
    buffer_store_dwordx4 v[216:219], v251, s[20:23], s33 offen sc1
k1_done:
    s_endpgm
k1_pl2:
    s_mov_b32 s53, 262144
    s_mov_b32 exec_hi, 0xffffff
k1_pl3:
    s_waitcnt vmcnt(0)
    v_xor_b32 v129, s51, v129
    v_xor_b32 v131, s51, v131
    v_xor_b32 v133, s51, v133
    v_xor_b32 v135, s51, v135
    v_xor_b32 v137, s51, v137
    v_xor_b32 v139, s51, v139
    v_xor_b32 v141, s51, v141
    v_xor_b32 v143, s51, v143
    v_or3_b32 v129, v129, v131, v133
    v_or3_b32 v129, v129, v135, v137
    v_or3_b32 v129, v129, v139, v141
    v_or_b32 v129, v129, v143
    v_cmp_ne_u32 vcc, 0, v129
    s_cbranch_vccz k1_pl4
    s_sub_u32 s53, s53, 1
    s_cbranch_scc1 k1_pl4
    buffer_load_dwordx4 v[128:131], v154, s[20:23], s40 offen offset:0 sc1
    buffer_load_dwordx4 v[132:135], v154, s[20:23], s40 offen offset:1792 sc1
    buffer_load_dwordx4 v[136:139], v154, s[20:23], s41 offen offset:0 sc1
    buffer_load_dwordx4 v[140:143], v154, s[20:23], s41 offen offset:1792 sc1
    s_branch k1_pl3
k1_pl4:
    v_lshlrev_b32 v160, 16, v128
    v_and_b32 v161, 0xffff0000, v128
    v_lshlrev_b32 v162, 16, v130
    v_and_b32 v163, 0xffff0000, v130
    v_mul_f32 v164, 1035512379, v160
    v_mul_f32 v165, 1035512379, v161
    v_mul_f32 v166, 1035512379, v162
    v_mul_f32 v167, 1035512379, v163
    ds_write_b128 v156, v[164:167] offset:32
    v_lshlrev_b32 v160, 16, v132
    v_and_b32 v161, 0xffff0000, v132
    v_lshlrev_b32 v162, 16, v134
    v_and_b32 v163, 0xffff0000, v134
    v_mul_f32 v168, 1035512379, v160
    v_mul_f32 v169, 1035512379, v161
    v_mul_f32 v170, 1035512379, v162
    v_mul_f32 v171, 1035512379, v163
    ds_write_b128 v156, v[168:171] offset:1824
    v_lshlrev_b32 v160, 16, v136
    v_and_b32 v161, 0xffff0000, v136
    v_lshlrev_b32 v162, 16, v138
    v_and_b32 v163, 0xffff0000, v138
    v_mul_f32 v172, 1035512379, v160
    v_mul_f32 v173, 1035512379, v161
    v_mul_f32 v174, 1035512379, v162
    v_mul_f32 v175, 1035512379, v163
    ds_write_b128 v156, v[172:175] offset:0
    v_lshlrev_b32 v160, 16, v140
    v_and_b32 v161, 0xffff0000, v140
    v_lshlrev_b32 v162, 16, v142
    v_and_b32 v163, 0xffff0000, v142
    v_mul_f32 v176, 1035512379, v160
    v_mul_f32 v177, 1035512379, v161
    v_mul_f32 v178, 1035512379, v162
    v_mul_f32 v179, 1035512379, v163
    ds_write_b128 v156, v[176:179] offset:1792
    s_mov_b64 exec, -1
    s_add_u32 m0, s26, 33792
    s_mov_b32 s32, 524288
    buffer_load_dwordx4 v225, s[12:15], s32 offen offset:0  lds
    s_mov_b32 s32, 588784
    buffer_load_dwordx4 v225, s[12:15], s32 offen offset:1040  lds
    s_mov_b32 s32, 653280
    buffer_load_dwordx4 v225, s[12:15], s32 offen offset:2080  lds
    s_mov_b32 s32, 717776
    buffer_load_dwordx4 v225, s[12:15], s32 offen offset:3120  lds
    s_add_u32 m0, s26, 84480
    s_mov_b32 s32, 786432
    buffer_load_dwordx4 v225, s[12:15], s32 offen offset:0  lds
    s_mov_b32 s32, 850928
    buffer_load_dwordx4 v225, s[12:15], s32 offen offset:1040  lds
    s_mov_b32 s32, 915424
    buffer_load_dwordx4 v225, s[12:15], s32 offen offset:2080  lds
    s_mov_b32 s32, 979920
    buffer_load_dwordx4 v225, s[12:15], s32 offen offset:3120  lds
    s_add_u32 m0, s26, 101376
    s_mov_b32 s32, 1048576
    buffer_load_dwordx4 v225, s[12:15], s32 offen offset:0  lds
    s_mov_b32 s32, 1113072
    buffer_load_dwordx4 v225, s[12:15], s32 offen offset:1040  lds
    s_mov_b32 s32, 1177568
    buffer_load_dwordx4 v225, s[12:15], s32 offen offset:2080  lds
    s_mov_b32 s32, 1242064
    buffer_load_dwordx4 v225, s[12:15], s32 offen offset:3120  lds
    s_branch k1_pl2r
k1_modrest:
    s_mov_b64 exec, 0xffff
    v_lshlrev_b32 v120, 4, v248
    v_add_u32 v120, 154112, v120
    ds_read_b128 v[128:131], v120
    s_sub_u32 s55, s54, 56
    s_mul_i32 s46, s55, 2341
    s_lshr_b32 s46, s46, 16
    s_mul_i32 s47, s46, 28
    s_sub_u32 s47, s55, s47
    s_lshl_b32 s47, s47, 4
    s_waitcnt lgkmcnt(0)
    v_add_f32 v128, v128, v129
    v_add_f32 v130, v130, v131
    v_add_f32 v128, v128, v130
    v_cvt_pk_bf16_f32 v128, v128, v128
    v_lshlrev_b32 v128, 16, v128
    s_cmp_eq_u32 s46, 2
    s_cbranch_scc0 k1_mr1
    v_add_f32 v128, 1.0, v128
    v_cvt_pk_bf16_f32 v128, v128, v128
    v_lshlrev_b32 v128, 16, v128
k1_mr1:
    v_lshlrev_b32 v120, 2, v248
    s_lshl_b32 s49, s55, 6
    s_add_u32 s49, s49, 1842688
    buffer_store_dword v128, v120, s[20:23], s49 offen sc1
    v_add_u32 v121, s47, v248
    v_lshrrev_b32 v122, 5, v121
    v_bfe_u32 v123, v121, 2, 2
    v_lshl_add_u32 v122, v122, 2, v123
    v_lshlrev_b32 v122, 6, v122
    v_and_b32 v123, 3, v121
    v_lshl_add_u32 v122, v123, 1, v122
    v_bfe_u32 v123, v121, 4, 1
    v_lshl_add_u32 v122, v123, 3, v122
    v_lshrrev_b32 v129, 16, v128
    s_and_b32 s47, s46, 1
    s_lshr_b32 s46, s46, 1
    s_lshl_b32 s47, s47, 5
    s_lshl_b32 s46, s46, 4
    s_add_u32 s46, s46, s47
    s_add_u32 s46, s46, 1851392
    buffer_store_short v129, v122, s[20:23], s46 offen sc1
    s_mov_b64 exec, -1
    s_branch k1_nomod
k1_end:
k1_safe:
    s_waitcnt vmcnt(0) lgkmcnt(0)
    s_barrier
    s_mov_b32 s35, 1
    s_mov_b32 s27, 0
    s_mov_b32 s28, 0
    s_mov_b32 s29, 32
    s_lshr_b32 s46, s24, 1
    s_and_b32 s47, s24, 1
    s_lshl_b32 s36, s46, 14
    s_lshl_b32 s37, s47, 12
    s_add_u32 s37, s37, s36
    s_mul_i32 s36, s47, 8448
    v_lshrrev_b32 v250, 5, v248
    v_lshlrev_b32 v251, 11, v250
    v_and_b32 v246, 31, v248
    v_lshl_add_u32 v246, v246, 4, v251
    v_add_u32 v246, s37, v246
    v_lshl_add_u32 v249, v250, 7, v252
    s_add_u32 s37, s36, 33792
    v_add_u32 v249, s37, v249
    v_bfe_u32 v251, v248, 3, 1
    v_and_b32 v244, 3, v248
    v_lshl_add_u32 v244, v251, 2, v244
    v_mul_u32_u24 v244, 1056, v244
    v_bfe_u32 v251, v248, 2, 1
    v_lshl_add_u32 v244, v251, 9, v244
    v_lshrrev_b32 v250, 4, v248
    v_lshl_add_u32 v244, v250, 4, v244
    v_add_u32 v244, s36, v244
    v_mov_b32 v0, 0
    v_accvgpr_write_b32 a128, 0
    v_mov_b32 v1, 0
    v_accvgpr_write_b32 a129, 0
    v_mov_b32 v2, 0
    v_accvgpr_write_b32 a130, 0
    v_mov_b32 v3, 0
    v_accvgpr_write_b32 a131, 0
    v_mov_b32 v4, 0
    v_accvgpr_write_b32 a132, 0
    v_mov_b32 v5, 0
    v_accvgpr_write_b32 a133, 0
    v_mov_b32 v6, 0
    v_accvgpr_write_b32 a134, 0
    v_mov_b32 v7, 0
    v_accvgpr_write_b32 a135, 0
    v_mov_b32 v8, 0
    v_accvgpr_write_b32 a136, 0
    v_mov_b32 v9, 0
    v_accvgpr_write_b32 a137, 0
    v_mov_b32 v10, 0
    v_accvgpr_write_b32 a138, 0
    v_mov_b32 v11, 0
    v_accvgpr_write_b32 a139, 0
    v_mov_b32 v12, 0
    v_accvgpr_write_b32 a140, 0
    v_mov_b32 v13, 0
    v_accvgpr_write_b32 a141, 0
    v_mov_b32 v14, 0
    v_accvgpr_write_b32 a142, 0
    v_mov_b32 v15, 0
    v_accvgpr_write_b32 a143, 0
    v_mov_b32 v16, 0
    v_accvgpr_write_b32 a144, 0
    v_mov_b32 v17, 0
    v_accvgpr_write_b32 a145, 0
    v_mov_b32 v18, 0
    v_accvgpr_write_b32 a146, 0
    v_mov_b32 v19, 0
    v_accvgpr_write_b32 a147, 0
    v_mov_b32 v20, 0
    v_accvgpr_write_b32 a148, 0
    v_mov_b32 v21, 0
    v_accvgpr_write_b32 a149, 0
    v_mov_b32 v22, 0
    v_accvgpr_write_b32 a150, 0
    v_mov_b32 v23, 0
    v_accvgpr_write_b32 a151, 0
    v_mov_b32 v24, 0
    v_accvgpr_write_b32 a152, 0
    v_mov_b32 v25, 0
    v_accvgpr_write_b32 a153, 0
    v_mov_b32 v26, 0
    v_accvgpr_write_b32 a154, 0
    v_mov_b32 v27, 0
    v_accvgpr_write_b32 a155, 0
    v_mov_b32 v28, 0
    v_accvgpr_write_b32 a156, 0
    v_mov_b32 v29, 0
    v_accvgpr_write_b32 a157, 0
    v_mov_b32 v30, 0
    v_accvgpr_write_b32 a158, 0
    v_mov_b32 v31, 0
    v_accvgpr_write_b32 a159, 0
    v_mov_b32 v32, 0
    v_accvgpr_write_b32 a160, 0
    v_mov_b32 v33, 0
    v_accvgpr_write_b32 a161, 0
    v_mov_b32 v34, 0
    v_accvgpr_write_b32 a162, 0
    v_mov_b32 v35, 0
    v_accvgpr_write_b32 a163, 0
    v_mov_b32 v36, 0
    v_accvgpr_write_b32 a164, 0
    v_mov_b32 v37, 0
    v_accvgpr_write_b32 a165, 0
    v_mov_b32 v38, 0
    v_accvgpr_write_b32 a166, 0
    v_mov_b32 v39, 0
    v_accvgpr_write_b32 a167, 0
    v_mov_b32 v40, 0
    v_accvgpr_write_b32 a168, 0
    v_mov_b32 v41, 0
    v_accvgpr_write_b32 a169, 0
    v_mov_b32 v42, 0
    v_accvgpr_write_b32 a170, 0
    v_mov_b32 v43, 0
    v_accvgpr_write_b32 a171, 0
    v_mov_b32 v44, 0
    v_accvgpr_write_b32 a172, 0
    v_mov_b32 v45, 0
    v_accvgpr_write_b32 a173, 0
    v_mov_b32 v46, 0
    v_accvgpr_write_b32 a174, 0
    v_mov_b32 v47, 0
    v_accvgpr_write_b32 a175, 0
    v_mov_b32 v48, 0
    v_accvgpr_write_b32 a176, 0
    v_mov_b32 v49, 0
    v_accvgpr_write_b32 a177, 0
    v_mov_b32 v50, 0
    v_accvgpr_write_b32 a178, 0
    v_mov_b32 v51, 0
    v_accvgpr_write_b32 a179, 0
    v_mov_b32 v52, 0
    v_accvgpr_write_b32 a180, 0
    v_mov_b32 v53, 0
    v_accvgpr_write_b32 a181, 0
    v_mov_b32 v54, 0
    v_accvgpr_write_b32 a182, 0
    v_mov_b32 v55, 0
    v_accvgpr_write_b32 a183, 0
    v_mov_b32 v56, 0
    v_accvgpr_write_b32 a184, 0
    v_mov_b32 v57, 0
    v_accvgpr_write_b32 a185, 0
    v_mov_b32 v58, 0
    v_accvgpr_write_b32 a186, 0
    v_mov_b32 v59, 0
    v_accvgpr_write_b32 a187, 0
    v_mov_b32 v60, 0
    v_accvgpr_write_b32 a188, 0
    v_mov_b32 v61, 0
    v_accvgpr_write_b32 a189, 0
    v_mov_b32 v62, 0
    v_accvgpr_write_b32 a190, 0
    v_mov_b32 v63, 0
    v_accvgpr_write_b32 a191, 0
    v_mov_b32 v64, 0
    v_accvgpr_write_b32 a192, 0
    v_mov_b32 v65, 0
    v_accvgpr_write_b32 a193, 0
    v_mov_b32 v66, 0
    v_accvgpr_write_b32 a194, 0
    v_mov_b32 v67, 0
    v_accvgpr_write_b32 a195, 0
    v_mov_b32 v68, 0
    v_accvgpr_write_b32 a196, 0
    v_mov_b32 v69, 0
    v_accvgpr_write_b32 a197, 0
    v_mov_b32 v70, 0
    v_accvgpr_write_b32 a198, 0
    v_mov_b32 v71, 0
    v_accvgpr_write_b32 a199, 0
    v_mov_b32 v72, 0
    v_accvgpr_write_b32 a200, 0
    v_mov_b32 v73, 0
    v_accvgpr_write_b32 a201, 0
    v_mov_b32 v74, 0
    v_accvgpr_write_b32 a202, 0
    v_mov_b32 v75, 0
    v_accvgpr_write_b32 a203, 0
    v_mov_b32 v76, 0
    v_accvgpr_write_b32 a204, 0
    v_mov_b32 v77, 0
    v_accvgpr_write_b32 a205, 0
    v_mov_b32 v78, 0
    v_accvgpr_write_b32 a206, 0
    v_mov_b32 v79, 0
    v_accvgpr_write_b32 a207, 0
    v_mov_b32 v80, 0
    v_accvgpr_write_b32 a208, 0
    v_mov_b32 v81, 0
    v_accvgpr_write_b32 a209, 0
    v_mov_b32 v82, 0
    v_accvgpr_write_b32 a210, 0
    v_mov_b32 v83, 0
    v_accvgpr_write_b32 a211, 0
    v_mov_b32 v84, 0
    v_accvgpr_write_b32 a212, 0
    v_mov_b32 v85, 0
    v_accvgpr_write_b32 a213, 0
    v_mov_b32 v86, 0
    v_accvgpr_write_b32 a214, 0
    v_mov_b32 v87, 0
    v_accvgpr_write_b32 a215, 0
    v_mov_b32 v88, 0
    v_accvgpr_write_b32 a216, 0
    v_mov_b32 v89, 0
    v_accvgpr_write_b32 a217, 0
    v_mov_b32 v90, 0
    v_accvgpr_write_b32 a218, 0
    v_mov_b32 v91, 0
    v_accvgpr_write_b32 a219, 0
    v_mov_b32 v92, 0
    v_accvgpr_write_b32 a220, 0
    v_mov_b32 v93, 0
    v_accvgpr_write_b32 a221, 0
    v_mov_b32 v94, 0
    v_accvgpr_write_b32 a222, 0
    v_mov_b32 v95, 0
    v_accvgpr_write_b32 a223, 0
    v_mov_b32 v96, 0
    v_accvgpr_write_b32 a224, 0
    v_mov_b32 v97, 0
    v_accvgpr_write_b32 a225, 0
    v_mov_b32 v98, 0
    v_accvgpr_write_b32 a226, 0
    v_mov_b32 v99, 0
    v_accvgpr_write_b32 a227, 0
    v_mov_b32 v100, 0
    v_accvgpr_write_b32 a228, 0
    v_mov_b32 v101, 0
    v_accvgpr_write_b32 a229, 0
    v_mov_b32 v102, 0
    v_accvgpr_write_b32 a230, 0
    v_mov_b32 v103, 0
    v_accvgpr_write_b32 a231, 0
    v_mov_b32 v104, 0
    v_accvgpr_write_b32 a232, 0
    v_mov_b32 v105, 0
    v_accvgpr_write_b32 a233, 0
    v_mov_b32 v106, 0
    v_accvgpr_write_b32 a234, 0
    v_mov_b32 v107, 0
    v_accvgpr_write_b32 a235, 0
    v_mov_b32 v108, 0
    v_accvgpr_write_b32 a236, 0
    v_mov_b32 v109, 0
    v_accvgpr_write_b32 a237, 0
    v_mov_b32 v110, 0
    v_accvgpr_write_b32 a238, 0
    v_mov_b32 v111, 0
    v_accvgpr_write_b32 a239, 0
    v_mov_b32 v112, 0
    v_accvgpr_write_b32 a240, 0
    v_mov_b32 v113, 0
    v_accvgpr_write_b32 a241, 0
    v_mov_b32 v114, 0
    v_accvgpr_write_b32 a242, 0
    v_mov_b32 v115, 0
    v_accvgpr_write_b32 a243, 0
    v_mov_b32 v116, 0
    v_accvgpr_write_b32 a244, 0
    v_mov_b32 v117, 0
    v_accvgpr_write_b32 a245, 0
    v_mov_b32 v118, 0
    v_accvgpr_write_b32 a246, 0
    v_mov_b32 v119, 0
    v_accvgpr_write_b32 a247, 0
    v_mov_b32 v120, 0
    v_accvgpr_write_b32 a248, 0
    v_mov_b32 v121, 0
    v_accvgpr_write_b32 a249, 0
    v_mov_b32 v122, 0
    v_accvgpr_write_b32 a250, 0
    v_mov_b32 v123, 0
    v_accvgpr_write_b32 a251, 0
    v_mov_b32 v124, 0
    v_accvgpr_write_b32 a252, 0
    v_mov_b32 v125, 0
    v_accvgpr_write_b32 a253, 0
    v_mov_b32 v126, 0
    v_accvgpr_write_b32 a254, 0
    v_mov_b32 v127, 0
    v_accvgpr_write_b32 a255, 0
    v_mov_b32 v240, 0
    v_mov_b32 v192, 4284592614
    v_mov_b32 v241, 0
    v_mov_b32 v193, 4284592614
    v_mov_b32 v242, 0
    v_mov_b32 v194, 4284592614
    v_mov_b32 v243, 0
    v_mov_b32 v195, 4284592614
k1_safe_loop:
    s_add_u32 m0, s25, 0
    s_nop 0
    buffer_load_dwordx4 v246, s[4:7], s27 offen offset:0  lds
    s_add_u32 m0, s25, 544
    s_nop 0
    buffer_load_dwordx4 v246, s[4:7], s27 offen offset:512  lds
    s_add_u32 m0, s25, 1088
    s_nop 0
    buffer_load_dwordx4 v246, s[4:7], s27 offen offset:1024  lds
    s_add_u32 m0, s25, 1632
    s_nop 0
    buffer_load_dwordx4 v246, s[4:7], s27 offen offset:1536  lds
    s_add_u32 s27, s27, 8192
    s_add_u32 m0, s25, 16896
    s_nop 0
    buffer_load_dwordx4 v246, s[4:7], s27 offen offset:0  lds
    s_add_u32 m0, s25, 17440
    s_nop 0
    buffer_load_dwordx4 v246, s[4:7], s27 offen offset:512  lds
    s_add_u32 m0, s25, 17984
    s_nop 0
    buffer_load_dwordx4 v246, s[4:7], s27 offen offset:1024  lds
    s_add_u32 m0, s25, 18528
    s_nop 0
    buffer_load_dwordx4 v246, s[4:7], s27 offen offset:1536  lds
    s_add_u32 s27, s27, 24576
    s_add_u32 m0, s25, 50688
    s_nop 0
    buffer_load_dwordx4 v247, s[8:11], s28 offen offset:0  lds
    s_add_u32 m0, s25, 51232
    s_nop 0
    buffer_load_dwordx4 v247, s[8:11], s28 offen offset:512  lds
    s_add_u32 m0, s25, 51776
    s_nop 0
    buffer_load_dwordx4 v247, s[8:11], s28 offen offset:1024  lds
    s_add_u32 m0, s25, 52320
    s_nop 0
    buffer_load_dwordx4 v247, s[8:11], s28 offen offset:1536  lds
    s_add_u32 s28, s28, 256
    s_add_u32 m0, s25, 33792
    s_nop 0
    buffer_load_dwordx4 v247, s[8:11], s28 offen offset:0  lds
    s_add_u32 m0, s25, 34336
    s_nop 0
    buffer_load_dwordx4 v247, s[8:11], s28 offen offset:512  lds
    s_add_u32 m0, s25, 34880
    s_nop 0
    buffer_load_dwordx4 v247, s[8:11], s28 offen offset:1024  lds
    s_add_u32 m0, s25, 35424
    s_nop 0
    buffer_load_dwordx4 v247, s[8:11], s28 offen offset:1536  lds
    s_add_u32 s28, s28, 32512
    s_waitcnt vmcnt(0)
    s_barrier
    ds_read_b128 v[208:211], v244 offset:0
    ds_read_b128 v[212:215], v244 offset:64
    ds_read_b128 v[216:219], v244 offset:128
    ds_read_b128 v[220:223], v244 offset:192
    ds_read_b128 v[224:227], v244 offset:256
    ds_read_b128 v[228:231], v244 offset:320
    ds_read_b128 v[232:235], v244 offset:384
    ds_read_b128 v[236:239], v244 offset:448
    s_waitcnt lgkmcnt(7)
    v_mfma_f32_16x16x32_bf16 v[128:131], v[208:211], a[0:3], 0
    v_mfma_f32_16x16x32_bf16 v[132:135], v[208:211], a[32:35], 0
    v_mfma_f32_16x16x32_bf16 v[136:139], v[208:211], a[64:67], 0
    v_mfma_f32_16x16x32_bf16 v[140:143], v[208:211], a[96:99], 0
    s_waitcnt lgkmcnt(6)
    v_mfma_f32_16x16x32_bf16 v[128:131], v[212:215], a[4:7], v[128:131]
    v_mfma_f32_16x16x32_bf16 v[132:135], v[212:215], a[36:39], v[132:135]
    v_mfma_f32_16x16x32_bf16 v[136:139], v[212:215], a[68:71], v[136:139]
    v_mfma_f32_16x16x32_bf16 v[140:143], v[212:215], a[100:103], v[140:143]
    s_waitcnt lgkmcnt(5)
    v_mfma_f32_16x16x32_bf16 v[128:131], v[216:219], a[8:11], v[128:131]
    v_mfma_f32_16x16x32_bf16 v[132:135], v[216:219], a[40:43], v[132:135]
    v_mfma_f32_16x16x32_bf16 v[136:139], v[216:219], a[72:75], v[136:139]
    v_mfma_f32_16x16x32_bf16 v[140:143], v[216:219], a[104:107], v[140:143]
    s_waitcnt lgkmcnt(4)
    v_mfma_f32_16x16x32_bf16 v[128:131], v[220:223], a[12:15], v[128:131]
    v_mfma_f32_16x16x32_bf16 v[132:135], v[220:223], a[44:47], v[132:135]
    v_mfma_f32_16x16x32_bf16 v[136:139], v[220:223], a[76:79], v[136:139]
    v_mfma_f32_16x16x32_bf16 v[140:143], v[220:223], a[108:111], v[140:143]
    s_waitcnt lgkmcnt(3)
    v_mfma_f32_16x16x32_bf16 v[128:131], v[224:227], a[16:19], v[128:131]
    v_mfma_f32_16x16x32_bf16 v[132:135], v[224:227], a[48:51], v[132:135]
    v_mfma_f32_16x16x32_bf16 v[136:139], v[224:227], a[80:83], v[136:139]
    v_mfma_f32_16x16x32_bf16 v[140:143], v[224:227], a[112:115], v[140:143]
    s_waitcnt lgkmcnt(2)
    v_mfma_f32_16x16x32_bf16 v[128:131], v[228:231], a[20:23], v[128:131]
    v_mfma_f32_16x16x32_bf16 v[132:135], v[228:231], a[52:55], v[132:135]
    v_mfma_f32_16x16x32_bf16 v[136:139], v[228:231], a[84:87], v[136:139]
    v_mfma_f32_16x16x32_bf16 v[140:143], v[228:231], a[116:119], v[140:143]
    s_waitcnt lgkmcnt(1)
    v_mfma_f32_16x16x32_bf16 v[128:131], v[232:235], a[24:27], v[128:131]
    v_mfma_f32_16x16x32_bf16 v[132:135], v[232:235], a[56:59], v[132:135]
    v_mfma_f32_16x16x32_bf16 v[136:139], v[232:235], a[88:91], v[136:139]
    v_mfma_f32_16x16x32_bf16 v[140:143], v[232:235], a[120:123], v[140:143]
    s_waitcnt lgkmcnt(0)
    v_mfma_f32_16x16x32_bf16 v[128:131], v[236:239], a[28:31], v[128:131]
    v_mfma_f32_16x16x32_bf16 v[132:135], v[236:239], a[60:63], v[132:135]
    v_mfma_f32_16x16x32_bf16 v[136:139], v[236:239], a[92:95], v[136:139]
    v_mfma_f32_16x16x32_bf16 v[140:143], v[236:239], a[124:127], v[140:143]
    ds_read_b128 v[208:211], v244 offset:16896
    ds_read_b128 v[212:215], v244 offset:16960
    ds_read_b128 v[216:219], v244 offset:17024
    ds_read_b128 v[220:223], v244 offset:17088
    ds_read_b128 v[224:227], v244 offset:17152
    ds_read_b128 v[228:231], v244 offset:17216
    ds_read_b128 v[232:235], v244 offset:17280
    ds_read_b128 v[236:239], v244 offset:17344
    s_waitcnt lgkmcnt(7)
    v_mfma_f32_16x16x32_bf16 v[144:147], v[208:211], a[0:3], 0
    v_mfma_f32_16x16x32_bf16 v[148:151], v[208:211], a[32:35], 0
    v_mfma_f32_16x16x32_bf16 v[152:155], v[208:211], a[64:67], 0
    v_mfma_f32_16x16x32_bf16 v[156:159], v[208:211], a[96:99], 0
    s_waitcnt lgkmcnt(6)
    v_mfma_f32_16x16x32_bf16 v[144:147], v[212:215], a[4:7], v[144:147]
    v_mfma_f32_16x16x32_bf16 v[148:151], v[212:215], a[36:39], v[148:151]
    v_mfma_f32_16x16x32_bf16 v[152:155], v[212:215], a[68:71], v[152:155]
    v_mfma_f32_16x16x32_bf16 v[156:159], v[212:215], a[100:103], v[156:159]
    s_waitcnt lgkmcnt(5)
    v_mfma_f32_16x16x32_bf16 v[144:147], v[216:219], a[8:11], v[144:147]
    v_mfma_f32_16x16x32_bf16 v[148:151], v[216:219], a[40:43], v[148:151]
    v_mfma_f32_16x16x32_bf16 v[152:155], v[216:219], a[72:75], v[152:155]
    v_mfma_f32_16x16x32_bf16 v[156:159], v[216:219], a[104:107], v[156:159]
    s_waitcnt lgkmcnt(4)
    v_mfma_f32_16x16x32_bf16 v[144:147], v[220:223], a[12:15], v[144:147]
    v_mfma_f32_16x16x32_bf16 v[148:151], v[220:223], a[44:47], v[148:151]
    v_mfma_f32_16x16x32_bf16 v[152:155], v[220:223], a[76:79], v[152:155]
    v_mfma_f32_16x16x32_bf16 v[156:159], v[220:223], a[108:111], v[156:159]
    s_waitcnt lgkmcnt(3)
    v_mfma_f32_16x16x32_bf16 v[144:147], v[224:227], a[16:19], v[144:147]
    v_mfma_f32_16x16x32_bf16 v[148:151], v[224:227], a[48:51], v[148:151]
    v_mfma_f32_16x16x32_bf16 v[152:155], v[224:227], a[80:83], v[152:155]
    v_mfma_f32_16x16x32_bf16 v[156:159], v[224:227], a[112:115], v[156:159]
    s_waitcnt lgkmcnt(2)
    v_mfma_f32_16x16x32_bf16 v[144:147], v[228:231], a[20:23], v[144:147]
    v_mfma_f32_16x16x32_bf16 v[148:151], v[228:231], a[52:55], v[148:151]
    v_mfma_f32_16x16x32_bf16 v[152:155], v[228:231], a[84:87], v[152:155]
    v_mfma_f32_16x16x32_bf16 v[156:159], v[228:231], a[116:119], v[156:159]
    s_waitcnt lgkmcnt(1)
    v_mfma_f32_16x16x32_bf16 v[144:147], v[232:235], a[24:27], v[144:147]
    v_mfma_f32_16x16x32_bf16 v[148:151], v[232:235], a[56:59], v[148:151]
    v_mfma_f32_16x16x32_bf16 v[152:155], v[232:235], a[88:91], v[152:155]
    v_mfma_f32_16x16x32_bf16 v[156:159], v[232:235], a[120:123], v[156:159]
    s_waitcnt lgkmcnt(0)
    v_mfma_f32_16x16x32_bf16 v[144:147], v[236:239], a[28:31], v[144:147]
    v_mfma_f32_16x16x32_bf16 v[148:151], v[236:239], a[60:63], v[148:151]
    v_mfma_f32_16x16x32_bf16 v[152:155], v[236:239], a[92:95], v[152:155]
    v_mfma_f32_16x16x32_bf16 v[156:159], v[236:239], a[124:127], v[156:159]
    s_nop 7
    v_max3_f32 v200, v128, v129, v130
    v_max3_f32 v200, v200, v131, v144
    v_max3_f32 v200, v200, v145, v146
    v_max_f32 v200, v200, v147
    v_max3_f32 v201, v132, v133, v134
    v_max3_f32 v201, v201, v135, v148
    v_max3_f32 v201, v201, v149, v150
    v_max_f32 v201, v201, v151
    v_max3_f32 v202, v136, v137, v138
    v_max3_f32 v202, v202, v139, v152
    v_max3_f32 v202, v202, v153, v154
    v_max_f32 v202, v202, v155
    v_max3_f32 v203, v140, v141, v142
    v_max3_f32 v203, v203, v143, v156
    v_max3_f32 v203, v203, v157, v158
    v_max_f32 v203, v203, v159
    v_mov_b32 v196, v200
    v_mov_b32 v197, v201
    v_mov_b32 v198, v202
    v_mov_b32 v199, v203
    s_nop 0
    v_permlane32_swap_b32 v200, v196
    v_permlane32_swap_b32 v201, v197
    v_permlane32_swap_b32 v202, v198
    v_permlane32_swap_b32 v203, v199
    v_max_f32 v200, v200, v196
    v_max_f32 v201, v201, v197
    v_max_f32 v202, v202, v198
    v_max_f32 v203, v203, v199
    v_mov_b32 v196, v200
    v_mov_b32 v197, v201
    v_mov_b32 v198, v202
    v_mov_b32 v199, v203
    s_nop 0
    v_permlane16_swap_b32 v200, v196
    v_permlane16_swap_b32 v201, v197
    v_permlane16_swap_b32 v202, v198
    v_permlane16_swap_b32 v203, v199
    v_max_f32 v200, v200, v196
    v_max_f32 v201, v201, v197
    v_max_f32 v202, v202, v198
    v_max_f32 v203, v203, v199
    v_max_f32 v200, v200, v192
    v_max_f32 v201, v201, v193
    v_max_f32 v202, v202, v194
    v_max_f32 v203, v203, v195
    v_sub_f32 v196, v192, v200
    v_sub_f32 v197, v193, v201
    v_sub_f32 v198, v194, v202
    v_sub_f32 v199, v195, v203
    v_exp_f32 v196, v196
    v_mov_b32 v192, v200
    v_exp_f32 v197, v197
    v_mov_b32 v193, v201
    v_exp_f32 v198, v198
    v_mov_b32 v194, v202
    v_exp_f32 v199, v199
    v_mov_b32 v195, v203
    s_nop 0
    v_mul_f32 v240, v240, v196
    v_mul_f32 v0, v0, v196
    v_mul_f32 v1, v1, v196
    v_mul_f32 v2, v2, v196
    v_mul_f32 v3, v3, v196
    v_mul_f32 v4, v4, v196
    v_mul_f32 v5, v5, v196
    v_mul_f32 v6, v6, v196
    v_mul_f32 v7, v7, v196
    v_mul_f32 v8, v8, v196
    v_mul_f32 v9, v9, v196
    v_mul_f32 v10, v10, v196
    v_mul_f32 v11, v11, v196
    v_mul_f32 v12, v12, v196
    v_mul_f32 v13, v13, v196
    v_mul_f32 v14, v14, v196
    v_mul_f32 v15, v15, v196
    v_mul_f32 v16, v16, v196
    v_mul_f32 v17, v17, v196
    v_mul_f32 v18, v18, v196
    v_mul_f32 v19, v19, v196
    v_mul_f32 v20, v20, v196
    v_mul_f32 v21, v21, v196
    v_mul_f32 v22, v22, v196
    v_mul_f32 v23, v23, v196
    v_mul_f32 v24, v24, v196
    v_mul_f32 v25, v25, v196
    v_mul_f32 v26, v26, v196
    v_mul_f32 v27, v27, v196
    v_mul_f32 v28, v28, v196
    v_mul_f32 v29, v29, v196
    v_mul_f32 v30, v30, v196
    v_mul_f32 v31, v31, v196
    v_mul_f32 v32, v32, v196
    v_mul_f32 v33, v33, v196
    v_mul_f32 v34, v34, v196
    v_mul_f32 v35, v35, v196
    v_mul_f32 v36, v36, v196
    v_mul_f32 v37, v37, v196
    v_mul_f32 v38, v38, v196
    v_mul_f32 v39, v39, v196
    v_mul_f32 v40, v40, v196
    v_mul_f32 v41, v41, v196
    v_mul_f32 v42, v42, v196
    v_mul_f32 v43, v43, v196
    v_mul_f32 v44, v44, v196
    v_mul_f32 v45, v45, v196
    v_mul_f32 v46, v46, v196
    v_mul_f32 v47, v47, v196
    v_mul_f32 v48, v48, v196
    v_mul_f32 v49, v49, v196
    v_mul_f32 v50, v50, v196
    v_mul_f32 v51, v51, v196
    v_mul_f32 v52, v52, v196
    v_mul_f32 v53, v53, v196
    v_mul_f32 v54, v54, v196
    v_mul_f32 v55, v55, v196
    v_mul_f32 v56, v56, v196
    v_mul_f32 v57, v57, v196
    v_mul_f32 v58, v58, v196
    v_mul_f32 v59, v59, v196
    v_mul_f32 v60, v60, v196
    v_mul_f32 v61, v61, v196
    v_mul_f32 v62, v62, v196
    v_mul_f32 v63, v63, v196
    v_mul_f32 v241, v241, v197
    v_mul_f32 v64, v64, v197
    v_mul_f32 v65, v65, v197
    v_mul_f32 v66, v66, v197
    v_mul_f32 v67, v67, v197
    v_mul_f32 v68, v68, v197
    v_mul_f32 v69, v69, v197
    v_mul_f32 v70, v70, v197
    v_mul_f32 v71, v71, v197
    v_mul_f32 v72, v72, v197
    v_mul_f32 v73, v73, v197
    v_mul_f32 v74, v74, v197
    v_mul_f32 v75, v75, v197
    v_mul_f32 v76, v76, v197
    v_mul_f32 v77, v77, v197
    v_mul_f32 v78, v78, v197
    v_mul_f32 v79, v79, v197
    v_mul_f32 v80, v80, v197
    v_mul_f32 v81, v81, v197
    v_mul_f32 v82, v82, v197
    v_mul_f32 v83, v83, v197
    v_mul_f32 v84, v84, v197
    v_mul_f32 v85, v85, v197
    v_mul_f32 v86, v86, v197
    v_mul_f32 v87, v87, v197
    v_mul_f32 v88, v88, v197
    v_mul_f32 v89, v89, v197
    v_mul_f32 v90, v90, v197
    v_mul_f32 v91, v91, v197
    v_mul_f32 v92, v92, v197
    v_mul_f32 v93, v93, v197
    v_mul_f32 v94, v94, v197
    v_mul_f32 v95, v95, v197
    v_mul_f32 v96, v96, v197
    v_mul_f32 v97, v97, v197
    v_mul_f32 v98, v98, v197
    v_mul_f32 v99, v99, v197
    v_mul_f32 v100, v100, v197
    v_mul_f32 v101, v101, v197
    v_mul_f32 v102, v102, v197
    v_mul_f32 v103, v103, v197
    v_mul_f32 v104, v104, v197
    v_mul_f32 v105, v105, v197
    v_mul_f32 v106, v106, v197
    v_mul_f32 v107, v107, v197
    v_mul_f32 v108, v108, v197
    v_mul_f32 v109, v109, v197
    v_mul_f32 v110, v110, v197
    v_mul_f32 v111, v111, v197
    v_mul_f32 v112, v112, v197
    v_mul_f32 v113, v113, v197
    v_mul_f32 v114, v114, v197
    v_mul_f32 v115, v115, v197
    v_mul_f32 v116, v116, v197
    v_mul_f32 v117, v117, v197
    v_mul_f32 v118, v118, v197
    v_mul_f32 v119, v119, v197
    v_mul_f32 v120, v120, v197
    v_mul_f32 v121, v121, v197
    v_mul_f32 v122, v122, v197
    v_mul_f32 v123, v123, v197
    v_mul_f32 v124, v124, v197
    v_mul_f32 v125, v125, v197
    v_mul_f32 v126, v126, v197
    v_mul_f32 v127, v127, v197
    v_mul_f32 v242, v242, v198
    v_accvgpr_read_b32 v208, a128
    v_mul_f32 v208, v208, v198
    v_accvgpr_write_b32 a128, v208
    v_accvgpr_read_b32 v209, a129
    v_mul_f32 v209, v209, v198
    v_accvgpr_write_b32 a129, v209
    v_accvgpr_read_b32 v210, a130
    v_mul_f32 v210, v210, v198
    v_accvgpr_write_b32 a130, v210
    v_accvgpr_read_b32 v211, a131
    v_mul_f32 v211, v211, v198
    v_accvgpr_write_b32 a131, v211
    v_accvgpr_read_b32 v212, a132
    v_mul_f32 v212, v212, v198
    v_accvgpr_write_b32 a132, v212
    v_accvgpr_read_b32 v213, a133
    v_mul_f32 v213, v213, v198
    v_accvgpr_write_b32 a133, v213
    v_accvgpr_read_b32 v214, a134
    v_mul_f32 v214, v214, v198
    v_accvgpr_write_b32 a134, v214
    v_accvgpr_read_b32 v215, a135
    v_mul_f32 v215, v215, v198
    v_accvgpr_write_b32 a135, v215
    v_accvgpr_read_b32 v208, a136
    v_mul_f32 v208, v208, v198
    v_accvgpr_write_b32 a136, v208
    v_accvgpr_read_b32 v209, a137
    v_mul_f32 v209, v209, v198
    v_accvgpr_write_b32 a137, v209
    v_accvgpr_read_b32 v210, a138
    v_mul_f32 v210, v210, v198
    v_accvgpr_write_b32 a138, v210
    v_accvgpr_read_b32 v211, a139
    v_mul_f32 v211, v211, v198
    v_accvgpr_write_b32 a139, v211
    v_accvgpr_read_b32 v212, a140
    v_mul_f32 v212, v212, v198
    v_accvgpr_write_b32 a140, v212
    v_accvgpr_read_b32 v213, a141
    v_mul_f32 v213, v213, v198
    v_accvgpr_write_b32 a141, v213
    v_accvgpr_read_b32 v214, a142
    v_mul_f32 v214, v214, v198
    v_accvgpr_write_b32 a142, v214
    v_accvgpr_read_b32 v215, a143
    v_mul_f32 v215, v215, v198
    v_accvgpr_write_b32 a143, v215
    v_accvgpr_read_b32 v208, a144
    v_mul_f32 v208, v208, v198
    v_accvgpr_write_b32 a144, v208
    v_accvgpr_read_b32 v209, a145
    v_mul_f32 v209, v209, v198
    v_accvgpr_write_b32 a145, v209
    v_accvgpr_read_b32 v210, a146
    v_mul_f32 v210, v210, v198
    v_accvgpr_write_b32 a146, v210
    v_accvgpr_read_b32 v211, a147
    v_mul_f32 v211, v211, v198
    v_accvgpr_write_b32 a147, v211
    v_accvgpr_read_b32 v212, a148
    v_mul_f32 v212, v212, v198
    v_accvgpr_write_b32 a148, v212
    v_accvgpr_read_b32 v213, a149
    v_mul_f32 v213, v213, v198
    v_accvgpr_write_b32 a149, v213
    v_accvgpr_read_b32 v214, a150
    v_mul_f32 v214, v214, v198
    v_accvgpr_write_b32 a150, v214
    v_accvgpr_read_b32 v215, a151
    v_mul_f32 v215, v215, v198
    v_accvgpr_write_b32 a151, v215
    v_accvgpr_read_b32 v208, a152
    v_mul_f32 v208, v208, v198
    v_accvgpr_write_b32 a152, v208
    v_accvgpr_read_b32 v209, a153
    v_mul_f32 v209, v209, v198
    v_accvgpr_write_b32 a153, v209
    v_accvgpr_read_b32 v210, a154
    v_mul_f32 v210, v210, v198
    v_accvgpr_write_b32 a154, v210
    v_accvgpr_read_b32 v211, a155
    v_mul_f32 v211, v211, v198
    v_accvgpr_write_b32 a155, v211
    v_accvgpr_read_b32 v212, a156
    v_mul_f32 v212, v212, v198
    v_accvgpr_write_b32 a156, v212
    v_accvgpr_read_b32 v213, a157
    v_mul_f32 v213, v213, v198
    v_accvgpr_write_b32 a157, v213
    v_accvgpr_read_b32 v214, a158
    v_mul_f32 v214, v214, v198
    v_accvgpr_write_b32 a158, v214
    v_accvgpr_read_b32 v215, a159
    v_mul_f32 v215, v215, v198
    v_accvgpr_write_b32 a159, v215
    v_accvgpr_read_b32 v208, a160
    v_mul_f32 v208, v208, v198
    v_accvgpr_write_b32 a160, v208
    v_accvgpr_read_b32 v209, a161
    v_mul_f32 v209, v209, v198
    v_accvgpr_write_b32 a161, v209
    v_accvgpr_read_b32 v210, a162
    v_mul_f32 v210, v210, v198
    v_accvgpr_write_b32 a162, v210
    v_accvgpr_read_b32 v211, a163
    v_mul_f32 v211, v211, v198
    v_accvgpr_write_b32 a163, v211
    v_accvgpr_read_b32 v212, a164
    v_mul_f32 v212, v212, v198
    v_accvgpr_write_b32 a164, v212
    v_accvgpr_read_b32 v213, a165
    v_mul_f32 v213, v213, v198
    v_accvgpr_write_b32 a165, v213
    v_accvgpr_read_b32 v214, a166
    v_mul_f32 v214, v214, v198
    v_accvgpr_write_b32 a166, v214
    v_accvgpr_read_b32 v215, a167
    v_mul_f32 v215, v215, v198
    v_accvgpr_write_b32 a167, v215
    v_accvgpr_read_b32 v208, a168
    v_mul_f32 v208, v208, v198
    v_accvgpr_write_b32 a168, v208
    v_accvgpr_read_b32 v209, a169
    v_mul_f32 v209, v209, v198
    v_accvgpr_write_b32 a169, v209
    v_accvgpr_read_b32 v210, a170
    v_mul_f32 v210, v210, v198
    v_accvgpr_write_b32 a170, v210
    v_accvgpr_read_b32 v211, a171
    v_mul_f32 v211, v211, v198
    v_accvgpr_write_b32 a171, v211
    v_accvgpr_read_b32 v212, a172
    v_mul_f32 v212, v212, v198
    v_accvgpr_write_b32 a172, v212
    v_accvgpr_read_b32 v213, a173
    v_mul_f32 v213, v213, v198
    v_accvgpr_write_b32 a173, v213
    v_accvgpr_read_b32 v214, a174
    v_mul_f32 v214, v214, v198
    v_accvgpr_write_b32 a174, v214
    v_accvgpr_read_b32 v215, a175
    v_mul_f32 v215, v215, v198
    v_accvgpr_write_b32 a175, v215
    v_accvgpr_read_b32 v208, a176
    v_mul_f32 v208, v208, v198
    v_accvgpr_write_b32 a176, v208
    v_accvgpr_read_b32 v209, a177
    v_mul_f32 v209, v209, v198
    v_accvgpr_write_b32 a177, v209
    v_accvgpr_read_b32 v210, a178
    v_mul_f32 v210, v210, v198
    v_accvgpr_write_b32 a178, v210
    v_accvgpr_read_b32 v211, a179
    v_mul_f32 v211, v211, v198
    v_accvgpr_write_b32 a179, v211
    v_accvgpr_read_b32 v212, a180
    v_mul_f32 v212, v212, v198
    v_accvgpr_write_b32 a180, v212
    v_accvgpr_read_b32 v213, a181
    v_mul_f32 v213, v213, v198
    v_accvgpr_write_b32 a181, v213
    v_accvgpr_read_b32 v214, a182
    v_mul_f32 v214, v214, v198
    v_accvgpr_write_b32 a182, v214
    v_accvgpr_read_b32 v215, a183
    v_mul_f32 v215, v215, v198
    v_accvgpr_write_b32 a183, v215
    v_accvgpr_read_b32 v208, a184
    v_mul_f32 v208, v208, v198
    v_accvgpr_write_b32 a184, v208
    v_accvgpr_read_b32 v209, a185
    v_mul_f32 v209, v209, v198
    v_accvgpr_write_b32 a185, v209
    v_accvgpr_read_b32 v210, a186
    v_mul_f32 v210, v210, v198
    v_accvgpr_write_b32 a186, v210
    v_accvgpr_read_b32 v211, a187
    v_mul_f32 v211, v211, v198
    v_accvgpr_write_b32 a187, v211
    v_accvgpr_read_b32 v212, a188
    v_mul_f32 v212, v212, v198
    v_accvgpr_write_b32 a188, v212
    v_accvgpr_read_b32 v213, a189
    v_mul_f32 v213, v213, v198
    v_accvgpr_write_b32 a189, v213
    v_accvgpr_read_b32 v214, a190
    v_mul_f32 v214, v214, v198
    v_accvgpr_write_b32 a190, v214
    v_accvgpr_read_b32 v215, a191
    v_mul_f32 v215, v215, v198
    v_accvgpr_write_b32 a191, v215
    v_mul_f32 v243, v243, v199
    v_accvgpr_read_b32 v208, a192
    v_mul_f32 v208, v208, v199
    v_accvgpr_write_b32 a192, v208
    v_accvgpr_read_b32 v209, a193
    v_mul_f32 v209, v209, v199
    v_accvgpr_write_b32 a193, v209
    v_accvgpr_read_b32 v210, a194
    v_mul_f32 v210, v210, v199
    v_accvgpr_write_b32 a194, v210
    v_accvgpr_read_b32 v211, a195
    v_mul_f32 v211, v211, v199
    v_accvgpr_write_b32 a195, v211
    v_accvgpr_read_b32 v212, a196
    v_mul_f32 v212, v212, v199
    v_accvgpr_write_b32 a196, v212
    v_accvgpr_read_b32 v213, a197
    v_mul_f32 v213, v213, v199
    v_accvgpr_write_b32 a197, v213
    v_accvgpr_read_b32 v214, a198
    v_mul_f32 v214, v214, v199
    v_accvgpr_write_b32 a198, v214
    v_accvgpr_read_b32 v215, a199
    v_mul_f32 v215, v215, v199
    v_accvgpr_write_b32 a199, v215
    v_accvgpr_read_b32 v208, a200
    v_mul_f32 v208, v208, v199
    v_accvgpr_write_b32 a200, v208
    v_accvgpr_read_b32 v209, a201
    v_mul_f32 v209, v209, v199
    v_accvgpr_write_b32 a201, v209
    v_accvgpr_read_b32 v210, a202
    v_mul_f32 v210, v210, v199
    v_accvgpr_write_b32 a202, v210
    v_accvgpr_read_b32 v211, a203
    v_mul_f32 v211, v211, v199
    v_accvgpr_write_b32 a203, v211
    v_accvgpr_read_b32 v212, a204
    v_mul_f32 v212, v212, v199
    v_accvgpr_write_b32 a204, v212
    v_accvgpr_read_b32 v213, a205
    v_mul_f32 v213, v213, v199
    v_accvgpr_write_b32 a205, v213
    v_accvgpr_read_b32 v214, a206
    v_mul_f32 v214, v214, v199
    v_accvgpr_write_b32 a206, v214
    v_accvgpr_read_b32 v215, a207
    v_mul_f32 v215, v215, v199
    v_accvgpr_write_b32 a207, v215
    v_accvgpr_read_b32 v208, a208
    v_mul_f32 v208, v208, v199
    v_accvgpr_write_b32 a208, v208
    v_accvgpr_read_b32 v209, a209
    v_mul_f32 v209, v209, v199
    v_accvgpr_write_b32 a209, v209
    v_accvgpr_read_b32 v210, a210
    v_mul_f32 v210, v210, v199
    v_accvgpr_write_b32 a210, v210
    v_accvgpr_read_b32 v211, a211
    v_mul_f32 v211, v211, v199
    v_accvgpr_write_b32 a211, v211
    v_accvgpr_read_b32 v212, a212
    v_mul_f32 v212, v212, v199
    v_accvgpr_write_b32 a212, v212
    v_accvgpr_read_b32 v213, a213
    v_mul_f32 v213, v213, v199
    v_accvgpr_write_b32 a213, v213
    v_accvgpr_read_b32 v214, a214
    v_mul_f32 v214, v214, v199
    v_accvgpr_write_b32 a214, v214
    v_accvgpr_read_b32 v215, a215
    v_mul_f32 v215, v215, v199
    v_accvgpr_write_b32 a215, v215
    v_accvgpr_read_b32 v208, a216
    v_mul_f32 v208, v208, v199
    v_accvgpr_write_b32 a216, v208
    v_accvgpr_read_b32 v209, a217
    v_mul_f32 v209, v209, v199
    v_accvgpr_write_b32 a217, v209
    v_accvgpr_read_b32 v210, a218
    v_mul_f32 v210, v210, v199
    v_accvgpr_write_b32 a218, v210
    v_accvgpr_read_b32 v211, a219
    v_mul_f32 v211, v211, v199
    v_accvgpr_write_b32 a219, v211
    v_accvgpr_read_b32 v212, a220
    v_mul_f32 v212, v212, v199
    v_accvgpr_write_b32 a220, v212
    v_accvgpr_read_b32 v213, a221
    v_mul_f32 v213, v213, v199
    v_accvgpr_write_b32 a221, v213
    v_accvgpr_read_b32 v214, a222
    v_mul_f32 v214, v214, v199
    v_accvgpr_write_b32 a222, v214
    v_accvgpr_read_b32 v215, a223
    v_mul_f32 v215, v215, v199
    v_accvgpr_write_b32 a223, v215
    v_accvgpr_read_b32 v208, a224
    v_mul_f32 v208, v208, v199
    v_accvgpr_write_b32 a224, v208
    v_accvgpr_read_b32 v209, a225
    v_mul_f32 v209, v209, v199
    v_accvgpr_write_b32 a225, v209
    v_accvgpr_read_b32 v210, a226
    v_mul_f32 v210, v210, v199
    v_accvgpr_write_b32 a226, v210
    v_accvgpr_read_b32 v211, a227
    v_mul_f32 v211, v211, v199
    v_accvgpr_write_b32 a227, v211
    v_accvgpr_read_b32 v212, a228
    v_mul_f32 v212, v212, v199
    v_accvgpr_write_b32 a228, v212
    v_accvgpr_read_b32 v213, a229
    v_mul_f32 v213, v213, v199
    v_accvgpr_write_b32 a229, v213
    v_accvgpr_read_b32 v214, a230
    v_mul_f32 v214, v214, v199
    v_accvgpr_write_b32 a230, v214
    v_accvgpr_read_b32 v215, a231
    v_mul_f32 v215, v215, v199
    v_accvgpr_write_b32 a231, v215
    v_accvgpr_read_b32 v208, a232
    v_mul_f32 v208, v208, v199
    v_accvgpr_write_b32 a232, v208
    v_accvgpr_read_b32 v209, a233
    v_mul_f32 v209, v209, v199
    v_accvgpr_write_b32 a233, v209
    v_accvgpr_read_b32 v210, a234
    v_mul_f32 v210, v210, v199
    v_accvgpr_write_b32 a234, v210
    v_accvgpr_read_b32 v211, a235
    v_mul_f32 v211, v211, v199
    v_accvgpr_write_b32 a235, v211
    v_accvgpr_read_b32 v212, a236
    v_mul_f32 v212, v212, v199
    v_accvgpr_write_b32 a236, v212
    v_accvgpr_read_b32 v213, a237
    v_mul_f32 v213, v213, v199
    v_accvgpr_write_b32 a237, v213
    v_accvgpr_read_b32 v214, a238
    v_mul_f32 v214, v214, v199
    v_accvgpr_write_b32 a238, v214
    v_accvgpr_read_b32 v215, a239
    v_mul_f32 v215, v215, v199
    v_accvgpr_write_b32 a239, v215
    v_accvgpr_read_b32 v208, a240
    v_mul_f32 v208, v208, v199
    v_accvgpr_write_b32 a240, v208
    v_accvgpr_read_b32 v209, a241
    v_mul_f32 v209, v209, v199
    v_accvgpr_write_b32 a241, v209
    v_accvgpr_read_b32 v210, a242
    v_mul_f32 v210, v210, v199
    v_accvgpr_write_b32 a242, v210
    v_accvgpr_read_b32 v211, a243
    v_mul_f32 v211, v211, v199
    v_accvgpr_write_b32 a243, v211
    v_accvgpr_read_b32 v212, a244
    v_mul_f32 v212, v212, v199
    v_accvgpr_write_b32 a244, v212
    v_accvgpr_read_b32 v213, a245
    v_mul_f32 v213, v213, v199
    v_accvgpr_write_b32 a245, v213
    v_accvgpr_read_b32 v214, a246
    v_mul_f32 v214, v214, v199
    v_accvgpr_write_b32 a246, v214
    v_accvgpr_read_b32 v215, a247
    v_mul_f32 v215, v215, v199
    v_accvgpr_write_b32 a247, v215
    v_accvgpr_read_b32 v208, a248
    v_mul_f32 v208, v208, v199
    v_accvgpr_write_b32 a248, v208
    v_accvgpr_read_b32 v209, a249
    v_mul_f32 v209, v209, v199
    v_accvgpr_write_b32 a249, v209
    v_accvgpr_read_b32 v210, a250
    v_mul_f32 v210, v210, v199
    v_accvgpr_write_b32 a250, v210
    v_accvgpr_read_b32 v211, a251
    v_mul_f32 v211, v211, v199
    v_accvgpr_write_b32 a251, v211
    v_accvgpr_read_b32 v212, a252
    v_mul_f32 v212, v212, v199
    v_accvgpr_write_b32 a252, v212
    v_accvgpr_read_b32 v213, a253
    v_mul_f32 v213, v213, v199
    v_accvgpr_write_b32 a253, v213
    v_accvgpr_read_b32 v214, a254
    v_mul_f32 v214, v214, v199
    v_accvgpr_write_b32 a254, v214
    v_accvgpr_read_b32 v215, a255
    v_mul_f32 v215, v215, v199
    v_accvgpr_write_b32 a255, v215
    v_sub_f32 v128, v128, v192
    v_sub_f32 v129, v129, v192
    v_sub_f32 v130, v130, v192
    v_sub_f32 v131, v131, v192
    v_sub_f32 v132, v132, v193
    v_sub_f32 v133, v133, v193
    v_sub_f32 v134, v134, v193
    v_sub_f32 v135, v135, v193
    v_sub_f32 v136, v136, v194
    v_sub_f32 v137, v137, v194
    v_sub_f32 v138, v138, v194
    v_sub_f32 v139, v139, v194
    v_sub_f32 v140, v140, v195
    v_sub_f32 v141, v141, v195
    v_sub_f32 v142, v142, v195
    v_sub_f32 v143, v143, v195
    v_exp_f32 v128, v128
    v_exp_f32 v129, v129
    s_nop 0
    v_add_f32 v240, v240, v128
    s_nop 0
    v_add_f32 v240, v240, v129
    s_nop 0
    v_cvt_pk_bf16_f32 v160, v128, v129
    v_exp_f32 v130, v130
    v_exp_f32 v131, v131
    s_nop 0
    v_add_f32 v240, v240, v130
    s_nop 0
    v_add_f32 v240, v240, v131
    s_nop 0
    v_cvt_pk_bf16_f32 v161, v130, v131
    v_exp_f32 v132, v132
    v_exp_f32 v133, v133
    s_nop 0
    v_add_f32 v241, v241, v132
    s_nop 0
    v_add_f32 v241, v241, v133
    s_nop 0
    v_cvt_pk_bf16_f32 v164, v132, v133
    v_exp_f32 v134, v134
    v_exp_f32 v135, v135
    s_nop 0
    v_add_f32 v241, v241, v134
    s_nop 0
    v_add_f32 v241, v241, v135
    s_nop 0
    v_cvt_pk_bf16_f32 v165, v134, v135
    v_exp_f32 v136, v136
    v_exp_f32 v137, v137
    s_nop 0
    v_add_f32 v242, v242, v136
    s_nop 0
    v_add_f32 v242, v242, v137
    s_nop 0
    v_cvt_pk_bf16_f32 v168, v136, v137
    v_exp_f32 v138, v138
    v_exp_f32 v139, v139
    s_nop 0
    v_add_f32 v242, v242, v138
    s_nop 0
    v_add_f32 v242, v242, v139
    s_nop 0
    v_cvt_pk_bf16_f32 v169, v138, v139
    v_exp_f32 v140, v140
    v_exp_f32 v141, v141
    s_nop 0
    v_add_f32 v243, v243, v140
    s_nop 0
    v_add_f32 v243, v243, v141
    s_nop 0
    v_cvt_pk_bf16_f32 v172, v140, v141
    v_exp_f32 v142, v142
    v_exp_f32 v143, v143
    s_nop 0
    v_add_f32 v243, v243, v142
    s_nop 0
    v_add_f32 v243, v243, v143
    s_nop 0
    v_cvt_pk_bf16_f32 v173, v142, v143
    v_sub_f32 v144, v144, v192
    v_sub_f32 v145, v145, v192
    v_sub_f32 v146, v146, v192
    v_sub_f32 v147, v147, v192
    v_sub_f32 v148, v148, v193
    v_sub_f32 v149, v149, v193
    v_sub_f32 v150, v150, v193
    v_sub_f32 v151, v151, v193
    v_sub_f32 v152, v152, v194
    v_sub_f32 v153, v153, v194
    v_sub_f32 v154, v154, v194
    v_sub_f32 v155, v155, v194
    v_sub_f32 v156, v156, v195
    v_sub_f32 v157, v157, v195
    v_sub_f32 v158, v158, v195
    v_sub_f32 v159, v159, v195
    v_exp_f32 v144, v144
    v_exp_f32 v145, v145
    s_nop 0
    v_add_f32 v240, v240, v144
    s_nop 0
    v_add_f32 v240, v240, v145
    s_nop 0
    v_cvt_pk_bf16_f32 v162, v144, v145
    v_exp_f32 v146, v146
    v_exp_f32 v147, v147
    s_nop 0
    v_add_f32 v240, v240, v146
    s_nop 0
    v_add_f32 v240, v240, v147
    s_nop 0
    v_cvt_pk_bf16_f32 v163, v146, v147
    v_exp_f32 v148, v148
    v_exp_f32 v149, v149
    s_nop 0
    v_add_f32 v241, v241, v148
    s_nop 0
    v_add_f32 v241, v241, v149
    s_nop 0
    v_cvt_pk_bf16_f32 v166, v148, v149
    v_exp_f32 v150, v150
    v_exp_f32 v151, v151
    s_nop 0
    v_add_f32 v241, v241, v150
    s_nop 0
    v_add_f32 v241, v241, v151
    s_nop 0
    v_cvt_pk_bf16_f32 v167, v150, v151
    v_exp_f32 v152, v152
    v_exp_f32 v153, v153
    s_nop 0
    v_add_f32 v242, v242, v152
    s_nop 0
    v_add_f32 v242, v242, v153
    s_nop 0
    v_cvt_pk_bf16_f32 v170, v152, v153
    v_exp_f32 v154, v154
    v_exp_f32 v155, v155
    s_nop 0
    v_add_f32 v242, v242, v154
    s_nop 0
    v_add_f32 v242, v242, v155
    s_nop 0
    v_cvt_pk_bf16_f32 v171, v154, v155
    v_exp_f32 v156, v156
    v_exp_f32 v157, v157
    s_nop 0
    v_add_f32 v243, v243, v156
    s_nop 0
    v_add_f32 v243, v243, v157
    s_nop 0
    v_cvt_pk_bf16_f32 v174, v156, v157
    v_exp_f32 v158, v158
    v_exp_f32 v159, v159
    s_nop 0
    v_add_f32 v243, v243, v158
    s_nop 0
    v_add_f32 v243, v243, v159
    s_nop 0
    v_cvt_pk_bf16_f32 v175, v158, v159
    ds_read_b64_tr_b16 v[208:209], v249 offset:16896
    ds_read_b64_tr_b16 v[210:211], v249 offset:17408
    ds_read_b64_tr_b16 v[212:213], v249 offset:16928
    ds_read_b64_tr_b16 v[214:215], v249 offset:17440
    ds_read_b64_tr_b16 v[216:217], v249 offset:16960
    ds_read_b64_tr_b16 v[218:219], v249 offset:17472
    ds_read_b64_tr_b16 v[220:221], v249 offset:16992
    ds_read_b64_tr_b16 v[222:223], v249 offset:17504
    ds_read_b64_tr_b16 v[224:225], v249 offset:17024
    ds_read_b64_tr_b16 v[226:227], v249 offset:17536
    ds_read_b64_tr_b16 v[228:229], v249 offset:17056
    ds_read_b64_tr_b16 v[230:231], v249 offset:17568
    ds_read_b64_tr_b16 v[232:233], v249 offset:17088
    ds_read_b64_tr_b16 v[234:235], v249 offset:17600
    ds_read_b64_tr_b16 v[236:237], v249 offset:17120
    ds_read_b64_tr_b16 v[238:239], v249 offset:17632
    s_waitcnt lgkmcnt(14)
    v_mfma_f32_16x16x32_bf16 v[0:3], v[208:211], v[160:163], v[0:3]
    v_mfma_f32_16x16x32_bf16 v[64:67], v[208:211], v[164:167], v[64:67]
    v_mfma_f32_16x16x32_bf16 a[128:131], v[208:211], v[168:171], a[128:131]
    v_mfma_f32_16x16x32_bf16 a[192:195], v[208:211], v[172:175], a[192:195]
    s_waitcnt lgkmcnt(12)
    v_mfma_f32_16x16x32_bf16 v[4:7], v[212:215], v[160:163], v[4:7]
    v_mfma_f32_16x16x32_bf16 v[68:71], v[212:215], v[164:167], v[68:71]
    v_mfma_f32_16x16x32_bf16 a[132:135], v[212:215], v[168:171], a[132:135]
    v_mfma_f32_16x16x32_bf16 a[196:199], v[212:215], v[172:175], a[196:199]
    s_waitcnt lgkmcnt(10)
    v_mfma_f32_16x16x32_bf16 v[8:11], v[216:219], v[160:163], v[8:11]
    v_mfma_f32_16x16x32_bf16 v[72:75], v[216:219], v[164:167], v[72:75]
    v_mfma_f32_16x16x32_bf16 a[136:139], v[216:219], v[168:171], a[136:139]
    v_mfma_f32_16x16x32_bf16 a[200:203], v[216:219], v[172:175], a[200:203]
    s_waitcnt lgkmcnt(8)
    v_mfma_f32_16x16x32_bf16 v[12:15], v[220:223], v[160:163], v[12:15]
    v_mfma_f32_16x16x32_bf16 v[76:79], v[220:223], v[164:167], v[76:79]
    v_mfma_f32_16x16x32_bf16 a[140:143], v[220:223], v[168:171], a[140:143]
    v_mfma_f32_16x16x32_bf16 a[204:207], v[220:223], v[172:175], a[204:207]
    s_waitcnt lgkmcnt(6)
    v_mfma_f32_16x16x32_bf16 v[16:19], v[224:227], v[160:163], v[16:19]
    v_mfma_f32_16x16x32_bf16 v[80:83], v[224:227], v[164:167], v[80:83]
    v_mfma_f32_16x16x32_bf16 a[144:147], v[224:227], v[168:171], a[144:147]
    v_mfma_f32_16x16x32_bf16 a[208:211], v[224:227], v[172:175], a[208:211]
    s_waitcnt lgkmcnt(4)
    v_mfma_f32_16x16x32_bf16 v[20:23], v[228:231], v[160:163], v[20:23]
    v_mfma_f32_16x16x32_bf16 v[84:87], v[228:231], v[164:167], v[84:87]
    v_mfma_f32_16x16x32_bf16 a[148:151], v[228:231], v[168:171], a[148:151]
    v_mfma_f32_16x16x32_bf16 a[212:215], v[228:231], v[172:175], a[212:215]
    s_waitcnt lgkmcnt(2)
    v_mfma_f32_16x16x32_bf16 v[24:27], v[232:235], v[160:163], v[24:27]
    v_mfma_f32_16x16x32_bf16 v[88:91], v[232:235], v[164:167], v[88:91]
    v_mfma_f32_16x16x32_bf16 a[152:155], v[232:235], v[168:171], a[152:155]
    v_mfma_f32_16x16x32_bf16 a[216:219], v[232:235], v[172:175], a[216:219]
    s_waitcnt lgkmcnt(0)
    v_mfma_f32_16x16x32_bf16 v[28:31], v[236:239], v[160:163], v[28:31]
    v_mfma_f32_16x16x32_bf16 v[92:95], v[236:239], v[164:167], v[92:95]
    v_mfma_f32_16x16x32_bf16 a[156:159], v[236:239], v[168:171], a[156:159]
    v_mfma_f32_16x16x32_bf16 a[220:223], v[236:239], v[172:175], a[220:223]
    ds_read_b64_tr_b16 v[208:209], v249 offset:0
    ds_read_b64_tr_b16 v[210:211], v249 offset:512
    ds_read_b64_tr_b16 v[212:213], v249 offset:32
    ds_read_b64_tr_b16 v[214:215], v249 offset:544
    ds_read_b64_tr_b16 v[216:217], v249 offset:64
    ds_read_b64_tr_b16 v[218:219], v249 offset:576
    ds_read_b64_tr_b16 v[220:221], v249 offset:96
    ds_read_b64_tr_b16 v[222:223], v249 offset:608
    ds_read_b64_tr_b16 v[224:225], v249 offset:128
    ds_read_b64_tr_b16 v[226:227], v249 offset:640
    ds_read_b64_tr_b16 v[228:229], v249 offset:160
    ds_read_b64_tr_b16 v[230:231], v249 offset:672
    ds_read_b64_tr_b16 v[232:233], v249 offset:192
    ds_read_b64_tr_b16 v[234:235], v249 offset:704
    ds_read_b64_tr_b16 v[236:237], v249 offset:224
    ds_read_b64_tr_b16 v[238:239], v249 offset:736
    s_waitcnt lgkmcnt(14)
    v_mfma_f32_16x16x32_bf16 v[32:35], v[208:211], v[160:163], v[32:35]
    v_mfma_f32_16x16x32_bf16 v[96:99], v[208:211], v[164:167], v[96:99]
    v_mfma_f32_16x16x32_bf16 a[160:163], v[208:211], v[168:171], a[160:163]
    v_mfma_f32_16x16x32_bf16 a[224:227], v[208:211], v[172:175], a[224:227]
    s_waitcnt lgkmcnt(12)
    v_mfma_f32_16x16x32_bf16 v[36:39], v[212:215], v[160:163], v[36:39]
    v_mfma_f32_16x16x32_bf16 v[100:103], v[212:215], v[164:167], v[100:103]
    v_mfma_f32_16x16x32_bf16 a[164:167], v[212:215], v[168:171], a[164:167]
    v_mfma_f32_16x16x32_bf16 a[228:231], v[212:215], v[172:175], a[228:231]
    s_waitcnt lgkmcnt(10)
    v_mfma_f32_16x16x32_bf16 v[40:43], v[216:219], v[160:163], v[40:43]
    v_mfma_f32_16x16x32_bf16 v[104:107], v[216:219], v[164:167], v[104:107]
    v_mfma_f32_16x16x32_bf16 a[168:171], v[216:219], v[168:171], a[168:171]
    v_mfma_f32_16x16x32_bf16 a[232:235], v[216:219], v[172:175], a[232:235]
    s_waitcnt lgkmcnt(8)
    v_mfma_f32_16x16x32_bf16 v[44:47], v[220:223], v[160:163], v[44:47]
    v_mfma_f32_16x16x32_bf16 v[108:111], v[220:223], v[164:167], v[108:111]
    v_mfma_f32_16x16x32_bf16 a[172:175], v[220:223], v[168:171], a[172:175]
    v_mfma_f32_16x16x32_bf16 a[236:239], v[220:223], v[172:175], a[236:239]
    s_waitcnt lgkmcnt(6)
    v_mfma_f32_16x16x32_bf16 v[48:51], v[224:227], v[160:163], v[48:51]
    v_mfma_f32_16x16x32_bf16 v[112:115], v[224:227], v[164:167], v[112:115]
    v_mfma_f32_16x16x32_bf16 a[176:179], v[224:227], v[168:171], a[176:179]
    v_mfma_f32_16x16x32_bf16 a[240:243], v[224:227], v[172:175], a[240:243]
    s_waitcnt lgkmcnt(4)
    v_mfma_f32_16x16x32_bf16 v[52:55], v[228:231], v[160:163], v[52:55]
    v_mfma_f32_16x16x32_bf16 v[116:119], v[228:231], v[164:167], v[116:119]
    v_mfma_f32_16x16x32_bf16 a[180:183], v[228:231], v[168:171], a[180:183]
    v_mfma_f32_16x16x32_bf16 a[244:247], v[228:231], v[172:175], a[244:247]
    s_waitcnt lgkmcnt(2)
    v_mfma_f32_16x16x32_bf16 v[56:59], v[232:235], v[160:163], v[56:59]
    v_mfma_f32_16x16x32_bf16 v[120:123], v[232:235], v[164:167], v[120:123]
    v_mfma_f32_16x16x32_bf16 a[184:187], v[232:235], v[168:171], a[184:187]
    v_mfma_f32_16x16x32_bf16 a[248:251], v[232:235], v[172:175], a[248:251]
    s_waitcnt lgkmcnt(0)
    v_mfma_f32_16x16x32_bf16 v[60:63], v[236:239], v[160:163], v[60:63]
    v_mfma_f32_16x16x32_bf16 v[124:127], v[236:239], v[164:167], v[124:127]
    v_mfma_f32_16x16x32_bf16 a[188:191], v[236:239], v[168:171], a[188:191]
    v_mfma_f32_16x16x32_bf16 a[252:255], v[236:239], v[172:175], a[252:255]
    s_nop 7
    s_barrier
    s_sub_u32 s29, s29, 1
    s_cmp_lg_u32 s29, 0
    s_cbranch_scc1 k1_safe_loop
    ds_write_b128 v253, v[192:195]
    s_waitcnt lgkmcnt(0)
    s_barrier
    ds_read_b128 v[196:199], v254
    s_waitcnt lgkmcnt(0)
    v_mov_b32 v200, v198
    v_mov_b32 v201, v199
    v_mov_b32 v202, v196
    v_mov_b32 v203, v197
    v_max_f32 v200, v200, v192
    v_max_f32 v201, v201, v193
    v_max_f32 v202, v202, v194
    v_max_f32 v203, v203, v195
    v_sub_f32 v196, v192, v200
    v_sub_f32 v197, v193, v201
    v_sub_f32 v198, v194, v202
    v_sub_f32 v199, v195, v203
    v_exp_f32 v196, v196
    v_mov_b32 v192, v200
    v_exp_f32 v197, v197
    v_mov_b32 v193, v201
    v_exp_f32 v198, v198
    v_mov_b32 v194, v202
    v_exp_f32 v199, v199
    v_mov_b32 v195, v203
    s_nop 0
    v_mul_f32 v240, v240, v196
    v_mul_f32 v0, v0, v196
    v_mul_f32 v1, v1, v196
    v_mul_f32 v2, v2, v196
    v_mul_f32 v3, v3, v196
    v_mul_f32 v4, v4, v196
    v_mul_f32 v5, v5, v196
    v_mul_f32 v6, v6, v196
    v_mul_f32 v7, v7, v196
    v_mul_f32 v8, v8, v196
    v_mul_f32 v9, v9, v196
    v_mul_f32 v10, v10, v196
    v_mul_f32 v11, v11, v196
    v_mul_f32 v12, v12, v196
    v_mul_f32 v13, v13, v196
    v_mul_f32 v14, v14, v196
    v_mul_f32 v15, v15, v196
    v_mul_f32 v16, v16, v196
    v_mul_f32 v17, v17, v196
    v_mul_f32 v18, v18, v196
    v_mul_f32 v19, v19, v196
    v_mul_f32 v20, v20, v196
    v_mul_f32 v21, v21, v196
    v_mul_f32 v22, v22, v196
    v_mul_f32 v23, v23, v196
    v_mul_f32 v24, v24, v196
    v_mul_f32 v25, v25, v196
    v_mul_f32 v26, v26, v196
    v_mul_f32 v27, v27, v196
    v_mul_f32 v28, v28, v196
    v_mul_f32 v29, v29, v196
    v_mul_f32 v30, v30, v196
    v_mul_f32 v31, v31, v196
    v_mul_f32 v32, v32, v196
    v_mul_f32 v33, v33, v196
    v_mul_f32 v34, v34, v196
    v_mul_f32 v35, v35, v196
    v_mul_f32 v36, v36, v196
    v_mul_f32 v37, v37, v196
    v_mul_f32 v38, v38, v196
    v_mul_f32 v39, v39, v196
    v_mul_f32 v40, v40, v196
    v_mul_f32 v41, v41, v196
    v_mul_f32 v42, v42, v196
    v_mul_f32 v43, v43, v196
    v_mul_f32 v44, v44, v196
    v_mul_f32 v45, v45, v196
    v_mul_f32 v46, v46, v196
    v_mul_f32 v47, v47, v196
    v_mul_f32 v48, v48, v196
    v_mul_f32 v49, v49, v196
    v_mul_f32 v50, v50, v196
    v_mul_f32 v51, v51, v196
    v_mul_f32 v52, v52, v196
    v_mul_f32 v53, v53, v196
    v_mul_f32 v54, v54, v196
    v_mul_f32 v55, v55, v196
    v_mul_f32 v56, v56, v196
    v_mul_f32 v57, v57, v196
    v_mul_f32 v58, v58, v196
    v_mul_f32 v59, v59, v196
    v_mul_f32 v60, v60, v196
    v_mul_f32 v61, v61, v196
    v_mul_f32 v62, v62, v196
    v_mul_f32 v63, v63, v196
    v_mul_f32 v241, v241, v197
    v_mul_f32 v64, v64, v197
    v_mul_f32 v65, v65, v197
    v_mul_f32 v66, v66, v197
    v_mul_f32 v67, v67, v197
    v_mul_f32 v68, v68, v197
    v_mul_f32 v69, v69, v197
    v_mul_f32 v70, v70, v197
    v_mul_f32 v71, v71, v197
    v_mul_f32 v72, v72, v197
    v_mul_f32 v73, v73, v197
    v_mul_f32 v74, v74, v197
    v_mul_f32 v75, v75, v197
    v_mul_f32 v76, v76, v197
    v_mul_f32 v77, v77, v197
    v_mul_f32 v78, v78, v197
    v_mul_f32 v79, v79, v197
    v_mul_f32 v80, v80, v197
    v_mul_f32 v81, v81, v197
    v_mul_f32 v82, v82, v197
    v_mul_f32 v83, v83, v197
    v_mul_f32 v84, v84, v197
    v_mul_f32 v85, v85, v197
    v_mul_f32 v86, v86, v197
    v_mul_f32 v87, v87, v197
    v_mul_f32 v88, v88, v197
    v_mul_f32 v89, v89, v197
    v_mul_f32 v90, v90, v197
    v_mul_f32 v91, v91, v197
    v_mul_f32 v92, v92, v197
    v_mul_f32 v93, v93, v197
    v_mul_f32 v94, v94, v197
    v_mul_f32 v95, v95, v197
    v_mul_f32 v96, v96, v197
    v_mul_f32 v97, v97, v197
    v_mul_f32 v98, v98, v197
    v_mul_f32 v99, v99, v197
    v_mul_f32 v100, v100, v197
    v_mul_f32 v101, v101, v197
    v_mul_f32 v102, v102, v197
    v_mul_f32 v103, v103, v197
    v_mul_f32 v104, v104, v197
    v_mul_f32 v105, v105, v197
    v_mul_f32 v106, v106, v197
    v_mul_f32 v107, v107, v197
    v_mul_f32 v108, v108, v197
    v_mul_f32 v109, v109, v197
    v_mul_f32 v110, v110, v197
    v_mul_f32 v111, v111, v197
    v_mul_f32 v112, v112, v197
    v_mul_f32 v113, v113, v197
    v_mul_f32 v114, v114, v197
    v_mul_f32 v115, v115, v197
    v_mul_f32 v116, v116, v197
    v_mul_f32 v117, v117, v197
    v_mul_f32 v118, v118, v197
    v_mul_f32 v119, v119, v197
    v_mul_f32 v120, v120, v197
    v_mul_f32 v121, v121, v197
    v_mul_f32 v122, v122, v197
    v_mul_f32 v123, v123, v197
    v_mul_f32 v124, v124, v197
    v_mul_f32 v125, v125, v197
    v_mul_f32 v126, v126, v197
    v_mul_f32 v127, v127, v197
    v_mul_f32 v242, v242, v198
    v_accvgpr_read_b32 v208, a128
    v_mul_f32 v208, v208, v198
    v_accvgpr_write_b32 a128, v208
    v_accvgpr_read_b32 v209, a129
    v_mul_f32 v209, v209, v198
    v_accvgpr_write_b32 a129, v209
    v_accvgpr_read_b32 v210, a130
    v_mul_f32 v210, v210, v198
    v_accvgpr_write_b32 a130, v210
    v_accvgpr_read_b32 v211, a131
    v_mul_f32 v211, v211, v198
    v_accvgpr_write_b32 a131, v211
    v_accvgpr_read_b32 v212, a132
    v_mul_f32 v212, v212, v198
    v_accvgpr_write_b32 a132, v212
    v_accvgpr_read_b32 v213, a133
    v_mul_f32 v213, v213, v198
    v_accvgpr_write_b32 a133, v213
    v_accvgpr_read_b32 v214, a134
    v_mul_f32 v214, v214, v198
    v_accvgpr_write_b32 a134, v214
    v_accvgpr_read_b32 v215, a135
    v_mul_f32 v215, v215, v198
    v_accvgpr_write_b32 a135, v215
    v_accvgpr_read_b32 v208, a136
    v_mul_f32 v208, v208, v198
    v_accvgpr_write_b32 a136, v208
    v_accvgpr_read_b32 v209, a137
    v_mul_f32 v209, v209, v198
    v_accvgpr_write_b32 a137, v209
    v_accvgpr_read_b32 v210, a138
    v_mul_f32 v210, v210, v198
    v_accvgpr_write_b32 a138, v210
    v_accvgpr_read_b32 v211, a139
    v_mul_f32 v211, v211, v198
    v_accvgpr_write_b32 a139, v211
    v_accvgpr_read_b32 v212, a140
    v_mul_f32 v212, v212, v198
    v_accvgpr_write_b32 a140, v212
    v_accvgpr_read_b32 v213, a141
    v_mul_f32 v213, v213, v198
    v_accvgpr_write_b32 a141, v213
    v_accvgpr_read_b32 v214, a142
    v_mul_f32 v214, v214, v198
    v_accvgpr_write_b32 a142, v214
    v_accvgpr_read_b32 v215, a143
    v_mul_f32 v215, v215, v198
    v_accvgpr_write_b32 a143, v215
    v_accvgpr_read_b32 v208, a144
    v_mul_f32 v208, v208, v198
    v_accvgpr_write_b32 a144, v208
    v_accvgpr_read_b32 v209, a145
    v_mul_f32 v209, v209, v198
    v_accvgpr_write_b32 a145, v209
    v_accvgpr_read_b32 v210, a146
    v_mul_f32 v210, v210, v198
    v_accvgpr_write_b32 a146, v210
    v_accvgpr_read_b32 v211, a147
    v_mul_f32 v211, v211, v198
    v_accvgpr_write_b32 a147, v211
    v_accvgpr_read_b32 v212, a148
    v_mul_f32 v212, v212, v198
    v_accvgpr_write_b32 a148, v212
    v_accvgpr_read_b32 v213, a149
    v_mul_f32 v213, v213, v198
    v_accvgpr_write_b32 a149, v213
    v_accvgpr_read_b32 v214, a150
    v_mul_f32 v214, v214, v198
    v_accvgpr_write_b32 a150, v214
    v_accvgpr_read_b32 v215, a151
    v_mul_f32 v215, v215, v198
    v_accvgpr_write_b32 a151, v215
    v_accvgpr_read_b32 v208, a152
    v_mul_f32 v208, v208, v198
    v_accvgpr_write_b32 a152, v208
    v_accvgpr_read_b32 v209, a153
    v_mul_f32 v209, v209, v198
    v_accvgpr_write_b32 a153, v209
    v_accvgpr_read_b32 v210, a154
    v_mul_f32 v210, v210, v198
    v_accvgpr_write_b32 a154, v210
    v_accvgpr_read_b32 v211, a155
    v_mul_f32 v211, v211, v198
    v_accvgpr_write_b32 a155, v211
    v_accvgpr_read_b32 v212, a156
    v_mul_f32 v212, v212, v198
    v_accvgpr_write_b32 a156, v212
    v_accvgpr_read_b32 v213, a157
    v_mul_f32 v213, v213, v198
    v_accvgpr_write_b32 a157, v213
    v_accvgpr_read_b32 v214, a158
    v_mul_f32 v214, v214, v198
    v_accvgpr_write_b32 a158, v214
    v_accvgpr_read_b32 v215, a159
    v_mul_f32 v215, v215, v198
    v_accvgpr_write_b32 a159, v215
    v_accvgpr_read_b32 v208, a160
    v_mul_f32 v208, v208, v198
    v_accvgpr_write_b32 a160, v208
    v_accvgpr_read_b32 v209, a161
    v_mul_f32 v209, v209, v198
    v_accvgpr_write_b32 a161, v209
    v_accvgpr_read_b32 v210, a162
    v_mul_f32 v210, v210, v198
    v_accvgpr_write_b32 a162, v210
    v_accvgpr_read_b32 v211, a163
    v_mul_f32 v211, v211, v198
    v_accvgpr_write_b32 a163, v211
    v_accvgpr_read_b32 v212, a164
    v_mul_f32 v212, v212, v198
    v_accvgpr_write_b32 a164, v212
    v_accvgpr_read_b32 v213, a165
    v_mul_f32 v213, v213, v198
    v_accvgpr_write_b32 a165, v213
    v_accvgpr_read_b32 v214, a166
    v_mul_f32 v214, v214, v198
    v_accvgpr_write_b32 a166, v214
    v_accvgpr_read_b32 v215, a167
    v_mul_f32 v215, v215, v198
    v_accvgpr_write_b32 a167, v215
    v_accvgpr_read_b32 v208, a168
    v_mul_f32 v208, v208, v198
    v_accvgpr_write_b32 a168, v208
    v_accvgpr_read_b32 v209, a169
    v_mul_f32 v209, v209, v198
    v_accvgpr_write_b32 a169, v209
    v_accvgpr_read_b32 v210, a170
    v_mul_f32 v210, v210, v198
    v_accvgpr_write_b32 a170, v210
    v_accvgpr_read_b32 v211, a171
    v_mul_f32 v211, v211, v198
    v_accvgpr_write_b32 a171, v211
    v_accvgpr_read_b32 v212, a172
    v_mul_f32 v212, v212, v198
    v_accvgpr_write_b32 a172, v212
    v_accvgpr_read_b32 v213, a173
    v_mul_f32 v213, v213, v198
    v_accvgpr_write_b32 a173, v213
    v_accvgpr_read_b32 v214, a174
    v_mul_f32 v214, v214, v198
    v_accvgpr_write_b32 a174, v214
    v_accvgpr_read_b32 v215, a175
    v_mul_f32 v215, v215, v198
    v_accvgpr_write_b32 a175, v215
    v_accvgpr_read_b32 v208, a176
    v_mul_f32 v208, v208, v198
    v_accvgpr_write_b32 a176, v208
    v_accvgpr_read_b32 v209, a177
    v_mul_f32 v209, v209, v198
    v_accvgpr_write_b32 a177, v209
    v_accvgpr_read_b32 v210, a178
    v_mul_f32 v210, v210, v198
    v_accvgpr_write_b32 a178, v210
    v_accvgpr_read_b32 v211, a179
    v_mul_f32 v211, v211, v198
    v_accvgpr_write_b32 a179, v211
    v_accvgpr_read_b32 v212, a180
    v_mul_f32 v212, v212, v198
    v_accvgpr_write_b32 a180, v212
    v_accvgpr_read_b32 v213, a181
    v_mul_f32 v213, v213, v198
    v_accvgpr_write_b32 a181, v213
    v_accvgpr_read_b32 v214, a182
    v_mul_f32 v214, v214, v198
    v_accvgpr_write_b32 a182, v214
    v_accvgpr_read_b32 v215, a183
    v_mul_f32 v215, v215, v198
    v_accvgpr_write_b32 a183, v215
    v_accvgpr_read_b32 v208, a184
    v_mul_f32 v208, v208, v198
    v_accvgpr_write_b32 a184, v208
    v_accvgpr_read_b32 v209, a185
    v_mul_f32 v209, v209, v198
    v_accvgpr_write_b32 a185, v209
    v_accvgpr_read_b32 v210, a186
    v_mul_f32 v210, v210, v198
    v_accvgpr_write_b32 a186, v210
    v_accvgpr_read_b32 v211, a187
    v_mul_f32 v211, v211, v198
    v_accvgpr_write_b32 a187, v211
    v_accvgpr_read_b32 v212, a188
    v_mul_f32 v212, v212, v198
    v_accvgpr_write_b32 a188, v212
    v_accvgpr_read_b32 v213, a189
    v_mul_f32 v213, v213, v198
    v_accvgpr_write_b32 a189, v213
    v_accvgpr_read_b32 v214, a190
    v_mul_f32 v214, v214, v198
    v_accvgpr_write_b32 a190, v214
    v_accvgpr_read_b32 v215, a191
    v_mul_f32 v215, v215, v198
    v_accvgpr_write_b32 a191, v215
    v_mul_f32 v243, v243, v199
    v_accvgpr_read_b32 v208, a192
    v_mul_f32 v208, v208, v199
    v_accvgpr_write_b32 a192, v208
    v_accvgpr_read_b32 v209, a193
    v_mul_f32 v209, v209, v199
    v_accvgpr_write_b32 a193, v209
    v_accvgpr_read_b32 v210, a194
    v_mul_f32 v210, v210, v199
    v_accvgpr_write_b32 a194, v210
    v_accvgpr_read_b32 v211, a195
    v_mul_f32 v211, v211, v199
    v_accvgpr_write_b32 a195, v211
    v_accvgpr_read_b32 v212, a196
    v_mul_f32 v212, v212, v199
    v_accvgpr_write_b32 a196, v212
    v_accvgpr_read_b32 v213, a197
    v_mul_f32 v213, v213, v199
    v_accvgpr_write_b32 a197, v213
    v_accvgpr_read_b32 v214, a198
    v_mul_f32 v214, v214, v199
    v_accvgpr_write_b32 a198, v214
    v_accvgpr_read_b32 v215, a199
    v_mul_f32 v215, v215, v199
    v_accvgpr_write_b32 a199, v215
    v_accvgpr_read_b32 v208, a200
    v_mul_f32 v208, v208, v199
    v_accvgpr_write_b32 a200, v208
    v_accvgpr_read_b32 v209, a201
    v_mul_f32 v209, v209, v199
    v_accvgpr_write_b32 a201, v209
    v_accvgpr_read_b32 v210, a202
    v_mul_f32 v210, v210, v199
    v_accvgpr_write_b32 a202, v210
    v_accvgpr_read_b32 v211, a203
    v_mul_f32 v211, v211, v199
    v_accvgpr_write_b32 a203, v211
    v_accvgpr_read_b32 v212, a204
    v_mul_f32 v212, v212, v199
    v_accvgpr_write_b32 a204, v212
    v_accvgpr_read_b32 v213, a205
    v_mul_f32 v213, v213, v199
    v_accvgpr_write_b32 a205, v213
    v_accvgpr_read_b32 v214, a206
    v_mul_f32 v214, v214, v199
    v_accvgpr_write_b32 a206, v214
    v_accvgpr_read_b32 v215, a207
    v_mul_f32 v215, v215, v199
    v_accvgpr_write_b32 a207, v215
    v_accvgpr_read_b32 v208, a208
    v_mul_f32 v208, v208, v199
    v_accvgpr_write_b32 a208, v208
    v_accvgpr_read_b32 v209, a209
    v_mul_f32 v209, v209, v199
    v_accvgpr_write_b32 a209, v209
    v_accvgpr_read_b32 v210, a210
    v_mul_f32 v210, v210, v199
    v_accvgpr_write_b32 a210, v210
    v_accvgpr_read_b32 v211, a211
    v_mul_f32 v211, v211, v199
    v_accvgpr_write_b32 a211, v211
    v_accvgpr_read_b32 v212, a212
    v_mul_f32 v212, v212, v199
    v_accvgpr_write_b32 a212, v212
    v_accvgpr_read_b32 v213, a213
    v_mul_f32 v213, v213, v199
    v_accvgpr_write_b32 a213, v213
    v_accvgpr_read_b32 v214, a214
    v_mul_f32 v214, v214, v199
    v_accvgpr_write_b32 a214, v214
    v_accvgpr_read_b32 v215, a215
    v_mul_f32 v215, v215, v199
    v_accvgpr_write_b32 a215, v215
    v_accvgpr_read_b32 v208, a216
    v_mul_f32 v208, v208, v199
    v_accvgpr_write_b32 a216, v208
    v_accvgpr_read_b32 v209, a217
    v_mul_f32 v209, v209, v199
    v_accvgpr_write_b32 a217, v209
    v_accvgpr_read_b32 v210, a218
    v_mul_f32 v210, v210, v199
    v_accvgpr_write_b32 a218, v210
    v_accvgpr_read_b32 v211, a219
    v_mul_f32 v211, v211, v199
    v_accvgpr_write_b32 a219, v211
    v_accvgpr_read_b32 v212, a220
    v_mul_f32 v212, v212, v199
    v_accvgpr_write_b32 a220, v212
    v_accvgpr_read_b32 v213, a221
    v_mul_f32 v213, v213, v199
    v_accvgpr_write_b32 a221, v213
    v_accvgpr_read_b32 v214, a222
    v_mul_f32 v214, v214, v199
    v_accvgpr_write_b32 a222, v214
    v_accvgpr_read_b32 v215, a223
    v_mul_f32 v215, v215, v199
    v_accvgpr_write_b32 a223, v215
    v_accvgpr_read_b32 v208, a224
    v_mul_f32 v208, v208, v199
    v_accvgpr_write_b32 a224, v208
    v_accvgpr_read_b32 v209, a225
    v_mul_f32 v209, v209, v199
    v_accvgpr_write_b32 a225, v209
    v_accvgpr_read_b32 v210, a226
    v_mul_f32 v210, v210, v199
    v_accvgpr_write_b32 a226, v210
    v_accvgpr_read_b32 v211, a227
    v_mul_f32 v211, v211, v199
    v_accvgpr_write_b32 a227, v211
    v_accvgpr_read_b32 v212, a228
    v_mul_f32 v212, v212, v199
    v_accvgpr_write_b32 a228, v212
    v_accvgpr_read_b32 v213, a229
    v_mul_f32 v213, v213, v199
    v_accvgpr_write_b32 a229, v213
    v_accvgpr_read_b32 v214, a230
    v_mul_f32 v214, v214, v199
    v_accvgpr_write_b32 a230, v214
    v_accvgpr_read_b32 v215, a231
    v_mul_f32 v215, v215, v199
    v_accvgpr_write_b32 a231, v215
    v_accvgpr_read_b32 v208, a232
    v_mul_f32 v208, v208, v199
    v_accvgpr_write_b32 a232, v208
    v_accvgpr_read_b32 v209, a233
    v_mul_f32 v209, v209, v199
    v_accvgpr_write_b32 a233, v209
    v_accvgpr_read_b32 v210, a234
    v_mul_f32 v210, v210, v199
    v_accvgpr_write_b32 a234, v210
    v_accvgpr_read_b32 v211, a235
    v_mul_f32 v211, v211, v199
    v_accvgpr_write_b32 a235, v211
    v_accvgpr_read_b32 v212, a236
    v_mul_f32 v212, v212, v199
    v_accvgpr_write_b32 a236, v212
    v_accvgpr_read_b32 v213, a237
    v_mul_f32 v213, v213, v199
    v_accvgpr_write_b32 a237, v213
    v_accvgpr_read_b32 v214, a238
    v_mul_f32 v214, v214, v199
    v_accvgpr_write_b32 a238, v214
    v_accvgpr_read_b32 v215, a239
    v_mul_f32 v215, v215, v199
    v_accvgpr_write_b32 a239, v215
    v_accvgpr_read_b32 v208, a240
    v_mul_f32 v208, v208, v199
    v_accvgpr_write_b32 a240, v208
    v_accvgpr_read_b32 v209, a241
    v_mul_f32 v209, v209, v199
    v_accvgpr_write_b32 a241, v209
    v_accvgpr_read_b32 v210, a242
    v_mul_f32 v210, v210, v199
    v_accvgpr_write_b32 a242, v210
    v_accvgpr_read_b32 v211, a243
    v_mul_f32 v211, v211, v199
    v_accvgpr_write_b32 a243, v211
    v_accvgpr_read_b32 v212, a244
    v_mul_f32 v212, v212, v199
    v_accvgpr_write_b32 a244, v212
    v_accvgpr_read_b32 v213, a245
    v_mul_f32 v213, v213, v199
    v_accvgpr_write_b32 a245, v213
    v_accvgpr_read_b32 v214, a246
    v_mul_f32 v214, v214, v199
    v_accvgpr_write_b32 a246, v214
    v_accvgpr_read_b32 v215, a247
    v_mul_f32 v215, v215, v199
    v_accvgpr_write_b32 a247, v215
    v_accvgpr_read_b32 v208, a248
    v_mul_f32 v208, v208, v199
    v_accvgpr_write_b32 a248, v208
    v_accvgpr_read_b32 v209, a249
    v_mul_f32 v209, v209, v199
    v_accvgpr_write_b32 a249, v209
    v_accvgpr_read_b32 v210, a250
    v_mul_f32 v210, v210, v199
    v_accvgpr_write_b32 a250, v210
    v_accvgpr_read_b32 v211, a251
    v_mul_f32 v211, v211, v199
    v_accvgpr_write_b32 a251, v211
    v_accvgpr_read_b32 v212, a252
    v_mul_f32 v212, v212, v199
    v_accvgpr_write_b32 a252, v212
    v_accvgpr_read_b32 v213, a253
    v_mul_f32 v213, v213, v199
    v_accvgpr_write_b32 a253, v213
    v_accvgpr_read_b32 v214, a254
    v_mul_f32 v214, v214, v199
    v_accvgpr_write_b32 a254, v214
    v_accvgpr_read_b32 v215, a255
    v_mul_f32 v215, v215, v199
    v_accvgpr_write_b32 a255, v215
    s_barrier
    s_lshl_b32 s46, s24, 14
    s_xor_b32 s47, s46, 16384
    v_lshlrev_b32 v251, 4, v248
    v_add_u32 v249, s46, v251
    v_add_u32 v250, s47, v251
    ds_write_b64 v253, v[242:243]
    ds_write_b128 v249, a[128:131] offset:0
    ds_write_b128 v249, a[132:135] offset:1024
    ds_write_b128 v249, a[136:139] offset:2048
    ds_write_b128 v249, a[140:143] offset:3072
    ds_write_b128 v249, a[144:147] offset:4096
    ds_write_b128 v249, a[148:151] offset:5120
    ds_write_b128 v249, a[152:155] offset:6144
    ds_write_b128 v249, a[156:159] offset:7168
    ds_write_b128 v249, a[192:195] offset:8192
    ds_write_b128 v249, a[196:199] offset:9216
    ds_write_b128 v249, a[200:203] offset:10240
    ds_write_b128 v249, a[204:207] offset:11264
    ds_write_b128 v249, a[208:211] offset:12288
    ds_write_b128 v249, a[212:215] offset:13312
    ds_write_b128 v249, a[216:219] offset:14336
    ds_write_b128 v249, a[220:223] offset:15360
    s_branch k1_comb
k1_slowln:
    v_mov_b32 v114, 0
    v_lshlrev_b32 v116, 16, v0
    v_and_b32 v117, 0xffff0000, v0
    v_sub_f32 v116, v116, v112
    v_sub_f32 v117, v117, v112
    v_fmac_f32 v114, v116, v116
    v_fmac_f32 v114, v117, v117
    v_lshlrev_b32 v116, 16, v1
    v_and_b32 v117, 0xffff0000, v1
    v_sub_f32 v116, v116, v112
    v_sub_f32 v117, v117, v112
    v_fmac_f32 v114, v116, v116
    v_fmac_f32 v114, v117, v117
    v_lshlrev_b32 v116, 16, v2
    v_and_b32 v117, 0xffff0000, v2
    v_sub_f32 v116, v116, v112
    v_sub_f32 v117, v117, v112
    v_fmac_f32 v114, v116, v116
    v_fmac_f32 v114, v117, v117
    v_lshlrev_b32 v116, 16, v3
    v_and_b32 v117, 0xffff0000, v3
    v_sub_f32 v116, v116, v112
    v_sub_f32 v117, v117, v112
    v_fmac_f32 v114, v116, v116
    v_fmac_f32 v114, v117, v117
    v_lshlrev_b32 v116, 16, v4
    v_and_b32 v117, 0xffff0000, v4
    v_sub_f32 v116, v116, v112
    v_sub_f32 v117, v117, v112
    v_fmac_f32 v114, v116, v116
    v_fmac_f32 v114, v117, v117
    v_lshlrev_b32 v116, 16, v5
    v_and_b32 v117, 0xffff0000, v5
    v_sub_f32 v116, v116, v112
    v_sub_f32 v117, v117, v112
    v_fmac_f32 v114, v116, v116
    v_fmac_f32 v114, v117, v117
    v_lshlrev_b32 v116, 16, v6
    v_and_b32 v117, 0xffff0000, v6
    v_sub_f32 v116, v116, v112
    v_sub_f32 v117, v117, v112
    v_fmac_f32 v114, v116, v116
    v_fmac_f32 v114, v117, v117
    v_lshlrev_b32 v116, 16, v7
    v_and_b32 v117, 0xffff0000, v7
    v_sub_f32 v116, v116, v112
    v_sub_f32 v117, v117, v112
    v_fmac_f32 v114, v116, v116
    v_fmac_f32 v114, v117, v117
    v_lshlrev_b32 v116, 16, v8
    v_and_b32 v117, 0xffff0000, v8
    v_sub_f32 v116, v116, v112
    v_sub_f32 v117, v117, v112
    v_fmac_f32 v114, v116, v116
    v_fmac_f32 v114, v117, v117
    v_lshlrev_b32 v116, 16, v9
    v_and_b32 v117, 0xffff0000, v9
    v_sub_f32 v116, v116, v112
    v_sub_f32 v117, v117, v112
    v_fmac_f32 v114, v116, v116
    v_fmac_f32 v114, v117, v117
    v_lshlrev_b32 v116, 16, v10
    v_and_b32 v117, 0xffff0000, v10
    v_sub_f32 v116, v116, v112
    v_sub_f32 v117, v117, v112
    v_fmac_f32 v114, v116, v116
    v_fmac_f32 v114, v117, v117
    v_lshlrev_b32 v116, 16, v11
    v_and_b32 v117, 0xffff0000, v11
    v_sub_f32 v116, v116, v112
    v_sub_f32 v117, v117, v112
    v_fmac_f32 v114, v116, v116
    v_fmac_f32 v114, v117, v117
    v_lshlrev_b32 v116, 16, v12
    v_and_b32 v117, 0xffff0000, v12
    v_sub_f32 v116, v116, v112
    v_sub_f32 v117, v117, v112
    v_fmac_f32 v114, v116, v116
    v_fmac_f32 v114, v117, v117
    v_lshlrev_b32 v116, 16, v13
    v_and_b32 v117, 0xffff0000, v13
    v_sub_f32 v116, v116, v112
    v_sub_f32 v117, v117, v112
    v_fmac_f32 v114, v116, v116
    v_fmac_f32 v114, v117, v117
    v_lshlrev_b32 v116, 16, v14
    v_and_b32 v117, 0xffff0000, v14
    v_sub_f32 v116, v116, v112
    v_sub_f32 v117, v117, v112
    v_fmac_f32 v114, v116, v116
    v_fmac_f32 v114, v117, v117
    v_lshlrev_b32 v116, 16, v15
    v_and_b32 v117, 0xffff0000, v15
    v_sub_f32 v116, v116, v112
    v_sub_f32 v117, v117, v112
    v_fmac_f32 v114, v116, v116
    v_fmac_f32 v114, v117, v117
    v_lshlrev_b32 v116, 16, v16
    v_and_b32 v117, 0xffff0000, v16
    v_sub_f32 v116, v116, v112
    v_sub_f32 v117, v117, v112
    v_fmac_f32 v114, v116, v116
    v_fmac_f32 v114, v117, v117
    v_lshlrev_b32 v116, 16, v17
    v_and_b32 v117, 0xffff0000, v17
    v_sub_f32 v116, v116, v112
    v_sub_f32 v117, v117, v112
    v_fmac_f32 v114, v116, v116
    v_fmac_f32 v114, v117, v117
    v_lshlrev_b32 v116, 16, v18
    v_and_b32 v117, 0xffff0000, v18
    v_sub_f32 v116, v116, v112
    v_sub_f32 v117, v117, v112
    v_fmac_f32 v114, v116, v116
    v_fmac_f32 v114, v117, v117
    v_lshlrev_b32 v116, 16, v19
    v_and_b32 v117, 0xffff0000, v19
    v_sub_f32 v116, v116, v112
    v_sub_f32 v117, v117, v112
    v_fmac_f32 v114, v116, v116
    v_fmac_f32 v114, v117, v117
    v_lshlrev_b32 v116, 16, v20
    v_and_b32 v117, 0xffff0000, v20
    v_sub_f32 v116, v116, v112
    v_sub_f32 v117, v117, v112
    v_fmac_f32 v114, v116, v116
    v_fmac_f32 v114, v117, v117
    v_lshlrev_b32 v116, 16, v21
    v_and_b32 v117, 0xffff0000, v21
    v_sub_f32 v116, v116, v112
    v_sub_f32 v117, v117, v112
    v_fmac_f32 v114, v116, v116
    v_fmac_f32 v114, v117, v117
    v_lshlrev_b32 v116, 16, v22
    v_and_b32 v117, 0xffff0000, v22
    v_sub_f32 v116, v116, v112
    v_sub_f32 v117, v117, v112
    v_fmac_f32 v114, v116, v116
    v_fmac_f32 v114, v117, v117
    v_lshlrev_b32 v116, 16, v23
    v_and_b32 v117, 0xffff0000, v23
    v_sub_f32 v116, v116, v112
    v_sub_f32 v117, v117, v112
    v_fmac_f32 v114, v116, v116
    v_fmac_f32 v114, v117, v117
    v_lshlrev_b32 v116, 16, v24
    v_and_b32 v117, 0xffff0000, v24
    v_sub_f32 v116, v116, v112
    v_sub_f32 v117, v117, v112
    v_fmac_f32 v114, v116, v116
    v_fmac_f32 v114, v117, v117
    v_lshlrev_b32 v116, 16, v25
    v_and_b32 v117, 0xffff0000, v25
    v_sub_f32 v116, v116, v112
    v_sub_f32 v117, v117, v112
    v_fmac_f32 v114, v116, v116
    v_fmac_f32 v114, v117, v117
    v_lshlrev_b32 v116, 16, v26
    v_and_b32 v117, 0xffff0000, v26
    v_sub_f32 v116, v116, v112
    v_sub_f32 v117, v117, v112
    v_fmac_f32 v114, v116, v116
    v_fmac_f32 v114, v117, v117
    v_lshlrev_b32 v116, 16, v27
    v_and_b32 v117, 0xffff0000, v27
    v_sub_f32 v116, v116, v112
    v_sub_f32 v117, v117, v112
    v_fmac_f32 v114, v116, v116
    v_fmac_f32 v114, v117, v117
    v_lshlrev_b32 v116, 16, v28
    v_and_b32 v117, 0xffff0000, v28
    v_sub_f32 v116, v116, v112
    v_sub_f32 v117, v117, v112
    v_fmac_f32 v114, v116, v116
    v_fmac_f32 v114, v117, v117
    v_lshlrev_b32 v116, 16, v29
    v_and_b32 v117, 0xffff0000, v29
    v_sub_f32 v116, v116, v112
    v_sub_f32 v117, v117, v112
    v_fmac_f32 v114, v116, v116
    v_fmac_f32 v114, v117, v117
    v_lshlrev_b32 v116, 16, v30
    v_and_b32 v117, 0xffff0000, v30
    v_sub_f32 v116, v116, v112
    v_sub_f32 v117, v117, v112
    v_fmac_f32 v114, v116, v116
    v_fmac_f32 v114, v117, v117
    v_lshlrev_b32 v116, 16, v31
    v_and_b32 v117, 0xffff0000, v31
    v_sub_f32 v116, v116, v112
    v_sub_f32 v117, v117, v112
    v_fmac_f32 v114, v116, v116
    v_fmac_f32 v114, v117, v117
    v_lshlrev_b32 v116, 16, v32
    v_and_b32 v117, 0xffff0000, v32
    v_sub_f32 v116, v116, v112
    v_sub_f32 v117, v117, v112
    v_fmac_f32 v114, v116, v116
    v_fmac_f32 v114, v117, v117
    v_lshlrev_b32 v116, 16, v33
    v_and_b32 v117, 0xffff0000, v33
    v_sub_f32 v116, v116, v112
    v_sub_f32 v117, v117, v112
    v_fmac_f32 v114, v116, v116
    v_fmac_f32 v114, v117, v117
    v_lshlrev_b32 v116, 16, v34
    v_and_b32 v117, 0xffff0000, v34
    v_sub_f32 v116, v116, v112
    v_sub_f32 v117, v117, v112
    v_fmac_f32 v114, v116, v116
    v_fmac_f32 v114, v117, v117
    v_lshlrev_b32 v116, 16, v35
    v_and_b32 v117, 0xffff0000, v35
    v_sub_f32 v116, v116, v112
    v_sub_f32 v117, v117, v112
    v_fmac_f32 v114, v116, v116
    v_fmac_f32 v114, v117, v117
    v_lshlrev_b32 v116, 16, v36
    v_and_b32 v117, 0xffff0000, v36
    v_sub_f32 v116, v116, v112
    v_sub_f32 v117, v117, v112
    v_fmac_f32 v114, v116, v116
    v_fmac_f32 v114, v117, v117
    v_lshlrev_b32 v116, 16, v37
    v_and_b32 v117, 0xffff0000, v37
    v_sub_f32 v116, v116, v112
    v_sub_f32 v117, v117, v112
    v_fmac_f32 v114, v116, v116
    v_fmac_f32 v114, v117, v117
    v_lshlrev_b32 v116, 16, v38
    v_and_b32 v117, 0xffff0000, v38
    v_sub_f32 v116, v116, v112
    v_sub_f32 v117, v117, v112
    v_fmac_f32 v114, v116, v116
    v_fmac_f32 v114, v117, v117
    v_lshlrev_b32 v116, 16, v39
    v_and_b32 v117, 0xffff0000, v39
    v_sub_f32 v116, v116, v112
    v_sub_f32 v117, v117, v112
    v_fmac_f32 v114, v116, v116
    v_fmac_f32 v114, v117, v117
    v_lshlrev_b32 v116, 16, v40
    v_and_b32 v117, 0xffff0000, v40
    v_sub_f32 v116, v116, v112
    v_sub_f32 v117, v117, v112
    v_fmac_f32 v114, v116, v116
    v_fmac_f32 v114, v117, v117
    v_lshlrev_b32 v116, 16, v41
    v_and_b32 v117, 0xffff0000, v41
    v_sub_f32 v116, v116, v112
    v_sub_f32 v117, v117, v112
    v_fmac_f32 v114, v116, v116
    v_fmac_f32 v114, v117, v117
    v_lshlrev_b32 v116, 16, v42
    v_and_b32 v117, 0xffff0000, v42
    v_sub_f32 v116, v116, v112
    v_sub_f32 v117, v117, v112
    v_fmac_f32 v114, v116, v116
    v_fmac_f32 v114, v117, v117
    v_lshlrev_b32 v116, 16, v43
    v_and_b32 v117, 0xffff0000, v43
    v_sub_f32 v116, v116, v112
    v_sub_f32 v117, v117, v112
    v_fmac_f32 v114, v116, v116
    v_fmac_f32 v114, v117, v117
    v_lshlrev_b32 v116, 16, v44
    v_and_b32 v117, 0xffff0000, v44
    v_sub_f32 v116, v116, v112
    v_sub_f32 v117, v117, v112
    v_fmac_f32 v114, v116, v116
    v_fmac_f32 v114, v117, v117
    v_lshlrev_b32 v116, 16, v45
    v_and_b32 v117, 0xffff0000, v45
    v_sub_f32 v116, v116, v112
    v_sub_f32 v117, v117, v112
    v_fmac_f32 v114, v116, v116
    v_fmac_f32 v114, v117, v117
    v_lshlrev_b32 v116, 16, v46
    v_and_b32 v117, 0xffff0000, v46
    v_sub_f32 v116, v116, v112
    v_sub_f32 v117, v117, v112
    v_fmac_f32 v114, v116, v116
    v_fmac_f32 v114, v117, v117
    v_lshlrev_b32 v116, 16, v47
    v_and_b32 v117, 0xffff0000, v47
    v_sub_f32 v116, v116, v112
    v_sub_f32 v117, v117, v112
    v_fmac_f32 v114, v116, v116
    v_fmac_f32 v114, v117, v117
    v_lshlrev_b32 v116, 16, v48
    v_and_b32 v117, 0xffff0000, v48
    v_sub_f32 v116, v116, v112
    v_sub_f32 v117, v117, v112
    v_fmac_f32 v114, v116, v116
    v_fmac_f32 v114, v117, v117
    v_lshlrev_b32 v116, 16, v49
    v_and_b32 v117, 0xffff0000, v49
    v_sub_f32 v116, v116, v112
    v_sub_f32 v117, v117, v112
    v_fmac_f32 v114, v116, v116
    v_fmac_f32 v114, v117, v117
    v_lshlrev_b32 v116, 16, v50
    v_and_b32 v117, 0xffff0000, v50
    v_sub_f32 v116, v116, v112
    v_sub_f32 v117, v117, v112
    v_fmac_f32 v114, v116, v116
    v_fmac_f32 v114, v117, v117
    v_lshlrev_b32 v116, 16, v51
    v_and_b32 v117, 0xffff0000, v51
    v_sub_f32 v116, v116, v112
    v_sub_f32 v117, v117, v112
    v_fmac_f32 v114, v116, v116
    v_fmac_f32 v114, v117, v117
    v_lshlrev_b32 v116, 16, v52
    v_and_b32 v117, 0xffff0000, v52
    v_sub_f32 v116, v116, v112
    v_sub_f32 v117, v117, v112
    v_fmac_f32 v114, v116, v116
    v_fmac_f32 v114, v117, v117
    v_lshlrev_b32 v116, 16, v53
    v_and_b32 v117, 0xffff0000, v53
    v_sub_f32 v116, v116, v112
    v_sub_f32 v117, v117, v112
    v_fmac_f32 v114, v116, v116
    v_fmac_f32 v114, v117, v117
    v_lshlrev_b32 v116, 16, v54
    v_and_b32 v117, 0xffff0000, v54
    v_sub_f32 v116, v116, v112
    v_sub_f32 v117, v117, v112
    v_fmac_f32 v114, v116, v116
    v_fmac_f32 v114, v117, v117
    v_lshlrev_b32 v116, 16, v55
    v_and_b32 v117, 0xffff0000, v55
    v_sub_f32 v116, v116, v112
    v_sub_f32 v117, v117, v112
    v_fmac_f32 v114, v116, v116
    v_fmac_f32 v114, v117, v117
    v_lshlrev_b32 v116, 16, v56
    v_and_b32 v117, 0xffff0000, v56
    v_sub_f32 v116, v116, v112
    v_sub_f32 v117, v117, v112
    v_fmac_f32 v114, v116, v116
    v_fmac_f32 v114, v117, v117
    v_lshlrev_b32 v116, 16, v57
    v_and_b32 v117, 0xffff0000, v57
    v_sub_f32 v116, v116, v112
    v_sub_f32 v117, v117, v112
    v_fmac_f32 v114, v116, v116
    v_fmac_f32 v114, v117, v117
    v_lshlrev_b32 v116, 16, v58
    v_and_b32 v117, 0xffff0000, v58
    v_sub_f32 v116, v116, v112
    v_sub_f32 v117, v117, v112
    v_fmac_f32 v114, v116, v116
    v_fmac_f32 v114, v117, v117
    v_lshlrev_b32 v116, 16, v59
    v_and_b32 v117, 0xffff0000, v59
    v_sub_f32 v116, v116, v112
    v_sub_f32 v117, v117, v112
    v_fmac_f32 v114, v116, v116
    v_fmac_f32 v114, v117, v117
    v_lshlrev_b32 v116, 16, v60
    v_and_b32 v117, 0xffff0000, v60
    v_sub_f32 v116, v116, v112
    v_sub_f32 v117, v117, v112
    v_fmac_f32 v114, v116, v116
    v_fmac_f32 v114, v117, v117
    v_lshlrev_b32 v116, 16, v61
    v_and_b32 v117, 0xffff0000, v61
    v_sub_f32 v116, v116, v112
    v_sub_f32 v117, v117, v112
    v_fmac_f32 v114, v116, v116
    v_fmac_f32 v114, v117, v117
    v_lshlrev_b32 v116, 16, v62
    v_and_b32 v117, 0xffff0000, v62
    v_sub_f32 v116, v116, v112
    v_sub_f32 v117, v117, v112
    v_fmac_f32 v114, v116, v116
    v_fmac_f32 v114, v117, v117
    v_lshlrev_b32 v116, 16, v63
    v_and_b32 v117, 0xffff0000, v63
    v_sub_f32 v116, v116, v112
    v_sub_f32 v117, v117, v112
    v_fmac_f32 v114, v116, v116
    v_fmac_f32 v114, v117, v117
    v_lshlrev_b32 v116, 16, v64
    v_and_b32 v117, 0xffff0000, v64
    v_sub_f32 v116, v116, v112
    v_sub_f32 v117, v117, v112
    v_fmac_f32 v114, v116, v116
    v_fmac_f32 v114, v117, v117
    v_lshlrev_b32 v116, 16, v65
    v_and_b32 v117, 0xffff0000, v65
    v_sub_f32 v116, v116, v112
    v_sub_f32 v117, v117, v112
    v_fmac_f32 v114, v116, v116
    v_fmac_f32 v114, v117, v117
    v_lshlrev_b32 v116, 16, v66
    v_and_b32 v117, 0xffff0000, v66
    v_sub_f32 v116, v116, v112
    v_sub_f32 v117, v117, v112
    v_fmac_f32 v114, v116, v116
    v_fmac_f32 v114, v117, v117
    v_lshlrev_b32 v116, 16, v67
    v_and_b32 v117, 0xffff0000, v67
    v_sub_f32 v116, v116, v112
    v_sub_f32 v117, v117, v112
    v_fmac_f32 v114, v116, v116
    v_fmac_f32 v114, v117, v117
    v_lshlrev_b32 v116, 16, v68
    v_and_b32 v117, 0xffff0000, v68
    v_sub_f32 v116, v116, v112
    v_sub_f32 v117, v117, v112
    v_fmac_f32 v114, v116, v116
    v_fmac_f32 v114, v117, v117
    v_lshlrev_b32 v116, 16, v69
    v_and_b32 v117, 0xffff0000, v69
    v_sub_f32 v116, v116, v112
    v_sub_f32 v117, v117, v112
    v_fmac_f32 v114, v116, v116
    v_fmac_f32 v114, v117, v117
    v_lshlrev_b32 v116, 16, v70
    v_and_b32 v117, 0xffff0000, v70
    v_sub_f32 v116, v116, v112
    v_sub_f32 v117, v117, v112
    v_fmac_f32 v114, v116, v116
    v_fmac_f32 v114, v117, v117
    v_lshlrev_b32 v116, 16, v71
    v_and_b32 v117, 0xffff0000, v71
    v_sub_f32 v116, v116, v112
    v_sub_f32 v117, v117, v112
    v_fmac_f32 v114, v116, v116
    v_fmac_f32 v114, v117, v117
    v_lshlrev_b32 v116, 16, v72
    v_and_b32 v117, 0xffff0000, v72
    v_sub_f32 v116, v116, v112
    v_sub_f32 v117, v117, v112
    v_fmac_f32 v114, v116, v116
    v_fmac_f32 v114, v117, v117
    v_lshlrev_b32 v116, 16, v73
    v_and_b32 v117, 0xffff0000, v73
    v_sub_f32 v116, v116, v112
    v_sub_f32 v117, v117, v112
    v_fmac_f32 v114, v116, v116
    v_fmac_f32 v114, v117, v117
    v_lshlrev_b32 v116, 16, v74
    v_and_b32 v117, 0xffff0000, v74
    v_sub_f32 v116, v116, v112
    v_sub_f32 v117, v117, v112
    v_fmac_f32 v114, v116, v116
    v_fmac_f32 v114, v117, v117
    v_lshlrev_b32 v116, 16, v75
    v_and_b32 v117, 0xffff0000, v75
    v_sub_f32 v116, v116, v112
    v_sub_f32 v117, v117, v112
    v_fmac_f32 v114, v116, v116
    v_fmac_f32 v114, v117, v117
    v_lshlrev_b32 v116, 16, v76
    v_and_b32 v117, 0xffff0000, v76
    v_sub_f32 v116, v116, v112
    v_sub_f32 v117, v117, v112
    v_fmac_f32 v114, v116, v116
    v_fmac_f32 v114, v117, v117
    v_lshlrev_b32 v116, 16, v77
    v_and_b32 v117, 0xffff0000, v77
    v_sub_f32 v116, v116, v112
    v_sub_f32 v117, v117, v112
    v_fmac_f32 v114, v116, v116
    v_fmac_f32 v114, v117, v117
    v_lshlrev_b32 v116, 16, v78
    v_and_b32 v117, 0xffff0000, v78
    v_sub_f32 v116, v116, v112
    v_sub_f32 v117, v117, v112
    v_fmac_f32 v114, v116, v116
    v_fmac_f32 v114, v117, v117
    v_lshlrev_b32 v116, 16, v79
    v_and_b32 v117, 0xffff0000, v79
    v_sub_f32 v116, v116, v112
    v_sub_f32 v117, v117, v112
    v_fmac_f32 v114, v116, v116
    v_fmac_f32 v114, v117, v117
    v_lshlrev_b32 v116, 16, v80
    v_and_b32 v117, 0xffff0000, v80
    v_sub_f32 v116, v116, v112
    v_sub_f32 v117, v117, v112
    v_fmac_f32 v114, v116, v116
    v_fmac_f32 v114, v117, v117
    v_lshlrev_b32 v116, 16, v81
    v_and_b32 v117, 0xffff0000, v81
    v_sub_f32 v116, v116, v112
    v_sub_f32 v117, v117, v112
    v_fmac_f32 v114, v116, v116
    v_fmac_f32 v114, v117, v117
    v_lshlrev_b32 v116, 16, v82
    v_and_b32 v117, 0xffff0000, v82
    v_sub_f32 v116, v116, v112
    v_sub_f32 v117, v117, v112
    v_fmac_f32 v114, v116, v116
    v_fmac_f32 v114, v117, v117
    v_lshlrev_b32 v116, 16, v83
    v_and_b32 v117, 0xffff0000, v83
    v_sub_f32 v116, v116, v112
    v_sub_f32 v117, v117, v112
    v_fmac_f32 v114, v116, v116
    v_fmac_f32 v114, v117, v117
    v_lshlrev_b32 v116, 16, v84
    v_and_b32 v117, 0xffff0000, v84
    v_sub_f32 v116, v116, v112
    v_sub_f32 v117, v117, v112
    v_fmac_f32 v114, v116, v116
    v_fmac_f32 v114, v117, v117
    v_lshlrev_b32 v116, 16, v85
    v_and_b32 v117, 0xffff0000, v85
    v_sub_f32 v116, v116, v112
    v_sub_f32 v117, v117, v112
    v_fmac_f32 v114, v116, v116
    v_fmac_f32 v114, v117, v117
    v_lshlrev_b32 v116, 16, v86
    v_and_b32 v117, 0xffff0000, v86
    v_sub_f32 v116, v116, v112
    v_sub_f32 v117, v117, v112
    v_fmac_f32 v114, v116, v116
    v_fmac_f32 v114, v117, v117
    v_lshlrev_b32 v116, 16, v87
    v_and_b32 v117, 0xffff0000, v87
    v_sub_f32 v116, v116, v112
    v_sub_f32 v117, v117, v112
    v_fmac_f32 v114, v116, v116
    v_fmac_f32 v114, v117, v117
    v_lshlrev_b32 v116, 16, v88
    v_and_b32 v117, 0xffff0000, v88
    v_sub_f32 v116, v116, v112
    v_sub_f32 v117, v117, v112
    v_fmac_f32 v114, v116, v116
    v_fmac_f32 v114, v117, v117
    v_lshlrev_b32 v116, 16, v89
    v_and_b32 v117, 0xffff0000, v89
    v_sub_f32 v116, v116, v112
    v_sub_f32 v117, v117, v112
    v_fmac_f32 v114, v116, v116
    v_fmac_f32 v114, v117, v117
    v_lshlrev_b32 v116, 16, v90
    v_and_b32 v117, 0xffff0000, v90
    v_sub_f32 v116, v116, v112
    v_sub_f32 v117, v117, v112
    v_fmac_f32 v114, v116, v116
    v_fmac_f32 v114, v117, v117
    v_lshlrev_b32 v116, 16, v91
    v_and_b32 v117, 0xffff0000, v91
    v_sub_f32 v116, v116, v112
    v_sub_f32 v117, v117, v112
    v_fmac_f32 v114, v116, v116
    v_fmac_f32 v114, v117, v117
    v_lshlrev_b32 v116, 16, v92
    v_and_b32 v117, 0xffff0000, v92
    v_sub_f32 v116, v116, v112
    v_sub_f32 v117, v117, v112
    v_fmac_f32 v114, v116, v116
    v_fmac_f32 v114, v117, v117
    v_lshlrev_b32 v116, 16, v93
    v_and_b32 v117, 0xffff0000, v93
    v_sub_f32 v116, v116, v112
    v_sub_f32 v117, v117, v112
    v_fmac_f32 v114, v116, v116
    v_fmac_f32 v114, v117, v117
    v_lshlrev_b32 v116, 16, v94
    v_and_b32 v117, 0xffff0000, v94
    v_sub_f32 v116, v116, v112
    v_sub_f32 v117, v117, v112
    v_fmac_f32 v114, v116, v116
    v_fmac_f32 v114, v117, v117
    v_lshlrev_b32 v116, 16, v95
    v_and_b32 v117, 0xffff0000, v95
    v_sub_f32 v116, v116, v112
    v_sub_f32 v117, v117, v112
    v_fmac_f32 v114, v116, v116
    v_fmac_f32 v114, v117, v117
    v_lshlrev_b32 v116, 16, v96
    v_and_b32 v117, 0xffff0000, v96
    v_sub_f32 v116, v116, v112
    v_sub_f32 v117, v117, v112
    v_fmac_f32 v114, v116, v116
    v_fmac_f32 v114, v117, v117
    v_lshlrev_b32 v116, 16, v97
    v_and_b32 v117, 0xffff0000, v97
    v_sub_f32 v116, v116, v112
    v_sub_f32 v117, v117, v112
    v_fmac_f32 v114, v116, v116
    v_fmac_f32 v114, v117, v117
    v_lshlrev_b32 v116, 16, v98
    v_and_b32 v117, 0xffff0000, v98
    v_sub_f32 v116, v116, v112
    v_sub_f32 v117, v117, v112
    v_fmac_f32 v114, v116, v116
    v_fmac_f32 v114, v117, v117
    v_lshlrev_b32 v116, 16, v99
    v_and_b32 v117, 0xffff0000, v99
    v_sub_f32 v116, v116, v112
    v_sub_f32 v117, v117, v112
    v_fmac_f32 v114, v116, v116
    v_fmac_f32 v114, v117, v117
    v_lshlrev_b32 v116, 16, v100
    v_and_b32 v117, 0xffff0000, v100
    v_sub_f32 v116, v116, v112
    v_sub_f32 v117, v117, v112
    v_fmac_f32 v114, v116, v116
    v_fmac_f32 v114, v117, v117
    v_lshlrev_b32 v116, 16, v101
    v_and_b32 v117, 0xffff0000, v101
    v_sub_f32 v116, v116, v112
    v_sub_f32 v117, v117, v112
    v_fmac_f32 v114, v116, v116
    v_fmac_f32 v114, v117, v117
    v_lshlrev_b32 v116, 16, v102
    v_and_b32 v117, 0xffff0000, v102
    v_sub_f32 v116, v116, v112
    v_sub_f32 v117, v117, v112
    v_fmac_f32 v114, v116, v116
    v_fmac_f32 v114, v117, v117
    v_lshlrev_b32 v116, 16, v103
    v_and_b32 v117, 0xffff0000, v103
    v_sub_f32 v116, v116, v112
    v_sub_f32 v117, v117, v112
    v_fmac_f32 v114, v116, v116
    v_fmac_f32 v114, v117, v117
    v_lshlrev_b32 v116, 16, v104
    v_and_b32 v117, 0xffff0000, v104
    v_sub_f32 v116, v116, v112
    v_sub_f32 v117, v117, v112
    v_fmac_f32 v114, v116, v116
    v_fmac_f32 v114, v117, v117
    v_lshlrev_b32 v116, 16, v105
    v_and_b32 v117, 0xffff0000, v105
    v_sub_f32 v116, v116, v112
    v_sub_f32 v117, v117, v112
    v_fmac_f32 v114, v116, v116
    v_fmac_f32 v114, v117, v117
    v_lshlrev_b32 v116, 16, v106
    v_and_b32 v117, 0xffff0000, v106
    v_sub_f32 v116, v116, v112
    v_sub_f32 v117, v117, v112
    v_fmac_f32 v114, v116, v116
    v_fmac_f32 v114, v117, v117
    v_lshlrev_b32 v116, 16, v107
    v_and_b32 v117, 0xffff0000, v107
    v_sub_f32 v116, v116, v112
    v_sub_f32 v117, v117, v112
    v_fmac_f32 v114, v116, v116
    v_fmac_f32 v114, v117, v117
    v_lshlrev_b32 v116, 16, v108
    v_and_b32 v117, 0xffff0000, v108
    v_sub_f32 v116, v116, v112
    v_sub_f32 v117, v117, v112
    v_fmac_f32 v114, v116, v116
    v_fmac_f32 v114, v117, v117
    v_lshlrev_b32 v116, 16, v109
    v_and_b32 v117, 0xffff0000, v109
    v_sub_f32 v116, v116, v112
    v_sub_f32 v117, v117, v112
    v_fmac_f32 v114, v116, v116
    v_fmac_f32 v114, v117, v117
    v_lshlrev_b32 v116, 16, v110
    v_and_b32 v117, 0xffff0000, v110
    v_sub_f32 v116, v116, v112
    v_sub_f32 v117, v117, v112
    v_fmac_f32 v114, v116, v116
    v_fmac_f32 v114, v117, v117
    v_lshlrev_b32 v116, 16, v111
    v_and_b32 v117, 0xffff0000, v111
    v_sub_f32 v116, v116, v112
    v_sub_f32 v117, v117, v112
    v_fmac_f32 v114, v116, v116
    v_fmac_f32 v114, v117, v117
    v_mov_b32 v115, v114
    s_nop 1
    v_permlane32_swap_b32 v114, v115
    v_add_f32 v114, v114, v115
    v_mul_f32 v114, 991054117, v114
    s_branch k1_lnok
.globl k2g_kernel
.p2align 8
.type k2g_kernel,@function
k2g_kernel:
    s_cmp_ge_u32 s2, 254
    s_cbranch_scc1 k2g_done
    s_load_dwordx2 s[4:5], s[0:1], 0
    s_load_dwordx2 s[6:7], s[0:1], 112
    s_load_dwordx8 s[40:47], s[0:1], 48
    s_load_dwordx2 s[10:11], s[0:1], 96
    v_lshrrev_b32 v9, 6, v0
    v_and_b32 v2, 63, v0
    v_mov_b32 v61, 1592594996
    v_readfirstlane_b32 s3, v9
    v_and_b32 v1, 15, v0
    v_lshrrev_b32 v3, 4, v2
    s_waitcnt lgkmcnt(0)
    s_mov_b32 s16, s6
    s_mov_b32 s17, s7
    s_mov_b32 s18, 268435456
    s_mov_b32 s19, 0x20000
    s_mov_b32 s24, s10
    s_mov_b32 s25, s11
    s_mov_b32 s26, 1835008
    s_mov_b32 s27, 0x20000
    s_mov_b32 s12, s4
    s_mov_b32 s13, s5
    s_mov_b32 s14, 1835008
    s_mov_b32 s15, 0x20000
    s_mov_b32 s20, s40
    s_mov_b32 s21, s41
    s_mov_b32 s22, 896
    s_mov_b32 s23, 0x20000
    s_mov_b32 s48, s42
    s_mov_b32 s49, s43
    s_mov_b32 s50, 1605632
    s_mov_b32 s51, 0x20000
    s_mov_b32 s52, s44
    s_mov_b32 s53, s45
    s_mov_b32 s54, 1605632
    s_mov_b32 s55, 0x20000
    s_mov_b32 s56, s46
    s_mov_b32 s57, s47
    s_mov_b32 s58, 1605632
    s_mov_b32 s59, 0x20000
    s_cmp_ge_u32 s2, 128
    s_cbranch_scc1 k2g_ffn
    v_lshlrev_b32 v4, 4, v2
    s_mov_b32 s69, s2
    s_lshr_b32 s28, s69, 1
    s_mul_i32 s28, s28, 28672
    s_and_b32 s29, s69, 1
    s_lshl_b32 s29, s29, 10
    s_add_u32 s28, s28, s29
    s_lshl_b32 s29, s3, 11
    s_add_u32 s28, s28, s29
    s_add_u32 s28, s28, 4194304
    v_lshlrev_b32 v5, 5, v9
    v_lshl_add_u32 v5, v3, 2, v5
    v_mul_u32_u24 v6, 896, v1
    v_lshl_add_u32 v6, v5, 1, v6
    s_mul_i32 s29, s69, 14336
    v_lshlrev_b32 v8, 1, v5
    v_lshlrev_b32 v7, 6, v3
    s_lshl_b32 s30, s3, 8
    s_add_u32 s30, s30, 1851392
    buffer_load_dwordx4 v[64:67], v4, s[16:19], s28 offen
    s_add_u32 s28, s28, 1835008
    buffer_load_dwordx4 v[68:71], v4, s[16:19], s28 offen
    s_add_u32 s28, s28, 1835008
    buffer_load_dwordx4 v[72:75], v4, s[16:19], s28 offen
    s_add_u32 s28, s28, 1835008
    buffer_load_dwordx4 v[76:79], v4, s[16:19], s28 offen
    s_add_u32 s28, s28, 1835008
    buffer_load_dwordx2 v[10:11], v6, s[12:15], s29 offen
    buffer_load_dwordx2 v[12:13], v6, s[12:15], s29 offen offset:32
    buffer_load_dwordx4 v[16:19], v7, s[16:19], s30 offen offset:0
    buffer_load_dwordx4 v[20:23], v7, s[16:19], s30 offen offset:16
    buffer_load_dwordx4 v[24:27], v7, s[16:19], s30 offen offset:32
    buffer_load_dwordx4 v[28:31], v7, s[16:19], s30 offen offset:48
    buffer_load_dwordx2 v[32:33], v8, s[20:23], 0 offen
    buffer_load_dwordx2 v[34:35], v8, s[20:23], 0 offen offset:32
    buffer_load_dwordx4 v[80:83], v4, s[16:19], s28 offen
    s_add_u32 s28, s28, 1835008
    buffer_load_dwordx4 v[84:87], v4, s[16:19], s28 offen
    s_add_u32 s28, s28, 1835008
    buffer_load_dwordx4 v[88:91], v4, s[16:19], s28 offen
    s_add_u32 s28, s28, 1835008
    buffer_load_dwordx4 v[92:95], v4, s[16:19], s28 offen
    s_add_u32 s28, s28, 1835008
    s_barrier
    buffer_load_dwordx4 v[96:99], v4, s[16:19], s28 offen
    s_add_u32 s28, s28, 1835008
    buffer_load_dwordx4 v[100:103], v4, s[16:19], s28 offen
    s_add_u32 s28, s28, 1835008
    buffer_load_dwordx4 v[104:107], v4, s[16:19], s28 offen
    s_add_u32 s28, s28, 1835008
    buffer_load_dwordx4 v[108:111], v4, s[16:19], s28 offen
    s_add_u32 s28, s28, 1835008
    buffer_load_dwordx4 v[112:115], v4, s[16:19], s28 offen
    s_add_u32 s28, s28, 1835008
    buffer_load_dwordx4 v[116:119], v4, s[16:19], s28 offen
    s_add_u32 s28, s28, 1835008
    buffer_load_dwordx4 v[120:123], v4, s[16:19], s28 offen
    s_add_u32 s28, s28, 1835008
    buffer_load_dwordx4 v[124:127], v4, s[16:19], s28 offen
    v_lshlrev_b32 v9, 2, v9
    v_lshl_add_u32 v9, v1, 6, v9
    v_lshrrev_b32 v36, 2, v1
    v_cmp_eq_u32 vcc, v36, v3
    v_and_b32 v36, 1, v1
    v_lshlrev_b32 v36, 4, v36
    v_mov_b32 v37, 0x3f80
    v_lshlrev_b32 v37, v36, v37
    v_cndmask_b32 v37, 0, v37, vcc
    v_and_b32 v36, 2, v1
    v_cmp_eq_u32 vcc, 0, v36
    s_nop 1
    v_cndmask_b32 v7, 0, v37, vcc
    v_cndmask_b32 v8, v37, 0, vcc
    v_lshlrev_b32 v3, 4, v3
    v_lshl_add_u32 v3, v1, 6, v3
    v_lshlrev_b32 v36, 6, v1
    s_lshl_b32 s30, s3, 10
    v_add_u32 v36, s30, v36
    v_mov_b32 v38, 0
    v_mov_b32 v39, 0
    s_cmp_ge_u32 s3, 7
    s_cbranch_scc1 k2g_nz
    s_mov_b64 exec, 0xffff
    ds_write_b64 v36, v[38:39] offset:56
    s_mov_b64 exec, -1
k2g_nz:
    v_mul_u32_u24 v15, 904, v1
    v_lshl_add_u32 v15, v5, 1, v15
    s_waitcnt vmcnt(12)
    v_lshlrev_b32 v40, 16, v32
    v_and_b32 v41, 0xffff0000, v32
    v_lshlrev_b32 v42, 16, v33
    v_and_b32 v43, 0xffff0000, v33
    v_lshlrev_b32 v44, 16, v34
    v_and_b32 v45, 0xffff0000, v34
    v_lshlrev_b32 v46, 16, v35
    v_and_b32 v47, 0xffff0000, v35
    v_lshlrev_b32 v50, 16, v24
    v_and_b32 v51, 0xffff0000, v24
    v_lshlrev_b32 v52, 16, v25
    v_and_b32 v53, 0xffff0000, v25
    v_lshlrev_b32 v54, 16, v26
    v_and_b32 v55, 0xffff0000, v26
    v_lshlrev_b32 v56, 16, v27
    v_and_b32 v57, 0xffff0000, v27
    v_mul_f32 v59, v50, v40
    v_fmac_f32 v59, v51, v41
    v_fmac_f32 v59, v52, v42
    v_fmac_f32 v59, v53, v43
    v_fmac_f32 v59, v54, v44
    v_fmac_f32 v59, v55, v45
    v_fmac_f32 v59, v56, v46
    v_fmac_f32 v59, v57, v47
    v_lshlrev_b32 v50, 16, v20
    v_and_b32 v51, 0xffff0000, v20
    v_lshlrev_b32 v52, 16, v21
    v_and_b32 v53, 0xffff0000, v21
    v_lshlrev_b32 v54, 16, v22
    v_and_b32 v55, 0xffff0000, v22
    v_lshlrev_b32 v56, 16, v23
    v_and_b32 v57, 0xffff0000, v23
    v_mul_f32 v40, v40, v50
    v_mul_f32 v41, v41, v51
    v_mul_f32 v42, v42, v52
    v_mul_f32 v43, v43, v53
    v_mul_f32 v44, v44, v54
    v_mul_f32 v45, v45, v55
    v_mul_f32 v46, v46, v56
    v_mul_f32 v47, v47, v57
    v_add_f32 v58, v40, v41
    v_add_f32 v58, v58, v42
    v_add_f32 v58, v58, v43
    v_add_f32 v58, v58, v44
    v_add_f32 v58, v58, v45
    v_add_f32 v58, v58, v46
    v_add_f32 v58, v58, v47
    v_mov_b32 v32, 0
    v_mov_b32 v33, 0
    v_mov_b32 v34, v7
    v_mov_b32 v35, v8
    v_mov_b32 v36, 0
    v_mov_b32 v37, 0
    v_mov_b32 v62, v58
    v_mov_b32 v63, v59
    s_nop 1
    v_permlane16_swap_b32 v58, v62
    v_permlane16_swap_b32 v59, v63
    v_add_f32 v58, v58, v62
    v_add_f32 v59, v59, v63
    v_mov_b32 v62, v58
    v_mov_b32 v63, v59
    s_nop 1
    v_permlane32_swap_b32 v58, v62
    v_permlane32_swap_b32 v59, v63
    v_add_f32 v58, v58, v62
    v_add_f32 v59, v59, v63
    s_mov_b64 exec, 0xffff
    ds_write_b32 v9, v58 offset:3072
    ds_write_b32 v9, v59 offset:4096
    s_mov_b64 exec, -1
    s_waitcnt vmcnt(12)
    v_mfma_f32_16x16x32_bf16 v[50:53], v[34:37], v[64:67], 0
    v_mfma_f32_16x16x32_bf16 v[54:57], v[32:35], v[64:67], 0
    s_waitcnt vmcnt(12)
    v_mfma_f32_16x16x32_bf16 v[50:53], v[34:37], v[68:71], v[50:53]
    v_mfma_f32_16x16x32_bf16 v[54:57], v[32:35], v[68:71], v[54:57]
    s_waitcnt vmcnt(12)
    v_mfma_f32_16x16x32_bf16 v[50:53], v[34:37], v[72:75], v[50:53]
    v_mfma_f32_16x16x32_bf16 v[54:57], v[32:35], v[72:75], v[54:57]
    s_waitcnt vmcnt(12)
    v_mfma_f32_16x16x32_bf16 v[50:53], v[34:37], v[76:79], v[50:53]
    v_mfma_f32_16x16x32_bf16 v[54:57], v[32:35], v[76:79], v[54:57]
    s_waitcnt vmcnt(11)
    v_mfma_f32_16x16x32_bf16 v[50:53], v[34:37], v[80:83], v[50:53]
    v_mfma_f32_16x16x32_bf16 v[54:57], v[32:35], v[80:83], v[54:57]
    s_waitcnt vmcnt(10)
    v_mfma_f32_16x16x32_bf16 v[50:53], v[34:37], v[84:87], v[50:53]
    v_mfma_f32_16x16x32_bf16 v[54:57], v[32:35], v[84:87], v[54:57]
    s_waitcnt vmcnt(9)
    v_mfma_f32_16x16x32_bf16 v[50:53], v[34:37], v[88:91], v[50:53]
    v_mfma_f32_16x16x32_bf16 v[54:57], v[32:35], v[88:91], v[54:57]
    s_waitcnt vmcnt(8)
    v_mfma_f32_16x16x32_bf16 v[50:53], v[34:37], v[92:95], v[50:53]
    v_mfma_f32_16x16x32_bf16 v[54:57], v[32:35], v[92:95], v[54:57]
    s_waitcnt vmcnt(7)
    v_mfma_f32_16x16x32_bf16 v[50:53], v[34:37], v[96:99], v[50:53]
    v_mfma_f32_16x16x32_bf16 v[54:57], v[32:35], v[96:99], v[54:57]
    v_lshlrev_b32 v64, 16, v10
    v_and_b32 v65, 0xffff0000, v10
    v_lshlrev_b32 v66, 16, v11
    v_and_b32 v67, 0xffff0000, v11
    v_lshlrev_b32 v68, 16, v12
    v_and_b32 v69, 0xffff0000, v12
    v_lshlrev_b32 v70, 16, v13
    v_and_b32 v71, 0xffff0000, v13
    v_lshlrev_b32 v72, 16, v16
    v_and_b32 v73, 0xffff0000, v16
    v_lshlrev_b32 v74, 16, v17
    v_and_b32 v75, 0xffff0000, v17
    v_lshlrev_b32 v76, 16, v18
    v_and_b32 v77, 0xffff0000, v18
    v_lshlrev_b32 v78, 16, v19
    v_and_b32 v79, 0xffff0000, v19
    s_waitcnt vmcnt(6)
    v_mfma_f32_16x16x32_bf16 v[50:53], v[34:37], v[100:103], v[50:53]
    v_mfma_f32_16x16x32_bf16 v[54:57], v[32:35], v[100:103], v[54:57]
    s_waitcnt vmcnt(5)
    v_mfma_f32_16x16x32_bf16 v[50:53], v[34:37], v[104:107], v[50:53]
    v_mfma_f32_16x16x32_bf16 v[54:57], v[32:35], v[104:107], v[54:57]
    s_waitcnt vmcnt(4)
    v_mfma_f32_16x16x32_bf16 v[50:53], v[34:37], v[108:111], v[50:53]
    v_mfma_f32_16x16x32_bf16 v[54:57], v[32:35], v[108:111], v[54:57]
    s_waitcnt vmcnt(3)
    v_mfma_f32_16x16x32_bf16 v[50:53], v[34:37], v[112:115], v[50:53]
    v_mfma_f32_16x16x32_bf16 v[54:57], v[32:35], v[112:115], v[54:57]
    s_waitcnt vmcnt(2)
    v_mfma_f32_16x16x32_bf16 v[50:53], v[34:37], v[116:119], v[50:53]
    v_mfma_f32_16x16x32_bf16 v[54:57], v[32:35], v[116:119], v[54:57]
    s_waitcnt vmcnt(1)
    v_mfma_f32_16x16x32_bf16 v[50:53], v[34:37], v[120:123], v[50:53]
    v_mfma_f32_16x16x32_bf16 v[54:57], v[32:35], v[120:123], v[54:57]
    s_waitcnt vmcnt(0)
    v_mfma_f32_16x16x32_bf16 v[50:53], v[34:37], v[124:127], v[50:53]
    v_mfma_f32_16x16x32_bf16 v[54:57], v[32:35], v[124:127], v[54:57]
    s_nop 6
    v_fma_f32 v50, v50, v72, v64
    v_fma_f32 v51, v51, v73, v65
    v_fma_f32 v52, v52, v74, v66
    v_fma_f32 v53, v53, v75, v67
    v_fma_f32 v54, v54, v76, v68
    v_fma_f32 v55, v55, v77, v69
    v_fma_f32 v56, v56, v78, v70
    v_fma_f32 v57, v57, v79, v71
    v_add_f32 v58, v50, v51
    v_mul_f32 v59, v50, v50
    v_mul_f32 v60, v50, v40
    v_fmac_f32 v59, v51, v51
    v_fmac_f32 v60, v51, v41
    v_add_f32 v58, v58, v52
    v_fmac_f32 v59, v52, v52
    v_fmac_f32 v60, v52, v42
    v_add_f32 v58, v58, v53
    v_fmac_f32 v59, v53, v53
    v_fmac_f32 v60, v53, v43
    v_add_f32 v58, v58, v54
    v_fmac_f32 v59, v54, v54
    v_fmac_f32 v60, v54, v44
    v_add_f32 v58, v58, v55
    v_fmac_f32 v59, v55, v55
    v_fmac_f32 v60, v55, v45
    v_add_f32 v58, v58, v56
    v_fmac_f32 v59, v56, v56
    v_fmac_f32 v60, v56, v46
    v_add_f32 v58, v58, v57
    v_fmac_f32 v59, v57, v57
    v_fmac_f32 v60, v57, v47
    v_cvt_pk_bf16_f32 v16, v50, v51
    v_cvt_pk_bf16_f32 v17, v52, v53
    v_cvt_pk_bf16_f32 v18, v54, v55
    v_cvt_pk_bf16_f32 v19, v56, v57
    ds_write_b64 v15, v[16:17] offset:8192
    ds_write_b64 v15, v[18:19] offset:8224
    v_mov_b32 v62, v58
    v_mov_b32 v63, v59
    v_mov_b32 v14, v60
    s_nop 0
    v_permlane16_swap_b32 v58, v62
    v_permlane16_swap_b32 v59, v63
    v_permlane16_swap_b32 v60, v14
    v_add_f32 v58, v58, v62
    v_add_f32 v59, v59, v63
    v_add_f32 v60, v60, v14
    v_mov_b32 v62, v58
    v_mov_b32 v63, v59
    v_mov_b32 v14, v60
    s_nop 0
    v_permlane32_swap_b32 v58, v62
    v_permlane32_swap_b32 v59, v63
    v_permlane32_swap_b32 v60, v14
    v_add_f32 v58, v58, v62
    v_add_f32 v59, v59, v63
    v_add_f32 v60, v60, v14
    s_mov_b64 exec, 0xffff
    ds_write_b32 v9, v58 offset:0
    ds_write_b32 v9, v59 offset:1024
    ds_write_b32 v9, v60 offset:2048
    s_mov_b64 exec, -1
    s_mov_b32 s33, 991054117
    s_cmp_lg_u32 s3, 0
    s_cbranch_scc1 k2g_np
    s_setprio 3
k2g_np:
    s_waitcnt lgkmcnt(0)
    s_barrier
    ds_read_b128 v[64:67], v3 offset:0
    ds_read_b128 v[68:71], v3 offset:1024
    ds_read_b128 v[72:75], v3 offset:2048
    ds_read_b128 v[76:79], v3 offset:3072
    ds_read_b128 v[80:83], v3 offset:4096
    s_waitcnt lgkmcnt(4)
    v_add_f32 v64, v64, v65
    v_add_f32 v66, v66, v67
    v_add_f32 v58, v64, v66
    s_waitcnt lgkmcnt(3)
    v_add_f32 v68, v68, v69
    v_add_f32 v70, v70, v71
    v_add_f32 v59, v68, v70
    s_waitcnt lgkmcnt(2)
    v_add_f32 v72, v72, v73
    v_add_f32 v74, v74, v75
    v_add_f32 v60, v72, v74
    s_waitcnt lgkmcnt(1)
    v_add_f32 v76, v76, v77
    v_add_f32 v78, v78, v79
    v_add_f32 v48, v76, v78
    s_waitcnt lgkmcnt(0)
    v_add_f32 v80, v80, v81
    v_add_f32 v82, v82, v83
    v_add_f32 v49, v80, v82
    v_mov_b32 v64, v58
    v_mov_b32 v65, v59
    v_mov_b32 v66, v60
    v_mov_b32 v67, v48
    v_mov_b32 v68, v49
    s_nop 0
    v_permlane16_swap_b32 v58, v64
    v_permlane16_swap_b32 v59, v65
    v_permlane16_swap_b32 v60, v66
    v_permlane16_swap_b32 v48, v67
    v_permlane16_swap_b32 v49, v68
    v_add_f32 v58, v58, v64
    v_add_f32 v59, v59, v65
    v_add_f32 v60, v60, v66
    v_add_f32 v48, v48, v67
    v_add_f32 v49, v49, v68
    v_mov_b32 v64, v58
    v_mov_b32 v65, v59
    v_mov_b32 v66, v60
    v_mov_b32 v67, v48
    v_mov_b32 v68, v49
    s_nop 0
    v_permlane32_swap_b32 v58, v64
    v_permlane32_swap_b32 v59, v65
    v_permlane32_swap_b32 v60, v66
    v_permlane32_swap_b32 v48, v67
    v_permlane32_swap_b32 v49, v68
    v_add_f32 v58, v58, v64
    v_add_f32 v59, v59, v65
    v_add_f32 v60, v60, v66
    v_add_f32 v48, v48, v67
    v_add_f32 v49, v49, v68
    v_mul_f32 v58, s33, v58
    v_mul_f32 v59, s33, v59
    v_mul_f32 v62, v58, v58
    v_sub_f32 v59, v59, v62
    v_mul_f32 v63, 1132462080, v59
    v_cmp_nle_f32 vcc, v62, v63
    s_cbranch_vccz k2g_varok
    v_sub_f32 v62, v50, v58
    v_mul_f32 v59, v62, v62
    v_mul_f32 v60, v62, v40
    v_sub_f32 v62, v51, v58
    v_fmac_f32 v59, v62, v62
    v_fmac_f32 v60, v62, v41
    v_sub_f32 v62, v52, v58
    v_fmac_f32 v59, v62, v62
    v_fmac_f32 v60, v62, v42
    v_sub_f32 v62, v53, v58
    v_fmac_f32 v59, v62, v62
    v_fmac_f32 v60, v62, v43
    v_sub_f32 v62, v54, v58
    v_fmac_f32 v59, v62, v62
    v_fmac_f32 v60, v62, v44
    v_sub_f32 v62, v55, v58
    v_fmac_f32 v59, v62, v62
    v_fmac_f32 v60, v62, v45
    v_sub_f32 v62, v56, v58
    v_fmac_f32 v59, v62, v62
    v_fmac_f32 v60, v62, v46
    v_sub_f32 v62, v57, v58
    v_fmac_f32 v59, v62, v62
    v_fmac_f32 v60, v62, v47
    v_mov_b32 v62, v59
    v_mov_b32 v63, v60
    s_nop 1
    v_permlane16_swap_b32 v59, v62
    v_permlane16_swap_b32 v60, v63
    v_add_f32 v59, v59, v62
    v_add_f32 v60, v60, v63
    v_mov_b32 v62, v59
    v_mov_b32 v63, v60
    s_nop 1
    v_permlane32_swap_b32 v59, v62
    v_permlane32_swap_b32 v60, v63
    v_add_f32 v59, v59, v62
    v_add_f32 v60, v60, v63
    s_mov_b64 exec, 0xffff
    ds_write_b32 v9, v59 offset:5120
    ds_write_b32 v9, v60 offset:6144
    s_mov_b64 exec, -1
    s_waitcnt lgkmcnt(0)
    s_barrier
    ds_read_b128 v[64:67], v3 offset:5120
    ds_read_b128 v[68:71], v3 offset:6144
    s_waitcnt lgkmcnt(1)
    v_add_f32 v64, v64, v65
    v_add_f32 v66, v66, v67
    v_add_f32 v59, v64, v66
    s_waitcnt lgkmcnt(0)
    v_add_f32 v68, v68, v69
    v_add_f32 v70, v70, v71
    v_add_f32 v60, v68, v70
    v_mov_b32 v64, v59
    v_mov_b32 v65, v60
    s_nop 1
    v_permlane16_swap_b32 v59, v64
    v_permlane16_swap_b32 v60, v65
    v_add_f32 v59, v59, v64
    v_add_f32 v60, v60, v65
    v_mov_b32 v64, v59
    v_mov_b32 v65, v60
    s_nop 1
    v_permlane32_swap_b32 v59, v64
    v_permlane32_swap_b32 v60, v65
    v_add_f32 v59, v59, v64
    v_add_f32 v60, v60, v65
    v_mul_f32 v59, s33, v59
    v_fmac_f32 v60, v58, v48
k2g_varok:
    v_add_f32 v59, 925353388, v59
    v_rsq_f32 v59, v59
    v_fma_f32 v60, -v58, v48, v60
    v_fma_f32 v60, v60, v59, v49
    v_cvt_pk_bf16_f32 v62, v60, v60
    v_lshlrev_b32 v62, 16, v62
    v_ashrrev_i32 v63, 31, v62
    v_or_b32 v63, 0x80000000, v63
    v_xor_b32 v62, v62, v63
    v_and_b32 v62, 0xffff0000, v62
    s_lshl_b32 s30, s69, 4
    s_sub_u32 s30, 0xffff, s30
    v_sub_u32 v63, s30, v1
    v_or_b32 v62, v62, v63
    v_mov_b32 v60, v62
    s_nop 1
    v_max_u32_dpp v60, v60, v60 quad_perm:[1,0,3,2] row_mask:0xf bank_mask:0xf
    s_nop 1
    v_max_u32_dpp v60, v60, v60 quad_perm:[2,3,0,1] row_mask:0xf bank_mask:0xf
    s_nop 1
    v_max_u32_dpp v60, v60, v60 row_half_mirror row_mask:0xf bank_mask:0xf
    s_nop 1
    v_max_u32_dpp v60, v60, v60 row_mirror row_mask:0xf bank_mask:0xf
    v_lshrrev_b32 v63, 3, v2
    v_lshlrev_b32 v63, 14, v63
    v_and_b32 v14, 7, v2
    v_lshl_add_u32 v14, v14, 4, v63
    v_cmp_eq_u32 s[38:39], v62, v60
    s_lshl_b32 s31, s69, 7
    s_add_u32 s31, s31, 2097152
    s_cmp_lg_u32 s3, 0
    s_cbranch_scc1 k2g_nokey
    s_ff1_i32_b64 s36, s[38:39]
    v_and_b32 v63, 1, v2
    v_cmp_eq_u32 vcc, 1, v63
    s_nop 1
    v_readlane_b32 s37, v58, s36
    v_readlane_b32 s66, v59, s36
    s_mul_i32 s36, s36, 904
    v_lshl_add_u32 v36, v2, 3, s36
    ds_read_b64 v[96:97], v36 offset:8192
    ds_read_b64 v[98:99], v36 offset:8704
    v_mov_b32 v62, v60
    v_mov_b32 v63, s37
    v_cndmask_b32 v100, v60, v63, vcc
    v_mov_b32 v63, s66
    v_cndmask_b32 v102, v62, v63, vcc
    v_mov_b32 v101, v61
    v_mov_b32 v103, v61
    buffer_store_dwordx4 v[100:103], v14, s[16:19], s31 offen sc1
    s_mul_i32 s30, s69, 3584
    s_add_u32 s30, s30, 2228224
    v_lshlrev_b32 v36, 4, v2
    v_mov_b32 v105, v61
    v_mov_b32 v107, v61
    v_mov_b32 v109, v61
    v_mov_b32 v111, v61
    s_waitcnt lgkmcnt(0)
    v_mov_b32 v104, v96
    v_mov_b32 v106, v97
    v_mov_b32 v108, v98
    v_mov_b32 v110, v99
    buffer_store_dwordx4 v[104:107], v36, s[16:19], s30 offen sc1
    buffer_store_dwordx4 v[108:111], v36, s[16:19], s30 offen offset:1024 sc1
    s_setprio 0
k2g_nokey:
    v_lshlrev_b32 v50, 16, v16
    v_and_b32 v51, 0xffff0000, v16
    v_lshlrev_b32 v52, 16, v17
    v_and_b32 v53, 0xffff0000, v17
    v_lshlrev_b32 v54, 16, v18
    v_and_b32 v55, 0xffff0000, v18
    v_lshlrev_b32 v56, 16, v19
    v_and_b32 v57, 0xffff0000, v19
    v_lshlrev_b32 v72, 16, v20
    v_and_b32 v73, 0xffff0000, v20
    v_lshlrev_b32 v74, 16, v21
    v_and_b32 v75, 0xffff0000, v21
    v_lshlrev_b32 v76, 16, v22
    v_and_b32 v77, 0xffff0000, v22
    v_lshlrev_b32 v78, 16, v23
    v_and_b32 v79, 0xffff0000, v23
    v_lshlrev_b32 v80, 16, v24
    v_and_b32 v81, 0xffff0000, v24
    v_lshlrev_b32 v82, 16, v25
    v_and_b32 v83, 0xffff0000, v25
    v_lshlrev_b32 v84, 16, v26
    v_and_b32 v85, 0xffff0000, v26
    v_lshlrev_b32 v86, 16, v27
    v_and_b32 v87, 0xffff0000, v27
    v_sub_f32 v64, v50, v58
    v_sub_f32 v65, v51, v58
    v_sub_f32 v66, v52, v58
    v_sub_f32 v67, v53, v58
    v_sub_f32 v68, v54, v58
    v_sub_f32 v69, v55, v58
    v_sub_f32 v70, v56, v58
    v_sub_f32 v71, v57, v58
    v_mul_f32 v72, v72, v59
    v_mul_f32 v73, v73, v59
    v_mul_f32 v74, v74, v59
    v_mul_f32 v75, v75, v59
    v_mul_f32 v76, v76, v59
    v_mul_f32 v77, v77, v59
    v_mul_f32 v78, v78, v59
    v_mul_f32 v79, v79, v59
    v_fma_f32 v64, v64, v72, v80
    v_fma_f32 v65, v65, v73, v81
    v_fma_f32 v66, v66, v74, v82
    v_fma_f32 v67, v67, v75, v83
    v_fma_f32 v68, v68, v76, v84
    v_fma_f32 v69, v69, v77, v85
    v_fma_f32 v70, v70, v78, v86
    v_fma_f32 v71, v71, v79, v87
    v_cvt_pk_bf16_f32 v96, v64, v50
    v_cvt_pk_bf16_f32 v98, v65, v51
    v_cvt_pk_bf16_f32 v100, v66, v52
    v_cvt_pk_bf16_f32 v102, v67, v53
    v_cvt_pk_bf16_f32 v104, v68, v54
    v_cvt_pk_bf16_f32 v106, v69, v55
    v_cvt_pk_bf16_f32 v108, v70, v56
    v_cvt_pk_bf16_f32 v110, v71, v57
    v_lshlrev_b32 v88, 16, v28
    v_and_b32 v89, 0xffff0000, v28
    v_lshlrev_b32 v90, 16, v29
    v_and_b32 v91, 0xffff0000, v29
    v_lshlrev_b32 v92, 16, v30
    v_and_b32 v93, 0xffff0000, v30
    v_lshlrev_b32 v94, 16, v31
    v_and_b32 v95, 0xffff0000, v31
    v_lshlrev_b32 v64, 16, v96
    v_and_b32 v50, 0xffff0000, v96
    v_lshlrev_b32 v65, 16, v98
    v_and_b32 v51, 0xffff0000, v98
    v_lshlrev_b32 v66, 16, v100
    v_and_b32 v52, 0xffff0000, v100
    v_lshlrev_b32 v67, 16, v102
    v_and_b32 v53, 0xffff0000, v102
    v_lshlrev_b32 v68, 16, v104
    v_and_b32 v54, 0xffff0000, v104
    v_lshlrev_b32 v69, 16, v106
    v_and_b32 v55, 0xffff0000, v106
    v_lshlrev_b32 v70, 16, v108
    v_and_b32 v56, 0xffff0000, v108
    v_lshlrev_b32 v71, 16, v110
    v_and_b32 v57, 0xffff0000, v110
    v_mul_f32 v88, v64, v88
    v_mul_f32 v89, v65, v89
    v_mul_f32 v90, v66, v90
    v_mul_f32 v91, v67, v91
    v_mul_f32 v92, v68, v92
    v_mul_f32 v93, v69, v93
    v_mul_f32 v94, v70, v94
    v_mul_f32 v95, v71, v95
    v_cvt_pk_bf16_f32 v80, v88, v89
    v_cvt_pk_bf16_f32 v81, v90, v91
    v_cvt_pk_bf16_f32 v82, v92, v93
    v_cvt_pk_bf16_f32 v83, v94, v95
    v_lshlrev_b32 v88, 16, v80
    v_and_b32 v89, 0xffff0000, v80
    v_lshlrev_b32 v90, 16, v81
    v_and_b32 v91, 0xffff0000, v81
    v_lshlrev_b32 v92, 16, v82
    v_and_b32 v93, 0xffff0000, v82
    v_lshlrev_b32 v94, 16, v83
    v_and_b32 v95, 0xffff0000, v83
    v_add_f32 v88, v88, v50
    v_add_f32 v89, v89, v51
    v_add_f32 v90, v90, v52
    v_add_f32 v91, v91, v53
    v_add_f32 v92, v92, v54
    v_add_f32 v93, v93, v55
    v_add_f32 v94, v94, v56
    v_add_f32 v95, v95, v57
    v_cvt_pk_bf16_f32 v80, v88, v89
    v_cvt_pk_bf16_f32 v81, v90, v91
    v_cvt_pk_bf16_f32 v82, v92, v93
    v_cvt_pk_bf16_f32 v83, v94, v95
    s_andn2_b64 exec, exec, s[38:39]
    buffer_store_dwordx2 v[80:81], v6, s[24:27], s29 offen
    buffer_store_dwordx2 v[82:83], v6, s[24:27], s29 offen offset:32
    s_mov_b64 exec, -1
    s_cmp_lg_u32 s3, 0
    s_cbranch_scc1 k2g_r_kwait
    v_lshlrev_b32 v37, 8, v2
    s_and_b32 s30, s2, 7
    s_lshl_b32 s30, s30, 14
    s_add_u32 s30, s30, 2097152
    s_mov_b32 s34, 262144
    s_sleep 40
k2g_r_kpoll:
    buffer_load_dwordx2 v[20:21], v37, s[16:19], s30 offen sc1
    buffer_load_dwordx2 v[22:23], v37, s[16:19], s30 offen offset:128 sc1
    s_waitcnt vmcnt(0)
    v_xor_b32 v21, v21, v61
    v_xor_b32 v23, v23, v61
    v_or_b32 v21, v21, v23
    v_cmp_ne_u32 vcc, 0, v21
    s_cbranch_vccz k2g_r_kok
    s_sleep 1
    s_sub_u32 s34, s34, 1
    s_cbranch_scc0 k2g_r_kpoll
k2g_r_kok:
    v_max_u32 v20, v20, v22
    s_nop 1
    v_max_u32_dpp v20, v20, v20 row_shr:1 row_mask:0xf bank_mask:0xf
    s_nop 1
    v_max_u32_dpp v20, v20, v20 row_shr:2 row_mask:0xf bank_mask:0xf
    s_nop 1
    v_max_u32_dpp v20, v20, v20 row_shr:4 row_mask:0xf bank_mask:0xf
    s_nop 1
    v_max_u32_dpp v20, v20, v20 row_shr:8 row_mask:0xf bank_mask:0xf
    s_nop 1
    v_max_u32_dpp v20, v20, v20 row_bcast:15 row_mask:0xa bank_mask:0xf
    s_nop 1
    v_max_u32_dpp v20, v20, v20 row_bcast:31 row_mask:0xc bank_mask:0xf
    v_mov_b32 v21, 32768
    s_mov_b32 exec_lo, 0
    s_mov_b32 exec_hi, 0x80000000
    ds_write_b32 v21, v20
    s_mov_b64 exec, -1
    s_waitcnt lgkmcnt(0)
k2g_r_kwait:
    s_barrier
    v_mov_b32 v21, 32768
    ds_read_b32 v20, v21
    s_waitcnt lgkmcnt(0)
    v_readfirstlane_b32 s32, v20
    s_nop 3
    s_not_b32 s33, s32
    s_and_b32 s35, s33, 0x7ff
    s_lshr_b32 s33, s35, 4
    s_cmp_eq_u32 s33, s69
    s_cbranch_scc1 k2g_done2
    s_mov_b64 exec, s[38:39]
    buffer_store_dwordx2 v[80:81], v6, s[24:27], s29 offen
    buffer_store_dwordx2 v[82:83], v6, s[24:27], s29 offen offset:32
    s_branch k2g_done2
k2g_ffn:
    s_cmp_ge_u32 s2, 240
    s_cbranch_scc1 k2g_fin
    s_sub_u32 s60, s2, 128
    s_and_b32 s61, s60, 7
    s_mul_i32 s61, s61, 14
    s_lshr_b32 s60, s60, 3
    s_add_u32 s60, s60, s61
    s_cmp_ge_u32 s3, 7
    s_cbranch_scc1 k2g_down
    v_and_b32 v5, 31, v2
    v_lshl_add_u32 v5, v9, 5, v5
    v_mul_u32_u24 v4, 3584, v5
    v_lshrrev_b32 v3, 5, v2
    v_lshl_add_u32 v4, v3, 4, v4
    s_lshl_b32 s62, s60, 5
    s_add_u32 s63, s62, 802816
    buffer_load_dwordx4 v[100:103], v4, s[48:51], s62 offen
    buffer_load_dwordx4 v[104:107], v4, s[48:51], s63 offen
    buffer_load_dwordx4 v[108:111], v4, s[52:55], s62 offen
    buffer_load_dwordx4 v[112:115], v4, s[52:55], s63 offen
    v_bfe_u32 v4, v2, 4, 1
    v_lshlrev_b32 v4, 9, v4
    v_lshl_add_u32 v4, v3, 8, v4
    v_bfe_u32 v6, v2, 2, 2
    v_lshl_add_u32 v4, v6, 6, v4
    v_lshl_add_u32 v4, v9, 2, v4
    v_lshlrev_b32 v6, 2, v5
    s_mov_b32 s62, 1844480
    buffer_load_dword v44, v6, s[16:19], s62 offen
    buffer_load_dword v45, v6, s[16:19], s62 offen offset:896
    buffer_load_dword v46, v6, s[16:19], s62 offen offset:1792
    buffer_load_dword v47, v6, s[16:19], s62 offen offset:2688
    v_and_b32 v7, 1, v5
    v_lshlrev_b32 v7, 4, v7
    v_sub_u32 v7, 16, v7
    v_lshrrev_b32 v5, 1, v5
    v_lshlrev_b32 v5, 3, v5
    s_waitcnt vmcnt(0)
    v_lshlrev_b32 v64, 16, v100
    v_and_b32 v65, 0xffff0000, v100
    v_lshlrev_b32 v66, 16, v101
    v_and_b32 v67, 0xffff0000, v101
    v_lshlrev_b32 v68, 16, v102
    v_and_b32 v69, 0xffff0000, v102
    v_lshlrev_b32 v70, 16, v103
    v_and_b32 v71, 0xffff0000, v103
    v_lshlrev_b32 v72, 16, v104
    v_and_b32 v73, 0xffff0000, v104
    v_lshlrev_b32 v74, 16, v105
    v_and_b32 v75, 0xffff0000, v105
    v_lshlrev_b32 v76, 16, v106
    v_and_b32 v77, 0xffff0000, v106
    v_lshlrev_b32 v78, 16, v107
    v_and_b32 v79, 0xffff0000, v107
    v_lshlrev_b32 v80, 16, v108
    v_and_b32 v81, 0xffff0000, v108
    v_lshlrev_b32 v82, 16, v109
    v_and_b32 v83, 0xffff0000, v109
    v_lshlrev_b32 v84, 16, v110
    v_and_b32 v85, 0xffff0000, v110
    v_lshlrev_b32 v86, 16, v111
    v_and_b32 v87, 0xffff0000, v111
    v_lshlrev_b32 v88, 16, v112
    v_and_b32 v89, 0xffff0000, v112
    v_lshlrev_b32 v90, 16, v113
    v_and_b32 v91, 0xffff0000, v113
    v_lshlrev_b32 v92, 16, v114
    v_and_b32 v93, 0xffff0000, v114
    v_lshlrev_b32 v94, 16, v115
    v_and_b32 v95, 0xffff0000, v115
    s_cmp_lg_u32 s3, 0
    s_cbranch_scc1 k2g_f_kwait
    v_lshlrev_b32 v37, 8, v2
    s_and_b32 s30, s2, 7
    s_lshl_b32 s30, s30, 14
    s_add_u32 s30, s30, 2097152
    s_mov_b32 s34, 262144
    s_and_b32 s35, s2, 63
    s_lshl_b64 exec, 1, s35
k2g_f_kpre:
    buffer_load_dwordx2 v[20:21], v37, s[16:19], s30 offen sc1
    s_waitcnt vmcnt(0)
    v_cmp_ne_u32 vcc, v21, v61
    s_cbranch_vccz k2g_f_kpok
    s_sleep 4
    s_sub_u32 s34, s34, 1
    s_cbranch_scc0 k2g_f_kpre
k2g_f_kpok:
    s_mov_b64 exec, -1
    s_mov_b32 s34, 262144
k2g_f_kpoll:
    buffer_load_dwordx2 v[20:21], v37, s[16:19], s30 offen sc1
    buffer_load_dwordx2 v[22:23], v37, s[16:19], s30 offen offset:128 sc1
    s_waitcnt vmcnt(0)
    v_xor_b32 v21, v21, v61
    v_xor_b32 v23, v23, v61
    v_or_b32 v21, v21, v23
    v_cmp_ne_u32 vcc, 0, v21
    s_cbranch_vccz k2g_f_kok
    s_sleep 1
    s_sub_u32 s34, s34, 1
    s_cbranch_scc0 k2g_f_kpoll
k2g_f_kok:
    v_max_u32 v20, v20, v22
    s_nop 1
    v_max_u32_dpp v20, v20, v20 row_shr:1 row_mask:0xf bank_mask:0xf
    s_nop 1
    v_max_u32_dpp v20, v20, v20 row_shr:2 row_mask:0xf bank_mask:0xf
    s_nop 1
    v_max_u32_dpp v20, v20, v20 row_shr:4 row_mask:0xf bank_mask:0xf
    s_nop 1
    v_max_u32_dpp v20, v20, v20 row_shr:8 row_mask:0xf bank_mask:0xf
    s_nop 1
    v_max_u32_dpp v20, v20, v20 row_bcast:15 row_mask:0xa bank_mask:0xf
    s_nop 1
    v_max_u32_dpp v20, v20, v20 row_bcast:31 row_mask:0xc bank_mask:0xf
    v_mov_b32 v21, 32768
    s_mov_b32 exec_lo, 0
    s_mov_b32 exec_hi, 0x80000000
    ds_write_b32 v21, v20
    s_mov_b64 exec, -1
    s_waitcnt lgkmcnt(0)
k2g_f_kwait:
    s_barrier
    v_mov_b32 v21, 32768
    ds_read_b32 v20, v21
    s_waitcnt lgkmcnt(0)
    v_readfirstlane_b32 s32, v20
    s_nop 3
    s_not_b32 s33, s32
    s_and_b32 s35, s33, 0x7ff
    s_lshr_b32 s33, s35, 4
    s_lshl_b32 s67, s33, 7
    s_and_b32 s66, s2, 7
    s_lshl_b32 s66, s66, 14
    s_add_u32 s67, s67, s66
    s_add_u32 s67, s67, 2097168
    s_mul_i32 s33, s33, 3584
    s_add_u32 s33, s33, 2228224
    s_mov_b32 s34, 262144
k2g_xpoll:
    buffer_load_dwordx2 v[40:41], v5, s[16:19], s33 offen sc1
    buffer_load_dwordx2 v[42:43], v5, s[16:19], s33 offen offset:896 sc1
    buffer_load_dwordx4 v[48:51], off, s[16:19], s67 sc1
    s_waitcnt vmcnt(0)
    v_xor_b32 v41, v41, v61
    v_xor_b32 v43, v43, v61
    v_or_b32 v41, v41, v43
    v_xor_b32 v49, v49, v61
    v_xor_b32 v51, v51, v61
    v_or3_b32 v41, v41, v49, v51
    v_cmp_ne_u32 vcc, 0, v41
    s_cbranch_vccz k2g_xok
    s_sub_u32 s34, s34, 1
    s_cbranch_scc0 k2g_xpoll
k2g_xok:
    v_lshlrev_b32 v40, v7, v40
    v_lshlrev_b32 v42, v7, v42
    v_and_b32 v40, 0xffff0000, v40
    v_and_b32 v42, 0xffff0000, v42
    v_mul_f32 v46, v46, v50
    v_mul_f32 v47, v47, v50
    v_sub_f32 v40, v40, v48
    v_sub_f32 v42, v42, v48
    v_fma_f32 v40, v40, v46, v44
    v_fma_f32 v42, v42, v47, v45
    v_cvt_pk_bf16_f32 v40, v40, v42
    v_and_b32 v42, 0xffff0000, v40
    v_lshlrev_b32 v40, 16, v40
    v_mul_f32 v64, v64, v40
    v_mul_f32 v80, v80, v40
    v_mul_f32 v65, v65, v40
    v_mul_f32 v81, v81, v40
    v_mul_f32 v66, v66, v40
    v_mul_f32 v82, v82, v40
    v_mul_f32 v67, v67, v40
    v_mul_f32 v83, v83, v40
    v_mul_f32 v68, v68, v40
    v_mul_f32 v84, v84, v40
    v_mul_f32 v69, v69, v40
    v_mul_f32 v85, v85, v40
    v_mul_f32 v70, v70, v40
    v_mul_f32 v86, v86, v40
    v_mul_f32 v71, v71, v40
    v_mul_f32 v87, v87, v40
    v_fmac_f32 v64, v72, v42
    v_fmac_f32 v80, v88, v42
    v_fmac_f32 v65, v73, v42
    v_fmac_f32 v81, v89, v42
    v_fmac_f32 v66, v74, v42
    v_fmac_f32 v82, v90, v42
    v_fmac_f32 v67, v75, v42
    v_fmac_f32 v83, v91, v42
    v_fmac_f32 v68, v76, v42
    v_fmac_f32 v84, v92, v42
    v_fmac_f32 v69, v77, v42
    v_fmac_f32 v85, v93, v42
    v_fmac_f32 v70, v78, v42
    v_fmac_f32 v86, v94, v42
    v_fmac_f32 v71, v79, v42
    v_fmac_f32 v87, v95, v42
    s_nop 0
    v_permlane16_swap_b32 v64, v80
    v_permlane16_swap_b32 v65, v81
    v_permlane16_swap_b32 v66, v82
    v_permlane16_swap_b32 v67, v83
    v_permlane16_swap_b32 v68, v84
    v_permlane16_swap_b32 v69, v85
    v_permlane16_swap_b32 v70, v86
    v_permlane16_swap_b32 v71, v87
    v_add_f32 v64, v64, v80
    v_add_f32 v65, v65, v81
    v_add_f32 v66, v66, v82
    v_add_f32 v67, v67, v83
    v_add_f32 v68, v68, v84
    v_add_f32 v69, v69, v85
    v_add_f32 v70, v70, v86
    v_add_f32 v71, v71, v87
    s_nop 0
    v_add_f32_dpp v72, v64, v64 row_ror:8 row_mask:0xf bank_mask:0x3
    v_add_f32_dpp v73, v65, v65 row_ror:8 row_mask:0xf bank_mask:0x3
    v_add_f32_dpp v74, v66, v66 row_ror:8 row_mask:0xf bank_mask:0x3
    v_add_f32_dpp v75, v67, v67 row_ror:8 row_mask:0xf bank_mask:0x3
    v_add_f32_dpp v72, v68, v68 row_ror:8 row_mask:0xf bank_mask:0xc
    v_add_f32_dpp v73, v69, v69 row_ror:8 row_mask:0xf bank_mask:0xc
    v_add_f32_dpp v74, v70, v70 row_ror:8 row_mask:0xf bank_mask:0xc
    v_add_f32_dpp v75, v71, v71 row_ror:8 row_mask:0xf bank_mask:0xc
    s_nop 0
    v_add_f32_dpp v76, v72, v72 row_half_mirror row_mask:0xf bank_mask:0x5
    v_add_f32_dpp v77, v73, v73 row_half_mirror row_mask:0xf bank_mask:0x5
    s_nop 0
    v_add_f32_dpp v76, v74, v74 row_half_mirror row_mask:0xf bank_mask:0xa
    v_add_f32_dpp v77, v75, v75 row_half_mirror row_mask:0xf bank_mask:0xa
    s_nop 1
    v_add_f32_dpp v76, v76, v76 quad_perm:[1,0,3,2] row_mask:0xf bank_mask:0xf
    v_add_f32_dpp v77, v77, v77 quad_perm:[1,0,3,2] row_mask:0xf bank_mask:0xf
    s_nop 1
    v_add_f32_dpp v76, v76, v76 quad_perm:[2,3,0,1] row_mask:0xf bank_mask:0xf
    v_add_f32_dpp v77, v77, v77 quad_perm:[2,3,0,1] row_mask:0xf bank_mask:0xf
    s_mov_b32 exec_lo, 0x11111111
    s_mov_b32 exec_hi, 0x11111111
    ds_write_b32 v4, v76
    ds_write_b32 v4, v77 offset:32
    s_waitcnt lgkmcnt(0)
    s_barrier
    s_branch k2g_done2
k2g_down:
    v_lshrrev_b32 v6, 3, v2
    v_and_b32 v7, 7, v2
    s_sub_u32 s36, s3, 7
    s_lshl_b32 s37, s36, 7
    v_mul_u32_u24 v4, 896, v6
    v_lshl_add_u32 v4, v7, 4, v4
    s_mul_i32 s62, s60, 14336
    s_add_u32 s62, s62, s37
    s_add_u32 s63, s62, 7168
    buffer_load_dwordx4 v[100:103], v4, s[56:59], s62 offen
    buffer_load_dwordx4 v[104:107], v4, s[56:59], s63 offen
    v_lshlrev_b32 v4, 5, v6
    v_lshlrev_b32 v8, 6, v7
    v_lshl_add_u32 v8, v6, 3, v8
    s_mul_i32 s29, s60, 3584
    s_lshl_b32 s36, s36, 9
    s_add_u32 s29, s29, s36
    s_add_u32 s29, s29, 2686976
    s_mov_b32 s33, 3216550459
    s_waitcnt vmcnt(0)
    v_lshlrev_b32 v20, 16, v100
    v_and_b32 v21, 0xffff0000, v100
    v_lshlrev_b32 v22, 16, v101
    v_and_b32 v23, 0xffff0000, v101
    v_lshlrev_b32 v24, 16, v102
    v_and_b32 v25, 0xffff0000, v102
    v_lshlrev_b32 v26, 16, v103
    v_and_b32 v27, 0xffff0000, v103
    v_lshlrev_b32 v28, 16, v104
    v_and_b32 v29, 0xffff0000, v104
    v_lshlrev_b32 v30, 16, v105
    v_and_b32 v31, 0xffff0000, v105
    v_lshlrev_b32 v32, 16, v106
    v_and_b32 v33, 0xffff0000, v106
    v_lshlrev_b32 v34, 16, v107
    v_and_b32 v35, 0xffff0000, v107
    s_barrier
    s_barrier
    ds_read_b128 v[64:67], v4 offset:0
    ds_read_b96 v[68:70], v4 offset:16
    ds_read_b128 v[72:75], v4 offset:512
    ds_read_b96 v[76:78], v4 offset:528
    ds_read_b128 v[80:83], v4 offset:256
    ds_read_b96 v[84:86], v4 offset:272
    ds_read_b128 v[88:91], v4 offset:768
    ds_read_b96 v[92:94], v4 offset:784
    s_waitcnt lgkmcnt(6)
    v_add_f32 v64, v64, v65
    v_add_f32 v66, v66, v67
    v_add_f32 v68, v68, v69
    v_add_f32 v64, v64, v66
    v_add_f32 v68, v68, v70
    v_add_f32 v64, v64, v68
    s_waitcnt lgkmcnt(4)
    v_add_f32 v72, v72, v73
    v_add_f32 v74, v74, v75
    v_add_f32 v76, v76, v77
    v_add_f32 v72, v72, v74
    v_add_f32 v76, v76, v78
    v_add_f32 v72, v72, v76
    s_waitcnt lgkmcnt(2)
    v_add_f32 v80, v80, v81
    v_add_f32 v82, v82, v83
    v_add_f32 v84, v84, v85
    v_add_f32 v80, v80, v82
    v_add_f32 v84, v84, v86
    v_add_f32 v80, v80, v84
    s_waitcnt lgkmcnt(0)
    v_add_f32 v88, v88, v89
    v_add_f32 v90, v90, v91
    v_add_f32 v92, v92, v93
    v_add_f32 v88, v88, v90
    v_add_f32 v92, v92, v94
    v_add_f32 v88, v88, v92
    v_cvt_pk_bf16_f32 v65, v64, v80
    v_cvt_pk_bf16_f32 v66, v72, v88
    v_lshlrev_b32 v68, 16, v65
    v_and_b32 v69, 0xffff0000, v65
    v_lshlrev_b32 v70, 16, v66
    v_and_b32 v71, 0xffff0000, v66
    v_mul_f32 v72, s33, v68
    v_mul_f32 v73, s33, v69
    v_exp_f32 v72, v72
    v_exp_f32 v73, v73
    s_nop 0
    v_add_f32 v72, 1.0, v72
    v_add_f32 v73, 1.0, v73
    v_rcp_f32 v72, v72
    v_rcp_f32 v73, v73
    s_nop 0
    v_mul_f32 v68, v68, v72
    v_mul_f32 v69, v69, v73
    v_cvt_pk_bf16_f32 v72, v68, v69
    v_lshlrev_b32 v68, 16, v72
    v_and_b32 v69, 0xffff0000, v72
    v_mul_f32 v68, v68, v70
    v_mul_f32 v69, v69, v71
    v_cvt_pk_bf16_f32 v72, v68, v69
    v_lshlrev_b32 v68, 16, v72
    v_and_b32 v69, 0xffff0000, v72
    v_mul_f32 v20, v20, v68
    v_mul_f32 v21, v21, v68
    v_mul_f32 v22, v22, v68
    v_mul_f32 v23, v23, v68
    v_mul_f32 v24, v24, v68
    v_mul_f32 v25, v25, v68
    v_mul_f32 v26, v26, v68
    v_mul_f32 v27, v27, v68
    v_fmac_f32 v20, v28, v69
    v_fmac_f32 v21, v29, v69
    v_fmac_f32 v22, v30, v69
    v_fmac_f32 v23, v31, v69
    v_fmac_f32 v24, v32, v69
    v_fmac_f32 v25, v33, v69
    v_fmac_f32 v26, v34, v69
    v_fmac_f32 v27, v35, v69
    s_nop 0
    v_permlane32_swap_b32 v20, v24
    v_permlane32_swap_b32 v21, v25
    v_permlane32_swap_b32 v22, v26
    v_permlane32_swap_b32 v23, v27
    v_add_f32 v20, v20, v24
    v_add_f32 v21, v21, v25
    v_add_f32 v22, v22, v26
    v_add_f32 v23, v23, v27
    s_nop 0
    v_permlane16_swap_b32 v20, v22
    v_permlane16_swap_b32 v21, v23
    v_add_f32 v20, v20, v22
    v_add_f32 v21, v21, v23
    s_nop 1
    v_add_f32_dpp v60, v20, v20 row_ror:8 row_mask:0xf bank_mask:0x3
    s_nop 1
    v_add_f32_dpp v60, v21, v21 row_ror:8 row_mask:0xf bank_mask:0xc
    buffer_store_dwordx2 v[60:61], v8, s[16:19], s29 offen sc1
    s_branch k2g_done2
k2g_fin:
    s_sub_u32 s60, s2, 240
    s_lshl_b32 s61, s60, 8
    v_and_b32 v4, 31, v0
    v_lshlrev_b32 v5, 3, v4
    v_lshlrev_b32 v7, 2, v4
    s_lshl_b32 s62, s60, 7
    s_add_u32 s62, s62, 1848064
    buffer_load_dword v30, v7, s[16:19], s62 offen
    s_sub_u32 s62, s62, 3584
    buffer_load_dword v44, v7, s[16:19], s62 offen
    buffer_load_dword v46, v7, s[16:19], s62 offen offset:1792
    v_and_b32 v6, 1, v4
    v_lshlrev_b32 v6, 4, v6
    v_sub_u32 v6, 16, v6
    v_lshrrev_b32 v5, 1, v4
    v_lshlrev_b32 v5, 3, v5
    v_lshrrev_b32 v8, 4, v0
    v_mul_u32_u24 v8, 3584, v8
    v_lshl_add_u32 v8, v1, 4, v8
    s_cmp_lg_u32 s3, 0
    s_cbranch_scc1 k2g_z_kwait
    v_lshlrev_b32 v37, 8, v2
    s_and_b32 s30, s2, 7
    s_lshl_b32 s30, s30, 14
    s_add_u32 s30, s30, 2097152
    s_mov_b32 s34, 262144
    s_and_b32 s35, s2, 63
    s_lshl_b64 exec, 1, s35
k2g_z_kpre:
    buffer_load_dwordx2 v[20:21], v37, s[16:19], s30 offen sc1
    s_waitcnt vmcnt(0)
    v_cmp_ne_u32 vcc, v21, v61
    s_cbranch_vccz k2g_z_kpok
    s_sleep 4
    s_sub_u32 s34, s34, 1
    s_cbranch_scc0 k2g_z_kpre
k2g_z_kpok:
    s_mov_b64 exec, -1
    s_mov_b32 s34, 262144
k2g_z_kpoll:
    buffer_load_dwordx2 v[20:21], v37, s[16:19], s30 offen sc1
    buffer_load_dwordx2 v[22:23], v37, s[16:19], s30 offen offset:128 sc1
    s_waitcnt vmcnt(0)
    v_xor_b32 v21, v21, v61
    v_xor_b32 v23, v23, v61
    v_or_b32 v21, v21, v23
    v_cmp_ne_u32 vcc, 0, v21
    s_cbranch_vccz k2g_z_kok
    s_sleep 1
    s_sub_u32 s34, s34, 1
    s_cbranch_scc0 k2g_z_kpoll
k2g_z_kok:
    v_max_u32 v20, v20, v22
    s_nop 1
    v_max_u32_dpp v20, v20, v20 row_shr:1 row_mask:0xf bank_mask:0xf
    s_nop 1
    v_max_u32_dpp v20, v20, v20 row_shr:2 row_mask:0xf bank_mask:0xf
    s_nop 1
    v_max_u32_dpp v20, v20, v20 row_shr:4 row_mask:0xf bank_mask:0xf
    s_nop 1
    v_max_u32_dpp v20, v20, v20 row_shr:8 row_mask:0xf bank_mask:0xf
    s_nop 1
    v_max_u32_dpp v20, v20, v20 row_bcast:15 row_mask:0xa bank_mask:0xf
    s_nop 1
    v_max_u32_dpp v20, v20, v20 row_bcast:31 row_mask:0xc bank_mask:0xf
    v_mov_b32 v21, 32768
    s_mov_b32 exec_lo, 0
    s_mov_b32 exec_hi, 0x80000000
    ds_write_b32 v21, v20
    s_mov_b64 exec, -1
    s_waitcnt lgkmcnt(0)
k2g_z_kwait:
    s_barrier
    v_mov_b32 v21, 32768
    ds_read_b32 v20, v21
    s_waitcnt lgkmcnt(0)
    v_readfirstlane_b32 s32, v20
    s_nop 3
    s_not_b32 s33, s32
    s_and_b32 s35, s33, 0x7ff
    s_lshr_b32 s33, s35, 4
    s_lshl_b32 s67, s33, 7
    s_and_b32 s66, s2, 7
    s_lshl_b32 s66, s66, 14
    s_add_u32 s67, s67, s66
    s_add_u32 s67, s67, 2097168
    s_mul_i32 s33, s33, 3584
    s_add_u32 s33, s33, 2228224
    s_lshr_b32 s66, s61, 1
    s_add_u32 s33, s33, s66
    s_and_b32 s34, s32, 0xffff0000
    s_xor_b32 s36, s34, 0x80000000
    s_andn2_b32 s37, 0xffff0000, s34
    s_bitcmp1_b32 s34, 31
    s_cselect_b32 s34, s36, s37
    v_mov_b32 v33, s34
    v_mul_f32 v33, 3216550459, v33
    v_exp_f32 v33, v33
    s_nop 0
    v_add_f32 v33, 1.0, v33
    v_rcp_f32 v33, v33
    s_nop 0
    v_cvt_pk_bf16_f32 v33, v33, v33
    v_lshlrev_b32 v33, 16, v33
    s_add_u32 s62, s61, 2686976
    s_add_u32 s63, s62, 200704
    s_mov_b32 s34, 262144
k2g_ypoll:
    buffer_load_dwordx2 v[40:41], v5, s[16:19], s33 offen sc1
    buffer_load_dwordx4 v[48:51], off, s[16:19], s67 sc1
    buffer_load_dwordx4 v[20:23], v8, s[16:19], s62 offen sc1
    buffer_load_dwordx4 v[24:27], v8, s[16:19], s63 offen sc1
    s_waitcnt vmcnt(0)
    v_xor_b32 v21, v21, v61
    v_xor_b32 v23, v23, v61
    v_xor_b32 v25, v25, v61
    v_xor_b32 v27, v27, v61
    v_xor_b32 v41, v41, v61
    v_xor_b32 v49, v49, v61
    v_xor_b32 v51, v51, v61
    v_or3_b32 v41, v41, v49, v51
    v_or3_b32 v21, v21, v23, v25
    v_or3_b32 v21, v21, v27, v41
    v_cmp_ne_u32 vcc, 0, v21
    s_cbranch_vccz k2g_yok
    s_sleep 1
    s_sub_u32 s34, s34, 1
    s_cbranch_scc0 k2g_ypoll
k2g_yok:
    v_add_f32 v20, v20, v24
    v_add_f32 v21, v22, v26
    v_mov_b32 v22, v20
    v_mov_b32 v23, v21
    s_nop 1
    v_permlane16_swap_b32 v20, v22
    v_permlane16_swap_b32 v21, v23
    v_add_f32 v20, v20, v22
    v_add_f32 v21, v21, v23
    v_mov_b32 v22, v20
    v_mov_b32 v23, v21
    s_nop 1
    v_permlane32_swap_b32 v20, v22
    v_permlane32_swap_b32 v21, v23
    v_add_f32 v20, v20, v22
    v_add_f32 v21, v21, v23
    v_lshlrev_b32 v9, 7, v9
    v_lshl_add_u32 v9, v1, 3, v9
    s_mov_b64 exec, 0xffff
    ds_write_b64 v9, v[20:21]
    s_mov_b64 exec, -1
    s_waitcnt lgkmcnt(0)
    s_barrier
    s_cmp_lg_u32 s3, 0
    s_cbranch_scc1 k2g_done2
    s_mov_b32 exec_hi, 0
    ds_read_b32 v8, v7 offset:0
    ds_read_b32 v9, v7 offset:128
    ds_read_b32 v10, v7 offset:256
    ds_read_b32 v11, v7 offset:384
    ds_read_b32 v12, v7 offset:512
    ds_read_b32 v13, v7 offset:640
    ds_read_b32 v14, v7 offset:768
    ds_read_b32 v15, v7 offset:896
    ds_read_b32 v16, v7 offset:1024
    ds_read_b32 v17, v7 offset:1152
    ds_read_b32 v18, v7 offset:1280
    ds_read_b32 v19, v7 offset:1408
    ds_read_b32 v20, v7 offset:1536
    ds_read_b32 v21, v7 offset:1664
    v_lshlrev_b32 v32, v6, v40
    v_and_b32 v32, 0xffff0000, v32
    v_mul_f32 v46, v46, v50
    v_sub_f32 v31, v32, v48
    v_fma_f32 v31, v31, v46, v44
    v_cvt_pk_bf16_f32 v31, v31, v31
    v_lshlrev_b32 v31, 16, v31
    s_waitcnt lgkmcnt(0)
    v_add_f32 v8, v8, v15
    v_add_f32 v9, v9, v16
    v_add_f32 v10, v10, v17
    v_add_f32 v11, v11, v18
    v_add_f32 v12, v12, v19
    v_add_f32 v13, v13, v20
    v_add_f32 v14, v14, v21
    v_add_f32 v8, v8, v9
    v_add_f32 v10, v10, v11
    v_add_f32 v12, v12, v13
    v_add_f32 v8, v8, v10
    v_add_f32 v12, v12, v14
    v_add_f32 v8, v8, v12
    v_cvt_pk_bf16_f32 v8, v8, v8
    v_lshlrev_b32 v8, 16, v8
    v_mul_f32 v8, v8, v33
    v_cvt_pk_bf16_f32 v8, v8, v8
    v_lshlrev_b32 v8, 16, v8
    v_add_f32 v8, v8, v31
    v_cvt_pk_bf16_f32 v8, v8, v8
    v_lshlrev_b32 v8, 16, v8
    v_mul_f32 v8, v8, v30
    v_cvt_pk_bf16_f32 v8, v8, v8
    v_lshlrev_b32 v8, 16, v8
    v_add_f32 v8, v8, v32
    v_cvt_pk_bf16_f32 v8, v8, v8
    s_mul_i32 s29, s35, 896
    s_lshl_b32 s28, s60, 6
    s_add_u32 s29, s29, s28
    v_lshlrev_b32 v5, 1, v4
    buffer_store_short v8, v5, s[24:27], s29 offen
k2g_done2:
    s_endpgm
k2g_done:
    s_endpgm
k2g_end:
.section .rodata,"a"
.p2align 6
.amdhsa_kernel k1_kernel
  .amdhsa_next_free_vgpr 512
  .amdhsa_next_free_sgpr 100
  .amdhsa_accum_offset 256
  .amdhsa_group_segment_fixed_size 0
  .amdhsa_kernarg_size 120
  .amdhsa_user_sgpr_count 2
  .amdhsa_user_sgpr_kernarg_segment_ptr 1
  .amdhsa_system_sgpr_workgroup_id_x 1
.end_amdhsa_kernel
.p2align 6
.amdhsa_kernel k2g_kernel
  .amdhsa_next_free_vgpr 128
  .amdhsa_next_free_sgpr 96
  .amdhsa_accum_offset 128
  .amdhsa_group_segment_fixed_size 0
  .amdhsa_kernarg_size 120
  .amdhsa_user_sgpr_count 2
  .amdhsa_user_sgpr_kernarg_segment_ptr 1
  .amdhsa_system_sgpr_workgroup_id_x 1
.end_amdhsa_kernel
```
